```python
import torch

def _softmax(x, axis=-1):
    return torch.softmax(x, dim=axis)
def _gelu(x):
    return torch.nn.functional.gelu(x, approximate="tanh")
def _silu(x):
    return torch.nn.functional.silu(x)
def _sigmoid(x):
    return torch.sigmoid(x)
def _layernorm(x, axis=-1, eps=1e-5):
    m = x.mean(dim=axis, keepdim=True)
    v = x.var(dim=axis, keepdim=True, unbiased=False)
    return (x - m) / torch.sqrt(v + eps)
def _scatter_add(tgt, idx, src, axis=0):
    return tgt.clone().index_add_(axis, idx, src)
def _segment_sum(src, seg, n):
    out = torch.zeros((n,) + src.shape[1:], dtype=src.dtype)
    return out.index_add_(0, seg, src)
def _pad(x, pw):
    flat = tuple(v for pair in reversed(pw) for v in pair)
    return torch.nn.functional.pad(x, flat)

kernel_name = 'interleave_layers__mha_block__mixer_channel_mlp__prompt'

def setup_inputs():

    _w = (lambda a: (lambda t: t.to(torch.bfloat16) if t.is_floating_point() else t)(torch.as_tensor(a)))
    def _A_setup():
        B, S, D, H = 1, 2048, 1024, 32
        return {
            "x": _w((lambda *s: torch.randn(*s, dtype=torch.bfloat16) * 0.05)(B, S, D)),
            "wqkv": _w((lambda *s: torch.randn(*s, dtype=torch.bfloat16) * 0.05)(D, 3 * D)),
            "wo": _w((lambda *s: torch.randn(*s, dtype=torch.bfloat16) * 0.05)(D, D)),
        }
    _A_in = _A_setup()

    def _B_setup():
        B, S, D, F = 1, 2048, 1024, 3584
        return {
            "x": _w((lambda *s: torch.randn(*s, dtype=torch.bfloat16) * 0.05)(B, S, D)),
            "w1": _w((lambda *s: torch.randn(*s, dtype=torch.bfloat16) * 3.2)(D, F) * (D ** -0.5)),
            "b1": _w((lambda *s: torch.randn(*s, dtype=torch.bfloat16) * 0.8)(F)),
            "w2": _w((lambda *s: torch.randn(*s, dtype=torch.bfloat16) * 0.4)(F, D) * (F ** -0.5)),
            "b2": _w((lambda *s: torch.randn(*s, dtype=torch.bfloat16) * 0.4)(D)),
        }
    _B_in = _B_setup()

    return {
        "A_x": _A_in["x"],
        "A_wqkv": _A_in["wqkv"],
        "A_wo": _A_in["wo"],
        "B_x": _B_in["x"],
        "B_w1": _B_in["w1"],
        "B_b1": _B_in["b1"],
        "B_w2": _B_in["w2"],
        "B_b2": _B_in["b2"],
    }

def reference(A_x, A_wqkv, A_wo, B_x, B_w1, B_b1, B_w2, B_b2):
    def _A_ref(x, wqkv, wo):
        B, S, D = x.shape
        H = 32
        Dh = D // H
        qkv = (lambda x, *d: x.permute(*d))((x @ wqkv).reshape(B, S, 3, H, Dh), 2, 0, 3, 1, 4)
        q, k, v = qkv[0], qkv[1], qkv[2]
        scores = torch.einsum("bhqd,bhkd->bhqk", q, k) * (Dh ** -0.5)
        p = _softmax(scores, axis=-1)
        o = torch.einsum("bhqk,bhkd->bhqd", p, v)
        return (lambda x, *d: x.permute(*d))(o, 0, 2, 1, 3).reshape(B, S, D) @ wo

    def _B_ref(x, w1, b1, w2, b2):
        y = _layernorm(x, axis=-1)
        h = _gelu(torch.einsum("bsd,df->bsf", y, w1) + b1)
        return torch.einsum("bsf,fd->bsd", h, w2) + b2

    x = A_x
    x = x + _A_ref(_layernorm(x, axis=-1), A_wqkv, A_wo)
    x = x + _B_ref(_layernorm(x, axis=-1), B_w1, B_b1, B_w2, B_b2)
    x = x + _A_ref(_layernorm(x, axis=-1), A_wqkv, A_wo)
    x = x + _B_ref(_layernorm(x, axis=-1), B_w1, B_b1, B_w2, B_b2)
    return x
```

```asm
; @launch kernel=qkv_a_kernel grid=(256,1,1) block=(512,1,1) lds=163840
.amdgcn_target "amdgcn-amd-amdhsa--gfx950"
.text
.p2align 8
code_start:
.p2align 8
cs_qkv:
.globl qkv_b_kernel
.p2align 8
.type qkv_b_kernel,@function
qkv_b_kernel:
    s_mov_b32 s3, 0
    s_branch qkv_body
.globl qkv_a_kernel
.p2align 8
.type qkv_a_kernel,@function
qkv_a_kernel:
    s_mov_b32 s3, 1
    s_mov_b32 s98, 0
    s_mov_b32 s99, -1
qkv_body:
    s_cmp_ge_u32 s2, 256
    s_cbranch_scc1 L_qkv_end
qkv_run:
    s_load_dwordx2 s[4:5], s[0:1], 0
    s_load_dwordx2 s[6:7], s[0:1], 8
    s_load_dwordx2 s[30:31], s[0:1], 80
    s_load_dwordx2 s[32:33], s[0:1], 64
    s_load_dwordx2 s[34:35], s[0:1], 56
    s_xor_b32 s29, s3, 1
    s_mul_i32 s29, s29, 134217728
    v_lshrrev_b32 v1, 6, v0
    v_and_b32 v0, 63, v0
    v_readfirstlane_b32 s40, v1
    s_and_b32 s43, s2, 7
    s_lshr_b32 s44, s2, 3
    s_and_b32 s41, s43, 1
    s_lshl_b32 s41, s41, 3
    s_and_b32 s42, s44, 7
    s_add_u32 s41, s41, s42
    s_lshr_b32 s42, s43, 1
    s_lshl_b32 s42, s42, 2
    s_lshr_b32 s44, s44, 3
    s_add_u32 s42, s42, s44
    s_mov_b32 s97, s40
    s_lshl_b32 s96, s42, 4
    s_add_u32 s96, s96, s41
    s_cmp_ge_u32 s40, 4
    s_cbranch_scc0 L_qkv_compute
L_qkv_loader:
    s_sub_u32 s51, s40, 4
    v_lshrrev_b32 v1, 3, v0
    v_lshrrev_b32 v2, 1, v1
    s_and_b32 s43, s51, 1
    s_lshl_b32 s44, s43, 2
    v_add_u32 v2, s44, v2
    v_and_b32 v3, 7, v0
    v_xor_b32 v2, v2, v3
    v_lshlrev_b32 v2, 4, v2
    s_lshl_b32 s44, s51, 3
    v_add_u32 v1, s44, v1
    s_lshl_b32 s46, s41, 7
    v_add_u32 v1, s46, v1
    s_cmp_lg_u32 s3, 0
    s_cbranch_scc1 L_qkv_xr11
    v_lshrrev_b32 v3, 6, v2
    v_and_b32 v4, 48, v2
    v_lshl_add_u32 v4, v3, 17, v4
    v_lshl_add_u32 v8, v1, 6, v4
    v_add_u32 v9, 2048, v8
    v_add_u32 v10, 4096, v8
    v_add_u32 v11, 6144, v8
    s_branch L_qkv_xj12
L_qkv_xr11:
    v_lshl_add_u32 v8, v1, 11, v2
    v_add_u32 v9, 65536, v8
    v_add_u32 v10, 131072, v8
    v_add_u32 v11, 196608, v8
L_qkv_xj12:
    s_cmp_lg_u32 s3, 0
    s_mov_b32 s61, 262144
    s_cselect_b32 s61, 128, s61
    v_lshrrev_b32 v1, 5, v0
    v_bfe_u32 v2, v0, 2, 2
    v_lshl_add_u32 v1, v1, 2, v2
    v_add_u32 v1, s44, v1
    v_mul_u32_u24 v1, 6144, v1
    v_and_b32 v2, 3, v0
    s_lshl_b32 s43, s43, 1
    v_xor_b32 v2, s43, v2
    v_bfe_u32 v3, v0, 4, 1
    v_lshl_add_u32 v2, v3, 2, v2
    v_lshl_add_u32 v1, v2, 4, v1
    s_lshl_b32 s43, s42, 7
    v_add_u32 v1, s43, v1
    v_add_u32 v12, 0, v1
    v_add_u32 v13, 2048, v1
    v_add_u32 v14, 4096, v1
    v_add_u32 v15, 196608, v1
    v_add_u32 v16, 198656, v1
    v_add_u32 v17, 200704, v1
    s_lshl_b32 s53, s51, 10
    s_mul_i32 s54, s51, 3072
    s_add_u32 s54, s54, 16384
    s_mov_b32 s45, 0
    s_add_u32 s55, s41, s42
    s_and_b32 s55, s55, 15
    s_mul_i32 s55, s55, 1
    s_mul_i32 s55, s55, s3
    s_mul_i32 s47, s55, 128
    s_mul_i32 s48, s55, 393216
    s_waitcnt lgkmcnt(0)
    s_add_u32 s43, s30, 50331648
    s_addc_u32 s44, s31, 0
    s_cmp_lg_u32 s3, 0
    s_cselect_b32 s8, s4, s43
    s_cselect_b32 s9, s5, s44
    s_and_b32 s9, s9, 0xffff
    s_mov_b32 s10, 4194304
    s_mov_b32 s11, 131072
    s_mov_b32 s12, s6
    s_and_b32 s13, s7, 0xffff
    s_mov_b32 s14, 6291456
    s_mov_b32 s15, 131072
    s_mov_b32 s46, 2
L_qkv_wp13:
    s_add_u32 s49, s45, s53
    s_add_u32 s50, s45, s54
    s_add_u32 m0, s50, 0
    s_nop 0
    buffer_load_dwordx4 v12, s[12:15], s48 offen lds
    s_add_u32 m0, s50, 1024
    s_nop 0
    buffer_load_dwordx4 v13, s[12:15], s48 offen lds
    s_add_u32 m0, s50, 2048
    s_nop 0
    buffer_load_dwordx4 v14, s[12:15], s48 offen lds
    s_add_u32 m0, s50, 12288
    s_nop 0
    buffer_load_dwordx4 v15, s[12:15], s48 offen lds
    s_add_u32 m0, s50, 13312
    s_nop 0
    buffer_load_dwordx4 v16, s[12:15], s48 offen lds
    s_add_u32 m0, s50, 14336
    s_nop 0
    buffer_load_dwordx4 v17, s[12:15], s48 offen lds
    s_add_u32 s48, s48, 393216
    s_cmp_eq_u32 s48, 6291456
    s_cselect_b32 s48, 0, s48
    s_add_u32 s45, s45, 40960
    s_cmp_eq_u32 s45, 163840
    s_cselect_b32 s45, 0, s45
    s_sub_u32 s46, s46, 1
    s_cmp_lg_u32 s46, 0
    s_cbranch_scc1 L_qkv_wp13
    s_cmp_eq_u32 s99, -1
    s_cbranch_scc1 L_qkv_dwe14
    s_cmp_lg_u32 s97, 4
    s_cbranch_scc1 L_qkv_dwb15
    s_add_u32 s64, s30, 65011712
    s_addc_u32 s65, s31, 0
    s_and_b32 s65, s65, 0xffff
    s_mov_b32 s66, 1048576
    s_mov_b32 s67, 131072
    v_lshlrev_b32 v76, 7, v0
    s_mov_b32 s46, 0x400000
    s_mov_b64 exec, 0xffff
L_qkv_dwp16:
    buffer_load_dword v77, v76, s[64:67], s99 offen sc1
    s_waitcnt vmcnt(0)
    v_cmp_ne_u32 vcc, s95, v77
    s_sub_u32 s46, s46, 1
    s_cbranch_scc1 L_qkv_dwg17
    s_nop 1
    s_cbranch_vccz L_qkv_dwg17
    s_sleep 1
    s_branch L_qkv_dwp16
L_qkv_dwg17:
    s_mov_b64 exec, -1
L_qkv_dwb15:
    s_barrier
L_qkv_dwe14:
    s_mov_b32 s45, 0
    s_add_u32 s49, s45, s53
    s_add_u32 s50, s45, s54
    s_add_u32 m0, s49, 0
    s_nop 0
    buffer_load_dwordx4 v8, s[8:11], s47 offen lds
    s_add_u32 m0, s49, 4096
    s_nop 0
    buffer_load_dwordx4 v9, s[8:11], s47 offen lds
    s_add_u32 m0, s49, 8192
    s_nop 0
    buffer_load_dwordx4 v10, s[8:11], s47 offen lds
    s_add_u32 m0, s49, 12288
    s_nop 0
    buffer_load_dwordx4 v11, s[8:11], s47 offen lds
    s_add_u32 s47, s47, s61
    s_cmp_eq_u32 s47, 2048
    s_cselect_b32 s47, 0, s47
    s_add_u32 s45, s45, 40960
    s_cmp_eq_u32 s45, 163840
    s_cselect_b32 s45, 0, s45
    s_add_u32 s49, s45, s53
    s_add_u32 s50, s45, s54
    s_add_u32 m0, s49, 0
    s_nop 0
    buffer_load_dwordx4 v8, s[8:11], s47 offen lds
    s_add_u32 m0, s49, 4096
    s_nop 0
    buffer_load_dwordx4 v9, s[8:11], s47 offen lds
    s_add_u32 m0, s49, 8192
    s_nop 0
    buffer_load_dwordx4 v10, s[8:11], s47 offen lds
    s_add_u32 m0, s49, 12288
    s_nop 0
    buffer_load_dwordx4 v11, s[8:11], s47 offen lds
    s_add_u32 s47, s47, s61
    s_cmp_eq_u32 s47, 2048
    s_cselect_b32 s47, 0, s47
    s_add_u32 s45, s45, 40960
    s_cmp_eq_u32 s45, 163840
    s_cselect_b32 s45, 0, s45
    s_waitcnt vmcnt(4)
    s_barrier
    s_add_u32 s49, s45, s53
    s_add_u32 s50, s45, s54
    s_add_u32 m0, s49, 0
    s_nop 0
    buffer_load_dwordx4 v8, s[8:11], s47 offen lds
    s_add_u32 m0, s49, 4096
    s_nop 0
    buffer_load_dwordx4 v9, s[8:11], s47 offen lds
    s_add_u32 m0, s50, 0
    s_nop 0
    buffer_load_dwordx4 v12, s[12:15], s48 offen lds
    s_add_u32 m0, s50, 1024
    s_nop 0
    buffer_load_dwordx4 v13, s[12:15], s48 offen lds
    s_add_u32 m0, s50, 2048
    s_nop 0
    buffer_load_dwordx4 v14, s[12:15], s48 offen lds
    s_add_u32 m0, s49, 8192
    s_nop 0
    buffer_load_dwordx4 v10, s[8:11], s47 offen lds
    s_add_u32 m0, s49, 12288
    s_nop 0
    buffer_load_dwordx4 v11, s[8:11], s47 offen lds
    s_add_u32 m0, s50, 12288
    s_nop 0
    buffer_load_dwordx4 v15, s[12:15], s48 offen lds
    s_add_u32 m0, s50, 13312
    s_nop 0
    buffer_load_dwordx4 v16, s[12:15], s48 offen lds
    s_add_u32 m0, s50, 14336
    s_nop 0
    buffer_load_dwordx4 v17, s[12:15], s48 offen lds
    s_add_u32 s47, s47, s61
    s_cmp_eq_u32 s47, 2048
    s_cselect_b32 s47, 0, s47
    s_add_u32 s48, s48, 393216
    s_cmp_eq_u32 s48, 6291456
    s_cselect_b32 s48, 0, s48
    s_add_u32 s45, s45, 40960
    s_cmp_eq_u32 s45, 163840
    s_cselect_b32 s45, 0, s45
    s_add_u32 s49, s45, s53
    s_add_u32 s50, s45, s54
    s_add_u32 m0, s49, 0
    s_nop 0
    buffer_load_dwordx4 v8, s[8:11], s47 offen lds
    s_add_u32 m0, s49, 4096
    s_nop 0
    buffer_load_dwordx4 v9, s[8:11], s47 offen lds
    s_add_u32 m0, s50, 0
    s_nop 0
    buffer_load_dwordx4 v12, s[12:15], s48 offen lds
    s_add_u32 m0, s50, 1024
    s_nop 0
    buffer_load_dwordx4 v13, s[12:15], s48 offen lds
    s_add_u32 m0, s50, 2048
    s_nop 0
    buffer_load_dwordx4 v14, s[12:15], s48 offen lds
    s_add_u32 m0, s49, 8192
    s_nop 0
    buffer_load_dwordx4 v10, s[8:11], s47 offen lds
    s_add_u32 m0, s49, 12288
    s_nop 0
    buffer_load_dwordx4 v11, s[8:11], s47 offen lds
    s_add_u32 m0, s50, 12288
    s_nop 0
    buffer_load_dwordx4 v15, s[12:15], s48 offen lds
    s_add_u32 m0, s50, 13312
    s_nop 0
    buffer_load_dwordx4 v16, s[12:15], s48 offen lds
    s_add_u32 m0, s50, 14336
    s_nop 0
    buffer_load_dwordx4 v17, s[12:15], s48 offen lds
    s_add_u32 s47, s47, s61
    s_cmp_eq_u32 s47, 2048
    s_cselect_b32 s47, 0, s47
    s_add_u32 s48, s48, 393216
    s_cmp_eq_u32 s48, 6291456
    s_cselect_b32 s48, 0, s48
    s_add_u32 s45, s45, 40960
    s_cmp_eq_u32 s45, 163840
    s_cselect_b32 s45, 0, s45
    s_mov_b32 s46, 12
L_qkv_lloop:
    s_waitcnt vmcnt(20)
    s_barrier
    s_add_u32 s49, s45, s53
    s_add_u32 s50, s45, s54
    s_add_u32 m0, s49, 0
    s_nop 0
    buffer_load_dwordx4 v8, s[8:11], s47 offen lds
    s_add_u32 m0, s49, 4096
    s_nop 0
    buffer_load_dwordx4 v9, s[8:11], s47 offen lds
    s_add_u32 m0, s50, 0
    s_nop 0
    buffer_load_dwordx4 v12, s[12:15], s48 offen lds
    s_add_u32 m0, s50, 1024
    s_nop 0
    buffer_load_dwordx4 v13, s[12:15], s48 offen lds
    s_add_u32 m0, s50, 2048
    s_nop 0
    buffer_load_dwordx4 v14, s[12:15], s48 offen lds
    s_add_u32 m0, s49, 8192
    s_nop 0
    buffer_load_dwordx4 v10, s[8:11], s47 offen lds
    s_add_u32 m0, s49, 12288
    s_nop 0
    buffer_load_dwordx4 v11, s[8:11], s47 offen lds
    s_add_u32 m0, s50, 12288
    s_nop 0
    buffer_load_dwordx4 v15, s[12:15], s48 offen lds
    s_add_u32 m0, s50, 13312
    s_nop 0
    buffer_load_dwordx4 v16, s[12:15], s48 offen lds
    s_add_u32 m0, s50, 14336
    s_nop 0
    buffer_load_dwordx4 v17, s[12:15], s48 offen lds
    s_add_u32 s47, s47, s61
    s_cmp_eq_u32 s47, 2048
    s_cselect_b32 s47, 0, s47
    s_add_u32 s48, s48, 393216
    s_cmp_eq_u32 s48, 6291456
    s_cselect_b32 s48, 0, s48
    s_add_u32 s45, s45, 40960
    s_cmp_eq_u32 s45, 163840
    s_cselect_b32 s45, 0, s45
    s_sub_u32 s46, s46, 1
    s_cmp_lg_u32 s46, 0
    s_cbranch_scc1 L_qkv_lloop
    s_add_u32 s24, s30, 37748736
    s_addc_u32 s25, s31, 0
    s_and_b32 s25, s25, 0xffff
    s_mov_b32 s26, 2097152
    s_mov_b32 s27, 131072
    s_mov_b32 s36, s34
    s_and_b32 s37, s35, 0xffff
    s_mov_b32 s38, 2048
    s_mov_b32 s39, 131072
    v_and_b32 v1, 31, v0
    s_lshl_b32 s43, s41, 7
    s_lshl_b32 s44, s51, 5
    s_add_u32 s43, s43, s44
    v_add_u32 v1, s43, v1
    v_lshlrev_b32 v1, 3, v1
    v_lshrrev_b32 v2, 5, v0
    v_lshl_add_u32 v1, v2, 17, v1
    s_mul_i32 s43, s3, 2146435072
    v_add_u32 v1, s43, v1
    s_mov_b32 s43, 0
    buffer_load_dwordx2 v[24:25], v1, s[24:27], s43 offen
    s_mov_b32 s43, 16384
    buffer_load_dwordx2 v[26:27], v1, s[24:27], s43 offen
    s_mov_b32 s43, 32768
    buffer_load_dwordx2 v[28:29], v1, s[24:27], s43 offen
    s_mov_b32 s43, 49152
    buffer_load_dwordx2 v[30:31], v1, s[24:27], s43 offen
    s_mov_b32 s43, 65536
    buffer_load_dwordx2 v[32:33], v1, s[24:27], s43 offen
    s_mov_b32 s43, 81920
    buffer_load_dwordx2 v[34:35], v1, s[24:27], s43 offen
    s_mov_b32 s43, 98304
    buffer_load_dwordx2 v[36:37], v1, s[24:27], s43 offen
    s_mov_b32 s43, 114688
    buffer_load_dwordx2 v[38:39], v1, s[24:27], s43 offen
    s_min_u32 s43, s51, 2
    s_lshl_b32 s43, s43, 10
    s_lshl_b32 s44, s42, 6
    s_add_u32 s43, s43, s44
    v_add_u32 v2, s43, v0
    v_lshlrev_b32 v3, 2, v2
    v_mov_b32 v47, v3
    s_cmp_lg_u32 s3, 0
    s_mov_b32 s43, 1048576
    s_cselect_b32 s43, 2146435072, s43
    buffer_load_dword v56, v3, s[24:27], s43 offen
    s_waitcnt vmcnt(29)
    s_barrier
    s_waitcnt vmcnt(19)
    s_barrier
    s_waitcnt vmcnt(9)
    s_barrier
    s_cmp_lg_u32 s3, 0
    s_cbranch_scc1 L_qkv_ool18
L_qkv_back19:
    s_waitcnt vmcnt(0)
    v_add_f32 v1, v24, v26
    v_add_f32 v2, v28, v30
    v_add_f32 v3, v32, v34
    v_add_f32 v4, v36, v38
    v_add_f32 v1, v1, v2
    v_add_f32 v3, v3, v4
    v_add_f32 v1, v1, v3
    v_mul_f32 v1, 0.125, v1
    v_mov_b32 v2, 0
    v_sub_f32 v24, v24, v1
    v_fmac_f32 v2, v24, v24
    v_sub_f32 v26, v26, v1
    v_fmac_f32 v2, v26, v26
    v_sub_f32 v28, v28, v1
    v_fmac_f32 v2, v28, v28
    v_sub_f32 v30, v30, v1
    v_fmac_f32 v2, v30, v30
    v_sub_f32 v32, v32, v1
    v_fmac_f32 v2, v32, v32
    v_sub_f32 v34, v34, v1
    v_fmac_f32 v2, v34, v34
    v_sub_f32 v36, v36, v1
    v_fmac_f32 v2, v36, v36
    v_sub_f32 v38, v38, v1
    v_fmac_f32 v2, v38, v38
    v_mul_f32 v2, 0x42800000, v2
    v_add_f32 v2, v2, v25
    v_add_f32 v2, v2, v27
    v_add_f32 v2, v2, v29
    v_add_f32 v2, v2, v31
    v_add_f32 v2, v2, v33
    v_add_f32 v2, v2, v35
    v_add_f32 v2, v2, v37
    v_add_f32 v2, v2, v39
    v_mov_b32 v3, v1
    v_mov_b32 v4, v2
    s_nop 1
    v_permlane32_swap_b32 v1, v3
    v_permlane32_swap_b32 v2, v4
    v_sub_f32 v5, v1, v3
    v_add_f32 v1, v1, v3
    v_mul_f32 v1, 0.5, v1
    v_add_f32 v2, v2, v4
    v_mul_f32 v6, 0x43800000, v5
    v_fmac_f32 v2, v5, v6
    v_mul_f32 v2, 0x3a800000, v2
    s_cmp_lg_u32 s3, 0
    s_cbranch_scc1 L_qkv_ool20
L_qkv_back21:
    v_add_f32 v3, 0x3727c5ac, v2
    v_rsq_f32 v50, v3
    s_nop 0
    v_mul_f32 v51, v50, v1
    v_sub_f32 v51, 0, v51
    v_and_b32 v1, 31, v0
    s_lshl_b32 s43, s51, 8
    v_lshl_add_u32 v1, v1, 3, s43
    ds_write_b64 v1, v[50:51] offset:0
    v_lshl_add_u32 v1, v0, 2, s43
    ds_write_b32 v1, v56 offset:1024
    s_waitcnt lgkmcnt(0)
    s_barrier
    s_lshr_b32 s43, s2, 3
    s_lshl_b32 s43, s43, 2
    s_add_u32 s43, s43, s51
    s_cmp_ge_u32 s43, 2
    s_cbranch_scc1 L_qkv_nct23
    s_getpc_b64 s[64:65]
L_qkv_pc22:
    s_sub_u32 s64, s64, L_qkv_pc22-code_start
    s_subb_u32 s65, s65, 0
    v_lshl_add_u32 v2, s43, 6, v0
    v_lshlrev_b32 v2, 7, v2
    v_add_u32 v2, cs_attn-code_start, v2
    v_min_u32 v2, ce_attn-code_start-4, v2
    v_mov_b32 v3, s65
    v_add_co_u32 v2, vcc, s64, v2
    s_nop 1
    v_addc_co_u32 v3, vcc, 0, v3, vcc
    global_load_dword v7, v[2:3], off
L_qkv_nct23:
    s_branch L_sync_qkv
L_qkv_end:
    s_endpgm
L_qkv_compute:
    s_lshr_b32 s51, s40, 1
    s_and_b32 s52, s40, 1
    v_and_b32 v1, 15, v0
    v_lshrrev_b32 v2, 4, v0
    v_lshrrev_b32 v3, 1, v1
    v_xor_b32 v3, v3, v2
    v_lshlrev_b32 v3, 4, v3
    v_lshl_add_u32 v7, v1, 7, v3
    s_lshl_b32 s43, s51, 13
    v_add_u32 v7, s43, v7
    v_xor_b32 v8, 64, v7
    v_lshrrev_b32 v3, 2, v1
    v_and_b32 v4, 3, v1
    v_lshlrev_b32 v3, 6, v3
    v_lshl_add_u32 v3, v4, 3, v3
    v_and_b32 v4, 1, v2
    v_lshl_add_u32 v5, v4, 5, v3
    v_mul_u32_u24 v6, 3072, v2
    v_add_u32 v9, v5, v6
    s_lshl_b32 s43, s52, 8
    s_add_u32 s43, s43, 16384
    v_add_u32 v9, s43, v9
    v_xor_b32 v10, 32, v9
    s_xor_b32 s43, s3, 1
    s_or_b32 s43, s43, s2
    s_or_b32 s43, s43, s40
    s_cmp_eq_u32 s43, 0
    s_cbranch_scc1 L_qkv_ool1
L_qkv_back2:
    s_lshr_b32 s43, s2, 3
    s_lshl_b32 s43, s43, 2
    s_add_u32 s43, s43, s40
    s_xor_b32 s44, s3, 1
    s_lshl_b32 s44, s44, 8
    s_add_u32 s43, s43, s44
    s_cmp_ge_u32 s43, 8
    s_cbranch_scc1 L_qkv_nct4
    s_getpc_b64 s[64:65]
L_qkv_pc3:
    s_sub_u32 s64, s64, L_qkv_pc3-code_start
    s_subb_u32 s65, s65, 0
    v_lshl_add_u32 v4, s43, 6, v0
    v_lshlrev_b32 v4, 7, v4
    v_add_u32 v4, code_start-code_start, v4
    v_min_u32 v4, code_end-code_start-4, v4
    v_mov_b32 v5, s65
    v_add_co_u32 v4, vcc, s64, v4
    s_nop 1
    v_addc_co_u32 v5, vcc, 0, v5, vcc
    global_load_dword v19, v[4:5], off
L_qkv_nct4:
    s_waitcnt lgkmcnt(0)
    s_add_u32 s16, s30, s29
    s_addc_u32 s17, s31, 0
    s_and_b32 s17, s17, 0xffff
    s_mov_b32 s18, 12587008
    s_mov_b32 s19, 131072
    s_add_u32 s24, s30, 37748736
    s_addc_u32 s25, s31, 0
    s_and_b32 s25, s25, 0xffff
    s_mov_b32 s26, 2097152
    s_mov_b32 s27, 131072
    s_mov_b32 s36, s34
    s_and_b32 s37, s35, 0xffff
    s_mov_b32 s38, 2048
    s_mov_b32 s39, 131072
    v_mov_b32 v20, 0
    v_mov_b32 v21, 0
    v_mov_b32 v22, 0
    v_mov_b32 v23, 0
    v_mov_b32 v24, 0
    v_mov_b32 v25, 0
    v_mov_b32 v26, 0
    v_mov_b32 v27, 0
    v_mov_b32 v28, 0
    v_mov_b32 v29, 0
    v_mov_b32 v30, 0
    v_mov_b32 v31, 0
    v_mov_b32 v32, 0
    v_mov_b32 v33, 0
    v_mov_b32 v34, 0
    v_mov_b32 v35, 0
    v_mov_b32 v36, 0
    v_mov_b32 v37, 0
    v_mov_b32 v38, 0
    v_mov_b32 v39, 0
    v_mov_b32 v40, 0
    v_mov_b32 v41, 0
    v_mov_b32 v42, 0
    v_mov_b32 v43, 0
    v_mov_b32 v44, 0
    v_mov_b32 v45, 0
    v_mov_b32 v46, 0
    v_mov_b32 v47, 0
    v_mov_b32 v48, 0
    v_mov_b32 v49, 0
    v_mov_b32 v50, 0
    v_mov_b32 v51, 0
    v_mov_b32 v52, 0
    v_mov_b32 v53, 0
    v_mov_b32 v54, 0
    v_mov_b32 v55, 0
    v_mov_b32 v56, 0
    v_mov_b32 v57, 0
    v_mov_b32 v58, 0
    v_mov_b32 v59, 0
    v_mov_b32 v60, 0
    v_mov_b32 v61, 0
    v_mov_b32 v62, 0
    v_mov_b32 v63, 0
    v_mov_b32 v64, 0
    v_mov_b32 v65, 0
    v_mov_b32 v66, 0
    v_mov_b32 v67, 0
    v_mov_b32 v68, 0
    v_mov_b32 v69, 0
    v_mov_b32 v70, 0
    v_mov_b32 v71, 0
    v_mov_b32 v72, 0
    v_mov_b32 v73, 0
    v_mov_b32 v74, 0
    v_mov_b32 v75, 0
    v_mov_b32 v76, 0
    v_mov_b32 v77, 0
    v_mov_b32 v78, 0
    v_mov_b32 v79, 0
    v_mov_b32 v80, 0
    v_mov_b32 v81, 0
    v_mov_b32 v82, 0
    v_mov_b32 v83, 0
    v_mov_b32 v84, 0
    v_mov_b32 v85, 0
    v_mov_b32 v86, 0
    v_mov_b32 v87, 0
    v_mov_b32 v88, 0
    v_mov_b32 v89, 0
    v_mov_b32 v90, 0
    v_mov_b32 v91, 0
    v_mov_b32 v92, 0
    v_mov_b32 v93, 0
    v_mov_b32 v94, 0
    v_mov_b32 v95, 0
    v_mov_b32 v96, 0
    v_mov_b32 v97, 0
    v_mov_b32 v98, 0
    v_mov_b32 v99, 0
    v_mov_b32 v100, 0
    v_mov_b32 v101, 0
    v_mov_b32 v102, 0
    v_mov_b32 v103, 0
    v_mov_b32 v104, 0
    v_mov_b32 v105, 0
    v_mov_b32 v106, 0
    v_mov_b32 v107, 0
    v_mov_b32 v108, 0
    v_mov_b32 v109, 0
    v_mov_b32 v110, 0
    v_mov_b32 v111, 0
    v_mov_b32 v112, 0
    v_mov_b32 v113, 0
    v_mov_b32 v114, 0
    v_mov_b32 v115, 0
    s_mov_b32 s45, 0
    s_cmp_eq_u32 s99, -1
    s_cbranch_scc1 L_qkv_dwe5
    s_barrier
L_qkv_dwe5:
    v_mov_b32 v196, 0
    v_mov_b32 v197, 0
    v_mov_b32 v198, 0
    v_mov_b32 v199, 0
    v_mov_b32 v200, 0
    v_mov_b32 v201, 0
    v_mov_b32 v202, 0
    v_mov_b32 v203, 0
    v_mov_b32 v204, 0
    v_mov_b32 v205, 0
    v_mov_b32 v206, 0
    v_mov_b32 v207, 0
    v_mov_b32 v208, 0
    v_mov_b32 v209, 0
    v_mov_b32 v210, 0
    v_mov_b32 v211, 0
    v_mov_b32 v212, 0
    v_mov_b32 v213, 0
    v_mov_b32 v214, 0
    v_mov_b32 v215, 0
    v_mov_b32 v216, 0
    v_mov_b32 v217, 0
    v_mov_b32 v218, 0
    v_mov_b32 v219, 0
    v_mov_b32 v220, 0
    v_mov_b32 v221, 0
    v_mov_b32 v222, 0
    v_mov_b32 v223, 0
    v_mov_b32 v224, 0
    v_mov_b32 v225, 0
    v_mov_b32 v226, 0
    v_mov_b32 v227, 0
    v_mov_b32 v228, 0
    v_mov_b32 v229, 0
    v_mov_b32 v230, 0
    v_mov_b32 v231, 0
    v_mov_b32 v232, 0
    v_mov_b32 v233, 0
    v_mov_b32 v234, 0
    v_mov_b32 v235, 0
    v_mov_b32 v236, 0
    v_mov_b32 v237, 0
    v_mov_b32 v238, 0
    v_mov_b32 v239, 0
    v_mov_b32 v240, 0
    v_mov_b32 v241, 0
    v_mov_b32 v242, 0
    v_mov_b32 v243, 0
    v_mov_b32 v244, 0
    v_mov_b32 v245, 0
    v_mov_b32 v246, 0
    v_mov_b32 v247, 0
    v_mov_b32 v248, 0
    v_mov_b32 v249, 0
    v_mov_b32 v250, 0
    v_mov_b32 v251, 0
    v_mov_b32 v252, 0x3f803f80
    v_mov_b32 v253, 0x3f803f80
    v_mov_b32 v254, 0x3f803f80
    v_mov_b32 v255, 0x3f803f80
    s_mov_b32 s46, 15
    v_add_u32 v12, s45, v7
    v_add_u32 v13, s45, v8
    v_add_u32 v14, s45, v9
    v_add_u32 v15, s45, v10
    s_barrier
    ds_read_b128 v[116:119], v12 offset:0
    ds_read_b64_tr_b16 v[132:133], v14 offset:0
    ds_read_b64_tr_b16 v[134:135], v14 offset:512
    ds_read_b64_tr_b16 v[136:137], v15 offset:0
    ds_read_b64_tr_b16 v[138:139], v15 offset:512
    ds_read_b128 v[120:123], v12 offset:2048
    ds_read_b128 v[124:127], v12 offset:4096
    ds_read_b128 v[128:131], v12 offset:6144
    ds_read_b64_tr_b16 v[140:141], v14 offset:1024
    ds_read_b64_tr_b16 v[142:143], v14 offset:1536
    ds_read_b64_tr_b16 v[144:145], v15 offset:1024
    ds_read_b64_tr_b16 v[146:147], v15 offset:1536
    ds_read_b64_tr_b16 v[148:149], v14 offset:2048
    ds_read_b64_tr_b16 v[150:151], v14 offset:2560
    ds_read_b64_tr_b16 v[152:153], v15 offset:2048
    ds_read_b64_tr_b16 v[154:155], v15 offset:2560
    s_cmp_lg_u32 s3, 0
    s_cbranch_scc1 L_qkv_selfloops
L_qkv_cloop:
    s_waitcnt lgkmcnt(0)
    v_mfma_f32_16x16x32_bf16 v[20:23], v[132:135], v[116:119], v[20:23]
    ds_read_b128 v[156:159], v13 offset:0
    v_mfma_f32_16x16x32_bf16 v[44:47], v[132:135], v[120:123], v[44:47]
    ds_read_b64_tr_b16 v[172:173], v14 offset:12288
    v_mfma_f32_16x16x32_bf16 v[68:71], v[132:135], v[124:127], v[68:71]
    ds_read_b64_tr_b16 v[174:175], v14 offset:12800
    v_mfma_f32_16x16x32_bf16 v[92:95], v[132:135], v[128:131], v[92:95]
    ds_read_b64_tr_b16 v[176:177], v15 offset:12288
    v_mfma_f32_16x16x32_bf16 v[24:27], v[136:139], v[116:119], v[24:27]
    v_mfma_f32_16x16x32_bf16 v[48:51], v[136:139], v[120:123], v[48:51]
    ds_read_b64_tr_b16 v[178:179], v15 offset:12800
    v_mfma_f32_16x16x32_bf16 v[72:75], v[136:139], v[124:127], v[72:75]
    ds_read_b128 v[160:163], v13 offset:2048
    v_mfma_f32_16x16x32_bf16 v[96:99], v[136:139], v[128:131], v[96:99]
    ds_read_b128 v[164:167], v13 offset:4096
    v_mfma_f32_16x16x32_bf16 v[28:31], v[140:143], v[116:119], v[28:31]
    ds_read_b128 v[168:171], v13 offset:6144
    v_mfma_f32_16x16x32_bf16 v[52:55], v[140:143], v[120:123], v[52:55]
    v_mfma_f32_16x16x32_bf16 v[76:79], v[140:143], v[124:127], v[76:79]
    ds_read_b64_tr_b16 v[180:181], v14 offset:13312
    v_mfma_f32_16x16x32_bf16 v[100:103], v[140:143], v[128:131], v[100:103]
    ds_read_b64_tr_b16 v[182:183], v14 offset:13824
    v_mfma_f32_16x16x32_bf16 v[32:35], v[144:147], v[116:119], v[32:35]
    ds_read_b64_tr_b16 v[184:185], v15 offset:13312
    v_mfma_f32_16x16x32_bf16 v[56:59], v[144:147], v[120:123], v[56:59]
    ds_read_b64_tr_b16 v[186:187], v15 offset:13824
    v_mfma_f32_16x16x32_bf16 v[80:83], v[144:147], v[124:127], v[80:83]
    v_mfma_f32_16x16x32_bf16 v[104:107], v[144:147], v[128:131], v[104:107]
    ds_read_b64_tr_b16 v[188:189], v14 offset:14336
    v_mfma_f32_16x16x32_bf16 v[36:39], v[116:119], v[148:151], v[36:39]
    ds_read_b64_tr_b16 v[190:191], v14 offset:14848
    v_mfma_f32_16x16x32_bf16 v[60:63], v[120:123], v[148:151], v[60:63]
    ds_read_b64_tr_b16 v[192:193], v15 offset:14336
    v_mfma_f32_16x16x32_bf16 v[84:87], v[124:127], v[148:151], v[84:87]
    ds_read_b64_tr_b16 v[194:195], v15 offset:14848
    v_mfma_f32_16x16x32_bf16 v[108:111], v[128:131], v[148:151], v[108:111]
    s_add_u32 s45, s45, 40960
    s_cmp_eq_u32 s45, 163840
    s_cselect_b32 s45, 0, s45
    v_add_u32 v12, s45, v7
    v_add_u32 v13, s45, v8
    v_add_u32 v14, s45, v9
    v_add_u32 v15, s45, v10
    v_mfma_f32_16x16x32_bf16 v[40:43], v[116:119], v[152:155], v[40:43]
    v_mfma_f32_16x16x32_bf16 v[64:67], v[120:123], v[152:155], v[64:67]
    v_mfma_f32_16x16x32_bf16 v[88:91], v[124:127], v[152:155], v[88:91]
    v_mfma_f32_16x16x32_bf16 v[112:115], v[128:131], v[152:155], v[112:115]
    s_waitcnt lgkmcnt(0)
    s_barrier
    v_mfma_f32_16x16x32_bf16 v[20:23], v[172:175], v[156:159], v[20:23]
    ds_read_b128 v[116:119], v12 offset:0
    v_mfma_f32_16x16x32_bf16 v[44:47], v[172:175], v[160:163], v[44:47]
    ds_read_b64_tr_b16 v[132:133], v14 offset:0
    v_mfma_f32_16x16x32_bf16 v[68:71], v[172:175], v[164:167], v[68:71]
    ds_read_b64_tr_b16 v[134:135], v14 offset:512
    v_mfma_f32_16x16x32_bf16 v[92:95], v[172:175], v[168:171], v[92:95]
    ds_read_b64_tr_b16 v[136:137], v15 offset:0
    v_mfma_f32_16x16x32_bf16 v[24:27], v[176:179], v[156:159], v[24:27]
    v_mfma_f32_16x16x32_bf16 v[48:51], v[176:179], v[160:163], v[48:51]
    ds_read_b64_tr_b16 v[138:139], v15 offset:512
    v_mfma_f32_16x16x32_bf16 v[72:75], v[176:179], v[164:167], v[72:75]
    ds_read_b128 v[120:123], v12 offset:2048
    v_mfma_f32_16x16x32_bf16 v[96:99], v[176:179], v[168:171], v[96:99]
    ds_read_b128 v[124:127], v12 offset:4096
    v_mfma_f32_16x16x32_bf16 v[28:31], v[180:183], v[156:159], v[28:31]
    ds_read_b128 v[128:131], v12 offset:6144
    v_mfma_f32_16x16x32_bf16 v[52:55], v[180:183], v[160:163], v[52:55]
    v_mfma_f32_16x16x32_bf16 v[76:79], v[180:183], v[164:167], v[76:79]
    ds_read_b64_tr_b16 v[140:141], v14 offset:1024
    v_mfma_f32_16x16x32_bf16 v[100:103], v[180:183], v[168:171], v[100:103]
    ds_read_b64_tr_b16 v[142:143], v14 offset:1536
    v_mfma_f32_16x16x32_bf16 v[32:35], v[184:187], v[156:159], v[32:35]
    ds_read_b64_tr_b16 v[144:145], v15 offset:1024
    v_mfma_f32_16x16x32_bf16 v[56:59], v[184:187], v[160:163], v[56:59]
    ds_read_b64_tr_b16 v[146:147], v15 offset:1536
    v_mfma_f32_16x16x32_bf16 v[80:83], v[184:187], v[164:167], v[80:83]
    v_mfma_f32_16x16x32_bf16 v[104:107], v[184:187], v[168:171], v[104:107]
    ds_read_b64_tr_b16 v[148:149], v14 offset:2048
    v_mfma_f32_16x16x32_bf16 v[36:39], v[156:159], v[188:191], v[36:39]
    ds_read_b64_tr_b16 v[150:151], v14 offset:2560
    v_mfma_f32_16x16x32_bf16 v[60:63], v[160:163], v[188:191], v[60:63]
    ds_read_b64_tr_b16 v[152:153], v15 offset:2048
    v_mfma_f32_16x16x32_bf16 v[84:87], v[164:167], v[188:191], v[84:87]
    ds_read_b64_tr_b16 v[154:155], v15 offset:2560
    v_mfma_f32_16x16x32_bf16 v[108:111], v[168:171], v[188:191], v[108:111]
    s_sub_u32 s46, s46, 1
    s_cmp_lg_u32 s46, 0
    v_mfma_f32_16x16x32_bf16 v[40:43], v[156:159], v[192:195], v[40:43]
    v_mfma_f32_16x16x32_bf16 v[64:67], v[160:163], v[192:195], v[64:67]
    v_mfma_f32_16x16x32_bf16 v[88:91], v[164:167], v[192:195], v[88:91]
    v_mfma_f32_16x16x32_bf16 v[112:115], v[168:171], v[192:195], v[112:115]
    s_cbranch_scc1 L_qkv_cloop
    s_waitcnt lgkmcnt(0)
    v_mfma_f32_16x16x32_bf16 v[20:23], v[132:135], v[116:119], v[20:23]
    ds_read_b128 v[156:159], v13 offset:0
    v_mfma_f32_16x16x32_bf16 v[44:47], v[132:135], v[120:123], v[44:47]
    ds_read_b64_tr_b16 v[172:173], v14 offset:12288
    v_mfma_f32_16x16x32_bf16 v[68:71], v[132:135], v[124:127], v[68:71]
    ds_read_b64_tr_b16 v[174:175], v14 offset:12800
    v_mfma_f32_16x16x32_bf16 v[92:95], v[132:135], v[128:131], v[92:95]
    ds_read_b64_tr_b16 v[176:177], v15 offset:12288
    v_mfma_f32_16x16x32_bf16 v[24:27], v[136:139], v[116:119], v[24:27]
    v_mfma_f32_16x16x32_bf16 v[48:51], v[136:139], v[120:123], v[48:51]
    ds_read_b64_tr_b16 v[178:179], v15 offset:12800
    v_mfma_f32_16x16x32_bf16 v[72:75], v[136:139], v[124:127], v[72:75]
    ds_read_b128 v[160:163], v13 offset:2048
    v_mfma_f32_16x16x32_bf16 v[96:99], v[136:139], v[128:131], v[96:99]
    ds_read_b128 v[164:167], v13 offset:4096
    v_mfma_f32_16x16x32_bf16 v[28:31], v[140:143], v[116:119], v[28:31]
    ds_read_b128 v[168:171], v13 offset:6144
    v_mfma_f32_16x16x32_bf16 v[52:55], v[140:143], v[120:123], v[52:55]
    v_mfma_f32_16x16x32_bf16 v[76:79], v[140:143], v[124:127], v[76:79]
    ds_read_b64_tr_b16 v[180:181], v14 offset:13312
    v_mfma_f32_16x16x32_bf16 v[100:103], v[140:143], v[128:131], v[100:103]
    ds_read_b64_tr_b16 v[182:183], v14 offset:13824
    v_mfma_f32_16x16x32_bf16 v[32:35], v[144:147], v[116:119], v[32:35]
    ds_read_b64_tr_b16 v[184:185], v15 offset:13312
    v_mfma_f32_16x16x32_bf16 v[56:59], v[144:147], v[120:123], v[56:59]
    ds_read_b64_tr_b16 v[186:187], v15 offset:13824
    v_mfma_f32_16x16x32_bf16 v[80:83], v[144:147], v[124:127], v[80:83]
    v_mfma_f32_16x16x32_bf16 v[104:107], v[144:147], v[128:131], v[104:107]
    ds_read_b64_tr_b16 v[188:189], v14 offset:14336
    v_mfma_f32_16x16x32_bf16 v[36:39], v[116:119], v[148:151], v[36:39]
    ds_read_b64_tr_b16 v[190:191], v14 offset:14848
    v_mfma_f32_16x16x32_bf16 v[60:63], v[120:123], v[148:151], v[60:63]
    ds_read_b64_tr_b16 v[192:193], v15 offset:14336
    v_mfma_f32_16x16x32_bf16 v[84:87], v[124:127], v[148:151], v[84:87]
    ds_read_b64_tr_b16 v[194:195], v15 offset:14848
    v_mfma_f32_16x16x32_bf16 v[108:111], v[128:131], v[148:151], v[108:111]
    v_mfma_f32_16x16x32_bf16 v[40:43], v[116:119], v[152:155], v[40:43]
    v_mfma_f32_16x16x32_bf16 v[64:67], v[120:123], v[152:155], v[64:67]
    v_mfma_f32_16x16x32_bf16 v[88:91], v[124:127], v[152:155], v[88:91]
    v_mfma_f32_16x16x32_bf16 v[112:115], v[128:131], v[152:155], v[112:115]
    s_waitcnt lgkmcnt(0)
    v_mfma_f32_16x16x32_bf16 v[20:23], v[172:175], v[156:159], v[20:23]
    v_mfma_f32_16x16x32_bf16 v[44:47], v[172:175], v[160:163], v[44:47]
    v_mfma_f32_16x16x32_bf16 v[68:71], v[172:175], v[164:167], v[68:71]
    v_mfma_f32_16x16x32_bf16 v[92:95], v[172:175], v[168:171], v[92:95]
    v_mfma_f32_16x16x32_bf16 v[24:27], v[176:179], v[156:159], v[24:27]
    v_mfma_f32_16x16x32_bf16 v[48:51], v[176:179], v[160:163], v[48:51]
    v_mfma_f32_16x16x32_bf16 v[72:75], v[176:179], v[164:167], v[72:75]
    v_mfma_f32_16x16x32_bf16 v[96:99], v[176:179], v[168:171], v[96:99]
    v_mfma_f32_16x16x32_bf16 v[28:31], v[180:183], v[156:159], v[28:31]
    v_mfma_f32_16x16x32_bf16 v[52:55], v[180:183], v[160:163], v[52:55]
    v_mfma_f32_16x16x32_bf16 v[76:79], v[180:183], v[164:167], v[76:79]
    v_mfma_f32_16x16x32_bf16 v[100:103], v[180:183], v[168:171], v[100:103]
    v_mfma_f32_16x16x32_bf16 v[32:35], v[184:187], v[156:159], v[32:35]
    v_mfma_f32_16x16x32_bf16 v[56:59], v[184:187], v[160:163], v[56:59]
    v_mfma_f32_16x16x32_bf16 v[80:83], v[184:187], v[164:167], v[80:83]
    v_mfma_f32_16x16x32_bf16 v[104:107], v[184:187], v[168:171], v[104:107]
    v_mfma_f32_16x16x32_bf16 v[36:39], v[156:159], v[188:191], v[36:39]
    v_mfma_f32_16x16x32_bf16 v[60:63], v[160:163], v[188:191], v[60:63]
    v_mfma_f32_16x16x32_bf16 v[84:87], v[164:167], v[188:191], v[84:87]
    v_mfma_f32_16x16x32_bf16 v[108:111], v[168:171], v[188:191], v[108:111]
    v_mfma_f32_16x16x32_bf16 v[40:43], v[156:159], v[192:195], v[40:43]
    v_mfma_f32_16x16x32_bf16 v[64:67], v[160:163], v[192:195], v[64:67]
    v_mfma_f32_16x16x32_bf16 v[88:91], v[164:167], v[192:195], v[88:91]
    v_mfma_f32_16x16x32_bf16 v[112:115], v[168:171], v[192:195], v[112:115]
L_qkv_join:
    s_barrier
    s_lshl_b32 s43, s51, 9
    v_lshl_add_u32 v3, v1, 3, s43
    ds_read_b64 v[116:117], v3 offset:0
    ds_read_b64 v[118:119], v3 offset:128
    ds_read_b64 v[120:121], v3 offset:256
    ds_read_b64 v[122:123], v3 offset:384
    v_lshl_add_u32 v3, v2, 5, s43
    ds_read_b128 v[148:151], v3 offset:0
    ds_read_b128 v[152:155], v3 offset:16
    ds_read_b128 v[156:159], v3 offset:128
    ds_read_b128 v[160:163], v3 offset:144
    ds_read_b128 v[164:167], v3 offset:256
    ds_read_b128 v[168:171], v3 offset:272
    ds_read_b128 v[172:175], v3 offset:384
    ds_read_b128 v[176:179], v3 offset:400
    s_lshl_b32 s43, s52, 7
    v_lshl_add_u32 v3, v2, 4, s43
    ds_read_b128 v[132:135], v3 offset:1024
    ds_read_b128 v[136:139], v3 offset:1088
    ds_read_b128 v[140:143], v3 offset:1280
    ds_read_b128 v[144:147], v3 offset:1344
    v_lshl_add_u32 v3, v1, 2, s43
    ds_read_b32 v180, v3 offset:1536
    ds_read_b32 v181, v3 offset:1600
    v_and_b32 v4, 3, v1
    v_bfe_u32 v5, v1, 2, 1
    v_lshl_or_b32 v4, v5, 3, v4
    v_bfe_u32 v5, v1, 3, 1
    v_lshl_or_b32 v4, v5, 2, v4
    v_lshlrev_b32 v4, 4, v4
    v_and_b32 v5, 1, v2
    v_lshl_or_b32 v4, v5, 10, v4
    v_lshrrev_b32 v5, 1, v2
    v_lshl_or_b32 v4, v5, 9, v4
    s_lshl_b32 s43, s42, 1
    s_add_u32 s43, s43, s52
    s_lshl_b32 s43, s43, 6
    s_lshl_b32 s44, s41, 2
    s_add_u32 s43, s43, s44
    s_lshl_b32 s44, s51, 1
    s_add_u32 s43, s43, s44
    s_lshl_b32 s43, s43, 11
    s_add_u32 s47, s43, 0
    s_lshl_b32 s43, s43, 1
    s_add_u32 s48, s43, 4196352
    s_add_u32 s50, s43, 4200448
    s_add_u32 s49, s43, 4198400
    s_add_u32 s45, s43, 4202496
    s_mov_b32 s44, 0x3e8293ee
    s_waitcnt lgkmcnt(0)
    v_mul_f32 v124, s44, v116
    v_mul_f32 v125, s44, v117
    v_mul_f32 v126, s44, v118
    v_mul_f32 v127, s44, v119
    v_mul_f32 v128, s44, v120
    v_mul_f32 v129, s44, v121
    v_mul_f32 v130, s44, v122
    v_mul_f32 v131, s44, v123
    v_pk_mul_f32 v[192:193], v[124:125], v[132:133] op_sel:[1,0] op_sel_hi:[1,1]
    v_pk_mul_f32 v[194:195], v[124:125], v[134:135] op_sel:[1,0] op_sel_hi:[1,1]
    v_pk_fma_f32 v[20:21], v[20:21], v[124:125], v[192:193] op_sel:[0,0,0] op_sel_hi:[1,0,1]
    v_pk_fma_f32 v[22:23], v[22:23], v[124:125], v[194:195] op_sel:[0,0,0] op_sel_hi:[1,0,1]
    v_cvt_pk_bf16_f32 v184, v20, v21
    v_cvt_pk_bf16_f32 v185, v22, v23
    v_pk_mul_f32 v[192:193], v[124:125], v[136:137] op_sel:[1,0] op_sel_hi:[1,1]
    v_pk_mul_f32 v[194:195], v[124:125], v[138:139] op_sel:[1,0] op_sel_hi:[1,1]
    v_pk_fma_f32 v[24:25], v[24:25], v[124:125], v[192:193] op_sel:[0,0,0] op_sel_hi:[1,0,1]
    v_pk_fma_f32 v[26:27], v[26:27], v[124:125], v[194:195] op_sel:[0,0,0] op_sel_hi:[1,0,1]
    v_cvt_pk_bf16_f32 v186, v24, v25
    v_cvt_pk_bf16_f32 v187, v26, v27
    s_nop 1
    v_permlane16_swap_b32 v184, v186
    v_permlane16_swap_b32 v185, v187
    buffer_store_dwordx4 v[184:187], v4, s[16:19], s47 offen offset:0 sc1
    v_pk_mul_f32 v[192:193], v[126:127], v[132:133] op_sel:[1,0] op_sel_hi:[1,1]
    v_pk_mul_f32 v[194:195], v[126:127], v[134:135] op_sel:[1,0] op_sel_hi:[1,1]
    v_pk_fma_f32 v[44:45], v[44:45], v[126:127], v[192:193] op_sel:[0,0,0] op_sel_hi:[1,0,1]
    v_pk_fma_f32 v[46:47], v[46:47], v[126:127], v[194:195] op_sel:[0,0,0] op_sel_hi:[1,0,1]
    v_cvt_pk_bf16_f32 v188, v44, v45
    v_cvt_pk_bf16_f32 v189, v46, v47
    v_pk_mul_f32 v[192:193], v[126:127], v[136:137] op_sel:[1,0] op_sel_hi:[1,1]
    v_pk_mul_f32 v[194:195], v[126:127], v[138:139] op_sel:[1,0] op_sel_hi:[1,1]
    v_pk_fma_f32 v[48:49], v[48:49], v[126:127], v[192:193] op_sel:[0,0,0] op_sel_hi:[1,0,1]
    v_pk_fma_f32 v[50:51], v[50:51], v[126:127], v[194:195] op_sel:[0,0,0] op_sel_hi:[1,0,1]
    v_cvt_pk_bf16_f32 v190, v48, v49
    v_cvt_pk_bf16_f32 v191, v50, v51
    s_nop 1
    v_permlane16_swap_b32 v188, v190
    v_permlane16_swap_b32 v189, v191
    buffer_store_dwordx4 v[188:191], v4, s[16:19], s47 offen offset:256 sc1
    v_pk_mul_f32 v[192:193], v[128:129], v[132:133] op_sel:[1,0] op_sel_hi:[1,1]
    v_pk_mul_f32 v[194:195], v[128:129], v[134:135] op_sel:[1,0] op_sel_hi:[1,1]
    v_pk_fma_f32 v[68:69], v[68:69], v[128:129], v[192:193] op_sel:[0,0,0] op_sel_hi:[1,0,1]
    v_pk_fma_f32 v[70:71], v[70:71], v[128:129], v[194:195] op_sel:[0,0,0] op_sel_hi:[1,0,1]
    v_cvt_pk_bf16_f32 v184, v68, v69
    v_cvt_pk_bf16_f32 v185, v70, v71
    v_pk_mul_f32 v[192:193], v[128:129], v[136:137] op_sel:[1,0] op_sel_hi:[1,1]
    v_pk_mul_f32 v[194:195], v[128:129], v[138:139] op_sel:[1,0] op_sel_hi:[1,1]
    v_pk_fma_f32 v[72:73], v[72:73], v[128:129], v[192:193] op_sel:[0,0,0] op_sel_hi:[1,0,1]
    v_pk_fma_f32 v[74:75], v[74:75], v[128:129], v[194:195] op_sel:[0,0,0] op_sel_hi:[1,0,1]
    v_cvt_pk_bf16_f32 v186, v72, v73
    v_cvt_pk_bf16_f32 v187, v74, v75
    s_nop 1
    v_permlane16_swap_b32 v184, v186
    v_permlane16_swap_b32 v185, v187
    buffer_store_dwordx4 v[184:187], v4, s[16:19], s47 offen offset:2048 sc1
    v_pk_mul_f32 v[192:193], v[130:131], v[132:133] op_sel:[1,0] op_sel_hi:[1,1]
    v_pk_mul_f32 v[194:195], v[130:131], v[134:135] op_sel:[1,0] op_sel_hi:[1,1]
    v_pk_fma_f32 v[92:93], v[92:93], v[130:131], v[192:193] op_sel:[0,0,0] op_sel_hi:[1,0,1]
    v_pk_fma_f32 v[94:95], v[94:95], v[130:131], v[194:195] op_sel:[0,0,0] op_sel_hi:[1,0,1]
    v_cvt_pk_bf16_f32 v188, v92, v93
    v_cvt_pk_bf16_f32 v189, v94, v95
    v_pk_mul_f32 v[192:193], v[130:131], v[136:137] op_sel:[1,0] op_sel_hi:[1,1]
    v_pk_mul_f32 v[194:195], v[130:131], v[138:139] op_sel:[1,0] op_sel_hi:[1,1]
    v_pk_fma_f32 v[96:97], v[96:97], v[130:131], v[192:193] op_sel:[0,0,0] op_sel_hi:[1,0,1]
    v_pk_fma_f32 v[98:99], v[98:99], v[130:131], v[194:195] op_sel:[0,0,0] op_sel_hi:[1,0,1]
    v_cvt_pk_bf16_f32 v190, v96, v97
    v_cvt_pk_bf16_f32 v191, v98, v99
    s_nop 1
    v_permlane16_swap_b32 v188, v190
    v_permlane16_swap_b32 v189, v191
    buffer_store_dwordx4 v[188:191], v4, s[16:19], s47 offen offset:2304 sc1
    v_pk_mul_f32 v[192:193], v[116:117], v[140:141] op_sel:[1,0] op_sel_hi:[1,1]
    v_pk_mul_f32 v[194:195], v[116:117], v[142:143] op_sel:[1,0] op_sel_hi:[1,1]
    v_pk_fma_f32 v[28:29], v[28:29], v[116:117], v[192:193] op_sel:[0,0,0] op_sel_hi:[1,0,1]
    v_pk_fma_f32 v[30:31], v[30:31], v[116:117], v[194:195] op_sel:[0,0,0] op_sel_hi:[1,0,1]
    v_cvt_pk_bf16_f32 v184, v28, v29
    v_cvt_pk_bf16_f32 v185, v30, v31
    v_pk_mul_f32 v[192:193], v[116:117], v[144:145] op_sel:[1,0] op_sel_hi:[1,1]
    v_pk_mul_f32 v[194:195], v[116:117], v[146:147] op_sel:[1,0] op_sel_hi:[1,1]
    v_pk_fma_f32 v[32:33], v[32:33], v[116:117], v[192:193] op_sel:[0,0,0] op_sel_hi:[1,0,1]
    v_pk_fma_f32 v[34:35], v[34:35], v[116:117], v[194:195] op_sel:[0,0,0] op_sel_hi:[1,0,1]
    v_cvt_pk_bf16_f32 v186, v32, v33
    v_cvt_pk_bf16_f32 v187, v34, v35
    s_nop 1
    v_permlane16_swap_b32 v184, v186
    v_permlane16_swap_b32 v185, v187
    buffer_store_dwordx4 v[184:187], v4, s[16:19], s48 offen offset:0 sc1
    v_pk_mul_f32 v[192:193], v[118:119], v[140:141] op_sel:[1,0] op_sel_hi:[1,1]
    v_pk_mul_f32 v[194:195], v[118:119], v[142:143] op_sel:[1,0] op_sel_hi:[1,1]
    v_pk_fma_f32 v[52:53], v[52:53], v[118:119], v[192:193] op_sel:[0,0,0] op_sel_hi:[1,0,1]
    v_pk_fma_f32 v[54:55], v[54:55], v[118:119], v[194:195] op_sel:[0,0,0] op_sel_hi:[1,0,1]
    v_cvt_pk_bf16_f32 v188, v52, v53
    v_cvt_pk_bf16_f32 v189, v54, v55
    v_pk_mul_f32 v[192:193], v[118:119], v[144:145] op_sel:[1,0] op_sel_hi:[1,1]
    v_pk_mul_f32 v[194:195], v[118:119], v[146:147] op_sel:[1,0] op_sel_hi:[1,1]
    v_pk_fma_f32 v[56:57], v[56:57], v[118:119], v[192:193] op_sel:[0,0,0] op_sel_hi:[1,0,1]
    v_pk_fma_f32 v[58:59], v[58:59], v[118:119], v[194:195] op_sel:[0,0,0] op_sel_hi:[1,0,1]
    v_cvt_pk_bf16_f32 v190, v56, v57
    v_cvt_pk_bf16_f32 v191, v58, v59
    s_nop 1
    v_permlane16_swap_b32 v188, v190
    v_permlane16_swap_b32 v189, v191
    buffer_store_dwordx4 v[188:191], v4, s[16:19], s48 offen offset:256 sc1
    v_pk_mul_f32 v[192:193], v[120:121], v[140:141] op_sel:[1,0] op_sel_hi:[1,1]
    v_pk_mul_f32 v[194:195], v[120:121], v[142:143] op_sel:[1,0] op_sel_hi:[1,1]
    v_pk_fma_f32 v[76:77], v[76:77], v[120:121], v[192:193] op_sel:[0,0,0] op_sel_hi:[1,0,1]
    v_pk_fma_f32 v[78:79], v[78:79], v[120:121], v[194:195] op_sel:[0,0,0] op_sel_hi:[1,0,1]
    v_cvt_pk_bf16_f32 v184, v76, v77
    v_cvt_pk_bf16_f32 v185, v78, v79
    v_pk_mul_f32 v[192:193], v[120:121], v[144:145] op_sel:[1,0] op_sel_hi:[1,1]
    v_pk_mul_f32 v[194:195], v[120:121], v[146:147] op_sel:[1,0] op_sel_hi:[1,1]
    v_pk_fma_f32 v[80:81], v[80:81], v[120:121], v[192:193] op_sel:[0,0,0] op_sel_hi:[1,0,1]
    v_pk_fma_f32 v[82:83], v[82:83], v[120:121], v[194:195] op_sel:[0,0,0] op_sel_hi:[1,0,1]
    v_cvt_pk_bf16_f32 v186, v80, v81
    v_cvt_pk_bf16_f32 v187, v82, v83
    s_nop 1
    v_permlane16_swap_b32 v184, v186
    v_permlane16_swap_b32 v185, v187
    buffer_store_dwordx4 v[184:187], v4, s[16:19], s50 offen offset:0 sc1
    v_pk_mul_f32 v[192:193], v[122:123], v[140:141] op_sel:[1,0] op_sel_hi:[1,1]
    v_pk_mul_f32 v[194:195], v[122:123], v[142:143] op_sel:[1,0] op_sel_hi:[1,1]
    v_pk_fma_f32 v[100:101], v[100:101], v[122:123], v[192:193] op_sel:[0,0,0] op_sel_hi:[1,0,1]
    v_pk_fma_f32 v[102:103], v[102:103], v[122:123], v[194:195] op_sel:[0,0,0] op_sel_hi:[1,0,1]
    v_cvt_pk_bf16_f32 v188, v100, v101
    v_cvt_pk_bf16_f32 v189, v102, v103
    v_pk_mul_f32 v[192:193], v[122:123], v[144:145] op_sel:[1,0] op_sel_hi:[1,1]
    v_pk_mul_f32 v[194:195], v[122:123], v[146:147] op_sel:[1,0] op_sel_hi:[1,1]
    v_pk_fma_f32 v[104:105], v[104:105], v[122:123], v[192:193] op_sel:[0,0,0] op_sel_hi:[1,0,1]
    v_pk_fma_f32 v[106:107], v[106:107], v[122:123], v[194:195] op_sel:[0,0,0] op_sel_hi:[1,0,1]
    v_cvt_pk_bf16_f32 v190, v104, v105
    v_cvt_pk_bf16_f32 v191, v106, v107
    s_nop 1
    v_permlane16_swap_b32 v188, v190
    v_permlane16_swap_b32 v189, v191
    buffer_store_dwordx4 v[188:191], v4, s[16:19], s50 offen offset:256 sc1
    v_mul_f32 v5, v149, v180
    v_fma_f32 v36, v36, v148, v5
    v_mul_f32 v5, v151, v180
    v_fma_f32 v37, v37, v150, v5
    v_mul_f32 v5, v153, v180
    v_fma_f32 v38, v38, v152, v5
    v_mul_f32 v5, v155, v180
    v_fma_f32 v39, v39, v154, v5
    v_cvt_pk_bf16_f32 v184, v36, v37
    v_cvt_pk_bf16_f32 v185, v38, v39
    v_mul_f32 v5, v157, v180
    v_fma_f32 v60, v60, v156, v5
    v_mul_f32 v5, v159, v180
    v_fma_f32 v61, v61, v158, v5
    v_mul_f32 v5, v161, v180
    v_fma_f32 v62, v62, v160, v5
    v_mul_f32 v5, v163, v180
    v_fma_f32 v63, v63, v162, v5
    v_cvt_pk_bf16_f32 v186, v60, v61
    v_cvt_pk_bf16_f32 v187, v62, v63
    s_nop 1
    v_permlane16_swap_b32 v184, v186
    v_permlane16_swap_b32 v185, v187
    buffer_store_dwordx4 v[184:187], v4, s[16:19], s49 offen offset:0 sc1
    v_mul_f32 v5, v149, v181
    v_fma_f32 v40, v40, v148, v5
    v_mul_f32 v5, v151, v181
    v_fma_f32 v41, v41, v150, v5
    v_mul_f32 v5, v153, v181
    v_fma_f32 v42, v42, v152, v5
    v_mul_f32 v5, v155, v181
    v_fma_f32 v43, v43, v154, v5
    v_cvt_pk_bf16_f32 v188, v40, v41
    v_cvt_pk_bf16_f32 v189, v42, v43
    v_mul_f32 v5, v157, v181
    v_fma_f32 v64, v64, v156, v5
    v_mul_f32 v5, v159, v181
    v_fma_f32 v65, v65, v158, v5
    v_mul_f32 v5, v161, v181
    v_fma_f32 v66, v66, v160, v5
    v_mul_f32 v5, v163, v181
    v_fma_f32 v67, v67, v162, v5
    v_cvt_pk_bf16_f32 v190, v64, v65
    v_cvt_pk_bf16_f32 v191, v66, v67
    s_nop 1
    v_permlane16_swap_b32 v188, v190
    v_permlane16_swap_b32 v189, v191
    buffer_store_dwordx4 v[188:191], v4, s[16:19], s49 offen offset:256 sc1
    v_mul_f32 v5, v165, v180
    v_fma_f32 v84, v84, v164, v5
    v_mul_f32 v5, v167, v180
    v_fma_f32 v85, v85, v166, v5
    v_mul_f32 v5, v169, v180
    v_fma_f32 v86, v86, v168, v5
    v_mul_f32 v5, v171, v180
    v_fma_f32 v87, v87, v170, v5
    v_cvt_pk_bf16_f32 v184, v84, v85
    v_cvt_pk_bf16_f32 v185, v86, v87
    v_mul_f32 v5, v173, v180
    v_fma_f32 v108, v108, v172, v5
    v_mul_f32 v5, v175, v180
    v_fma_f32 v109, v109, v174, v5
    v_mul_f32 v5, v177, v180
    v_fma_f32 v110, v110, v176, v5
    v_mul_f32 v5, v179, v180
    v_fma_f32 v111, v111, v178, v5
    v_cvt_pk_bf16_f32 v186, v108, v109
    v_cvt_pk_bf16_f32 v187, v110, v111
    s_nop 1
    v_permlane16_swap_b32 v184, v186
    v_permlane16_swap_b32 v185, v187
    buffer_store_dwordx4 v[184:187], v4, s[16:19], s45 offen offset:0 sc1
    v_mul_f32 v5, v165, v181
    v_fma_f32 v88, v88, v164, v5
    v_mul_f32 v5, v167, v181
    v_fma_f32 v89, v89, v166, v5
    v_mul_f32 v5, v169, v181
    v_fma_f32 v90, v90, v168, v5
    v_mul_f32 v5, v171, v181
    v_fma_f32 v91, v91, v170, v5
    v_cvt_pk_bf16_f32 v188, v88, v89
    v_cvt_pk_bf16_f32 v189, v90, v91
    v_mul_f32 v5, v173, v181
    v_fma_f32 v112, v112, v172, v5
    v_mul_f32 v5, v175, v181
    v_fma_f32 v113, v113, v174, v5
    v_mul_f32 v5, v177, v181
    v_fma_f32 v114, v114, v176, v5
    v_mul_f32 v5, v179, v181
    v_fma_f32 v115, v115, v178, v5
    v_cvt_pk_bf16_f32 v190, v112, v113
    v_cvt_pk_bf16_f32 v191, v114, v115
    s_nop 1
    v_permlane16_swap_b32 v188, v190
    v_permlane16_swap_b32 v189, v191
    buffer_store_dwordx4 v[188:191], v4, s[16:19], s45 offen offset:256 sc1
    s_branch L_sync_qkv
L_qkv_ool1:
    s_load_dwordx2 s[64:65], s[0:1], 72
    s_memrealtime s[62:63]
    s_waitcnt lgkmcnt(0)
    s_or_b32 s62, s62, 1
    v_mov_b32 v3, s62
    v_mov_b32 v4, 0
    s_mov_b32 s68, s64
    s_and_b32 s69, s65, 0xffff
    s_mov_b32 s70, 256
    s_mov_b32 s71, 131072
    s_mov_b64 exec, 1
    buffer_store_dword v3, v4, s[68:71], 0 offen sc1
    s_mov_b64 exec, -1
    s_branch L_qkv_back2
L_qkv_selfloops:
    s_xor_b32 s43, s51, s52
    s_cmp_lg_u32 s43, 0
    s_cbranch_scc1 L_qkv_slb9
L_qkv_cloopa:
    s_waitcnt lgkmcnt(0)
    v_mfma_f32_16x16x32_bf16 v[20:23], v[132:135], v[116:119], v[20:23]
    ds_read_b128 v[156:159], v13 offset:0
    v_mfma_f32_16x16x32_bf16 v[44:47], v[132:135], v[120:123], v[44:47]
    ds_read_b64_tr_b16 v[172:173], v14 offset:12288
    v_mfma_f32_16x16x32_bf16 v[68:71], v[132:135], v[124:127], v[68:71]
    v_mfma_f32_16x16x32_bf16 v[92:95], v[132:135], v[128:131], v[92:95]
    ds_read_b64_tr_b16 v[174:175], v14 offset:12800
    v_mfma_f32_16x16x32_bf16 v[24:27], v[136:139], v[116:119], v[24:27]
    ds_read_b64_tr_b16 v[176:177], v15 offset:12288
    v_mfma_f32_16x16x32_bf16 v[48:51], v[136:139], v[120:123], v[48:51]
    v_mfma_f32_16x16x32_bf16 v[72:75], v[136:139], v[124:127], v[72:75]
    ds_read_b64_tr_b16 v[178:179], v15 offset:12800
    v_mfma_f32_16x16x32_bf16 v[96:99], v[136:139], v[128:131], v[96:99]
    v_mfma_f32_16x16x32_bf16 v[28:31], v[140:143], v[116:119], v[28:31]
    ds_read_b128 v[160:163], v13 offset:2048
    v_mfma_f32_16x16x32_bf16 v[52:55], v[140:143], v[120:123], v[52:55]
    ds_read_b128 v[164:167], v13 offset:4096
    v_mfma_f32_16x16x32_bf16 v[76:79], v[140:143], v[124:127], v[76:79]
    v_mfma_f32_16x16x32_bf16 v[100:103], v[140:143], v[128:131], v[100:103]
    ds_read_b128 v[168:171], v13 offset:6144
    v_mfma_f32_16x16x32_bf16 v[32:35], v[144:147], v[116:119], v[32:35]
    v_mfma_f32_16x16x32_bf16 v[56:59], v[144:147], v[120:123], v[56:59]
    ds_read_b64_tr_b16 v[180:181], v14 offset:13312
    v_mfma_f32_16x16x32_bf16 v[80:83], v[144:147], v[124:127], v[80:83]
    ds_read_b64_tr_b16 v[182:183], v14 offset:13824
    v_mfma_f32_16x16x32_bf16 v[104:107], v[144:147], v[128:131], v[104:107]
    v_mfma_f32_16x16x32_bf16 v[36:39], v[116:119], v[148:151], v[36:39]
    ds_read_b64_tr_b16 v[184:185], v15 offset:13312
    v_mfma_f32_16x16x32_bf16 v[60:63], v[120:123], v[148:151], v[60:63]
    ds_read_b64_tr_b16 v[186:187], v15 offset:13824
    v_mfma_f32_16x16x32_bf16 v[84:87], v[124:127], v[148:151], v[84:87]
    v_mfma_f32_16x16x32_bf16 v[108:111], v[128:131], v[148:151], v[108:111]
    ds_read_b64_tr_b16 v[188:189], v14 offset:14336
    v_mfma_f32_16x16x32_bf16 v[40:43], v[116:119], v[152:155], v[40:43]
    v_mfma_f32_16x16x32_bf16 v[64:67], v[120:123], v[152:155], v[64:67]
    ds_read_b64_tr_b16 v[190:191], v14 offset:14848
    v_mfma_f32_16x16x32_bf16 v[88:91], v[124:127], v[152:155], v[88:91]
    ds_read_b64_tr_b16 v[192:193], v15 offset:14336
    v_mfma_f32_16x16x32_bf16 v[112:115], v[128:131], v[152:155], v[112:115]
    v_mfma_f32_16x16x32_bf16 v[196:199], v[132:135], v[252:255], v[196:199]
    ds_read_b64_tr_b16 v[194:195], v15 offset:14848
    v_mfma_f32_16x16x32_bf16 v[200:203], v[136:139], v[252:255], v[200:203]
    s_add_u32 s45, s45, 40960
    s_cmp_eq_u32 s45, 163840
    s_cselect_b32 s45, 0, s45
    v_add_u32 v12, s45, v7
    v_add_u32 v13, s45, v8
    v_add_u32 v14, s45, v9
    v_add_u32 v15, s45, v10
    v_mfma_f32_16x16x32_bf16 v[204:207], v[140:143], v[252:255], v[204:207]
    v_mfma_f32_16x16x32_bf16 v[208:211], v[144:147], v[252:255], v[208:211]
    v_mfma_f32_16x16x32_bf16 v[212:215], v[148:151], v[252:255], v[212:215]
    v_mfma_f32_16x16x32_bf16 v[216:219], v[152:155], v[252:255], v[216:219]
    s_waitcnt lgkmcnt(0)
    s_barrier
    v_mfma_f32_16x16x32_bf16 v[20:23], v[172:175], v[156:159], v[20:23]
    ds_read_b128 v[116:119], v12 offset:0
    v_mfma_f32_16x16x32_bf16 v[44:47], v[172:175], v[160:163], v[44:47]
    ds_read_b64_tr_b16 v[132:133], v14 offset:0
    v_mfma_f32_16x16x32_bf16 v[68:71], v[172:175], v[164:167], v[68:71]
    v_mfma_f32_16x16x32_bf16 v[92:95], v[172:175], v[168:171], v[92:95]
    ds_read_b64_tr_b16 v[134:135], v14 offset:512
    v_mfma_f32_16x16x32_bf16 v[24:27], v[176:179], v[156:159], v[24:27]
    v_mfma_f32_16x16x32_bf16 v[48:51], v[176:179], v[160:163], v[48:51]
    ds_read_b64_tr_b16 v[136:137], v15 offset:0
    v_mfma_f32_16x16x32_bf16 v[72:75], v[176:179], v[164:167], v[72:75]
    v_mfma_f32_16x16x32_bf16 v[96:99], v[176:179], v[168:171], v[96:99]
    ds_read_b64_tr_b16 v[138:139], v15 offset:512
    v_mfma_f32_16x16x32_bf16 v[28:31], v[180:183], v[156:159], v[28:31]
    ds_read_b128 v[120:123], v12 offset:2048
    v_mfma_f32_16x16x32_bf16 v[52:55], v[180:183], v[160:163], v[52:55]
    v_mfma_f32_16x16x32_bf16 v[76:79], v[180:183], v[164:167], v[76:79]
    ds_read_b128 v[124:127], v12 offset:4096
    v_mfma_f32_16x16x32_bf16 v[100:103], v[180:183], v[168:171], v[100:103]
    v_mfma_f32_16x16x32_bf16 v[32:35], v[184:187], v[156:159], v[32:35]
    ds_read_b128 v[128:131], v12 offset:6144
    v_mfma_f32_16x16x32_bf16 v[56:59], v[184:187], v[160:163], v[56:59]
    v_mfma_f32_16x16x32_bf16 v[80:83], v[184:187], v[164:167], v[80:83]
    ds_read_b64_tr_b16 v[140:141], v14 offset:1024
    v_mfma_f32_16x16x32_bf16 v[104:107], v[184:187], v[168:171], v[104:107]
    ds_read_b64_tr_b16 v[142:143], v14 offset:1536
    v_mfma_f32_16x16x32_bf16 v[36:39], v[156:159], v[188:191], v[36:39]
    v_mfma_f32_16x16x32_bf16 v[60:63], v[160:163], v[188:191], v[60:63]
    ds_read_b64_tr_b16 v[144:145], v15 offset:1024
    v_mfma_f32_16x16x32_bf16 v[84:87], v[164:167], v[188:191], v[84:87]
    v_mfma_f32_16x16x32_bf16 v[108:111], v[168:171], v[188:191], v[108:111]
    ds_read_b64_tr_b16 v[146:147], v15 offset:1536
    v_mfma_f32_16x16x32_bf16 v[40:43], v[156:159], v[192:195], v[40:43]
    v_mfma_f32_16x16x32_bf16 v[64:67], v[160:163], v[192:195], v[64:67]
    ds_read_b64_tr_b16 v[148:149], v14 offset:2048
    v_mfma_f32_16x16x32_bf16 v[88:91], v[164:167], v[192:195], v[88:91]
    ds_read_b64_tr_b16 v[150:151], v14 offset:2560
    v_mfma_f32_16x16x32_bf16 v[112:115], v[168:171], v[192:195], v[112:115]
    v_mfma_f32_16x16x32_bf16 v[220:223], v[252:255], v[156:159], v[220:223]
    ds_read_b64_tr_b16 v[152:153], v15 offset:2048
    v_mfma_f32_16x16x32_bf16 v[236:239], v[156:159], v[156:159], v[236:239]
    v_mfma_f32_16x16x32_bf16 v[224:227], v[252:255], v[160:163], v[224:227]
    ds_read_b64_tr_b16 v[154:155], v15 offset:2560
    v_mfma_f32_16x16x32_bf16 v[240:243], v[160:163], v[160:163], v[240:243]
    s_sub_u32 s46, s46, 1
    s_cmp_lg_u32 s46, 0
    v_mfma_f32_16x16x32_bf16 v[228:231], v[252:255], v[164:167], v[228:231]
    v_mfma_f32_16x16x32_bf16 v[244:247], v[164:167], v[164:167], v[244:247]
    v_mfma_f32_16x16x32_bf16 v[232:235], v[252:255], v[168:171], v[232:235]
    v_mfma_f32_16x16x32_bf16 v[248:251], v[168:171], v[168:171], v[248:251]
    s_cbranch_scc1 L_qkv_cloopa
    s_waitcnt lgkmcnt(0)
    v_mfma_f32_16x16x32_bf16 v[20:23], v[132:135], v[116:119], v[20:23]
    ds_read_b128 v[156:159], v13 offset:0
    v_mfma_f32_16x16x32_bf16 v[44:47], v[132:135], v[120:123], v[44:47]
    ds_read_b64_tr_b16 v[172:173], v14 offset:12288
    v_mfma_f32_16x16x32_bf16 v[68:71], v[132:135], v[124:127], v[68:71]
    v_mfma_f32_16x16x32_bf16 v[92:95], v[132:135], v[128:131], v[92:95]
    ds_read_b64_tr_b16 v[174:175], v14 offset:12800
    v_mfma_f32_16x16x32_bf16 v[24:27], v[136:139], v[116:119], v[24:27]
    ds_read_b64_tr_b16 v[176:177], v15 offset:12288
    v_mfma_f32_16x16x32_bf16 v[48:51], v[136:139], v[120:123], v[48:51]
    v_mfma_f32_16x16x32_bf16 v[72:75], v[136:139], v[124:127], v[72:75]
    ds_read_b64_tr_b16 v[178:179], v15 offset:12800
    v_mfma_f32_16x16x32_bf16 v[96:99], v[136:139], v[128:131], v[96:99]
    v_mfma_f32_16x16x32_bf16 v[28:31], v[140:143], v[116:119], v[28:31]
    ds_read_b128 v[160:163], v13 offset:2048
    v_mfma_f32_16x16x32_bf16 v[52:55], v[140:143], v[120:123], v[52:55]
    ds_read_b128 v[164:167], v13 offset:4096
    v_mfma_f32_16x16x32_bf16 v[76:79], v[140:143], v[124:127], v[76:79]
    v_mfma_f32_16x16x32_bf16 v[100:103], v[140:143], v[128:131], v[100:103]
    ds_read_b128 v[168:171], v13 offset:6144
    v_mfma_f32_16x16x32_bf16 v[32:35], v[144:147], v[116:119], v[32:35]
    v_mfma_f32_16x16x32_bf16 v[56:59], v[144:147], v[120:123], v[56:59]
    ds_read_b64_tr_b16 v[180:181], v14 offset:13312
    v_mfma_f32_16x16x32_bf16 v[80:83], v[144:147], v[124:127], v[80:83]
    ds_read_b64_tr_b16 v[182:183], v14 offset:13824
    v_mfma_f32_16x16x32_bf16 v[104:107], v[144:147], v[128:131], v[104:107]
    v_mfma_f32_16x16x32_bf16 v[36:39], v[116:119], v[148:151], v[36:39]
    ds_read_b64_tr_b16 v[184:185], v15 offset:13312
    v_mfma_f32_16x16x32_bf16 v[60:63], v[120:123], v[148:151], v[60:63]
    ds_read_b64_tr_b16 v[186:187], v15 offset:13824
    v_mfma_f32_16x16x32_bf16 v[84:87], v[124:127], v[148:151], v[84:87]
    v_mfma_f32_16x16x32_bf16 v[108:111], v[128:131], v[148:151], v[108:111]
    ds_read_b64_tr_b16 v[188:189], v14 offset:14336
    v_mfma_f32_16x16x32_bf16 v[40:43], v[116:119], v[152:155], v[40:43]
    v_mfma_f32_16x16x32_bf16 v[64:67], v[120:123], v[152:155], v[64:67]
    ds_read_b64_tr_b16 v[190:191], v14 offset:14848
    v_mfma_f32_16x16x32_bf16 v[88:91], v[124:127], v[152:155], v[88:91]
    ds_read_b64_tr_b16 v[192:193], v15 offset:14336
    v_mfma_f32_16x16x32_bf16 v[112:115], v[128:131], v[152:155], v[112:115]
    v_mfma_f32_16x16x32_bf16 v[196:199], v[132:135], v[252:255], v[196:199]
    ds_read_b64_tr_b16 v[194:195], v15 offset:14848
    v_mfma_f32_16x16x32_bf16 v[200:203], v[136:139], v[252:255], v[200:203]
    v_mfma_f32_16x16x32_bf16 v[204:207], v[140:143], v[252:255], v[204:207]
    v_mfma_f32_16x16x32_bf16 v[208:211], v[144:147], v[252:255], v[208:211]
    v_mfma_f32_16x16x32_bf16 v[212:215], v[148:151], v[252:255], v[212:215]
    v_mfma_f32_16x16x32_bf16 v[216:219], v[152:155], v[252:255], v[216:219]
    s_waitcnt lgkmcnt(0)
    v_mfma_f32_16x16x32_bf16 v[220:223], v[252:255], v[156:159], v[220:223]
    v_mfma_f32_16x16x32_bf16 v[236:239], v[156:159], v[156:159], v[236:239]
    v_mfma_f32_16x16x32_bf16 v[224:227], v[252:255], v[160:163], v[224:227]
    v_mfma_f32_16x16x32_bf16 v[240:243], v[160:163], v[160:163], v[240:243]
    v_mfma_f32_16x16x32_bf16 v[228:231], v[252:255], v[164:167], v[228:231]
    v_mfma_f32_16x16x32_bf16 v[244:247], v[164:167], v[164:167], v[244:247]
    v_mfma_f32_16x16x32_bf16 v[232:235], v[252:255], v[168:171], v[232:235]
    v_mfma_f32_16x16x32_bf16 v[248:251], v[168:171], v[168:171], v[248:251]
    v_mfma_f32_16x16x32_bf16 v[20:23], v[172:175], v[156:159], v[20:23]
    v_mfma_f32_16x16x32_bf16 v[44:47], v[172:175], v[160:163], v[44:47]
    v_mfma_f32_16x16x32_bf16 v[68:71], v[172:175], v[164:167], v[68:71]
    v_mfma_f32_16x16x32_bf16 v[92:95], v[172:175], v[168:171], v[92:95]
    v_mfma_f32_16x16x32_bf16 v[24:27], v[176:179], v[156:159], v[24:27]
    v_mfma_f32_16x16x32_bf16 v[48:51], v[176:179], v[160:163], v[48:51]
    v_mfma_f32_16x16x32_bf16 v[72:75], v[176:179], v[164:167], v[72:75]
    v_mfma_f32_16x16x32_bf16 v[96:99], v[176:179], v[168:171], v[96:99]
    v_mfma_f32_16x16x32_bf16 v[28:31], v[180:183], v[156:159], v[28:31]
    v_mfma_f32_16x16x32_bf16 v[52:55], v[180:183], v[160:163], v[52:55]
    v_mfma_f32_16x16x32_bf16 v[76:79], v[180:183], v[164:167], v[76:79]
    v_mfma_f32_16x16x32_bf16 v[100:103], v[180:183], v[168:171], v[100:103]
    v_mfma_f32_16x16x32_bf16 v[32:35], v[184:187], v[156:159], v[32:35]
    v_mfma_f32_16x16x32_bf16 v[56:59], v[184:187], v[160:163], v[56:59]
    v_mfma_f32_16x16x32_bf16 v[80:83], v[184:187], v[164:167], v[80:83]
    v_mfma_f32_16x16x32_bf16 v[104:107], v[184:187], v[168:171], v[104:107]
    v_mfma_f32_16x16x32_bf16 v[36:39], v[156:159], v[188:191], v[36:39]
    v_mfma_f32_16x16x32_bf16 v[60:63], v[160:163], v[188:191], v[60:63]
    v_mfma_f32_16x16x32_bf16 v[84:87], v[164:167], v[188:191], v[84:87]
    v_mfma_f32_16x16x32_bf16 v[108:111], v[168:171], v[188:191], v[108:111]
    v_mfma_f32_16x16x32_bf16 v[40:43], v[156:159], v[192:195], v[40:43]
    v_mfma_f32_16x16x32_bf16 v[64:67], v[160:163], v[192:195], v[64:67]
    v_mfma_f32_16x16x32_bf16 v[88:91], v[164:167], v[192:195], v[88:91]
    v_mfma_f32_16x16x32_bf16 v[112:115], v[168:171], v[192:195], v[112:115]
    s_branch L_qkv_sle10
L_qkv_slb9:
L_qkv_cloopb:
    s_waitcnt lgkmcnt(0)
    v_mfma_f32_16x16x32_bf16 v[20:23], v[132:135], v[116:119], v[20:23]
    ds_read_b128 v[156:159], v13 offset:0
    v_mfma_f32_16x16x32_bf16 v[44:47], v[132:135], v[120:123], v[44:47]
    ds_read_b64_tr_b16 v[172:173], v14 offset:12288
    v_mfma_f32_16x16x32_bf16 v[68:71], v[132:135], v[124:127], v[68:71]
    v_mfma_f32_16x16x32_bf16 v[92:95], v[132:135], v[128:131], v[92:95]
    ds_read_b64_tr_b16 v[174:175], v14 offset:12800
    v_mfma_f32_16x16x32_bf16 v[24:27], v[136:139], v[116:119], v[24:27]
    v_mfma_f32_16x16x32_bf16 v[48:51], v[136:139], v[120:123], v[48:51]
    ds_read_b64_tr_b16 v[176:177], v15 offset:12288
    v_mfma_f32_16x16x32_bf16 v[72:75], v[136:139], v[124:127], v[72:75]
    v_mfma_f32_16x16x32_bf16 v[96:99], v[136:139], v[128:131], v[96:99]
    ds_read_b64_tr_b16 v[178:179], v15 offset:12800
    v_mfma_f32_16x16x32_bf16 v[28:31], v[140:143], v[116:119], v[28:31]
    ds_read_b128 v[160:163], v13 offset:2048
    v_mfma_f32_16x16x32_bf16 v[52:55], v[140:143], v[120:123], v[52:55]
    v_mfma_f32_16x16x32_bf16 v[76:79], v[140:143], v[124:127], v[76:79]
    ds_read_b128 v[164:167], v13 offset:4096
    v_mfma_f32_16x16x32_bf16 v[100:103], v[140:143], v[128:131], v[100:103]
    v_mfma_f32_16x16x32_bf16 v[32:35], v[144:147], v[116:119], v[32:35]
    ds_read_b128 v[168:171], v13 offset:6144
    v_mfma_f32_16x16x32_bf16 v[56:59], v[144:147], v[120:123], v[56:59]
    v_mfma_f32_16x16x32_bf16 v[80:83], v[144:147], v[124:127], v[80:83]
    ds_read_b64_tr_b16 v[180:181], v14 offset:13312
    v_mfma_f32_16x16x32_bf16 v[104:107], v[144:147], v[128:131], v[104:107]
    ds_read_b64_tr_b16 v[182:183], v14 offset:13824
    v_mfma_f32_16x16x32_bf16 v[36:39], v[116:119], v[148:151], v[36:39]
    v_mfma_f32_16x16x32_bf16 v[60:63], v[120:123], v[148:151], v[60:63]
    ds_read_b64_tr_b16 v[184:185], v15 offset:13312
    v_mfma_f32_16x16x32_bf16 v[84:87], v[124:127], v[148:151], v[84:87]
    v_mfma_f32_16x16x32_bf16 v[108:111], v[128:131], v[148:151], v[108:111]
    ds_read_b64_tr_b16 v[186:187], v15 offset:13824
    v_mfma_f32_16x16x32_bf16 v[40:43], v[116:119], v[152:155], v[40:43]
    v_mfma_f32_16x16x32_bf16 v[64:67], v[120:123], v[152:155], v[64:67]
    ds_read_b64_tr_b16 v[188:189], v14 offset:14336
    v_mfma_f32_16x16x32_bf16 v[88:91], v[124:127], v[152:155], v[88:91]
    ds_read_b64_tr_b16 v[190:191], v14 offset:14848
    v_mfma_f32_16x16x32_bf16 v[112:115], v[128:131], v[152:155], v[112:115]
    v_mfma_f32_16x16x32_bf16 v[220:223], v[252:255], v[116:119], v[220:223]
    ds_read_b64_tr_b16 v[192:193], v15 offset:14336
    v_mfma_f32_16x16x32_bf16 v[236:239], v[116:119], v[116:119], v[236:239]
    v_mfma_f32_16x16x32_bf16 v[224:227], v[252:255], v[120:123], v[224:227]
    ds_read_b64_tr_b16 v[194:195], v15 offset:14848
    v_mfma_f32_16x16x32_bf16 v[240:243], v[120:123], v[120:123], v[240:243]
    s_add_u32 s45, s45, 40960
    s_cmp_eq_u32 s45, 163840
    s_cselect_b32 s45, 0, s45
    v_add_u32 v12, s45, v7
    v_add_u32 v13, s45, v8
    v_add_u32 v14, s45, v9
    v_add_u32 v15, s45, v10
    v_mfma_f32_16x16x32_bf16 v[228:231], v[252:255], v[124:127], v[228:231]
    v_mfma_f32_16x16x32_bf16 v[244:247], v[124:127], v[124:127], v[244:247]
    v_mfma_f32_16x16x32_bf16 v[232:235], v[252:255], v[128:131], v[232:235]
    v_mfma_f32_16x16x32_bf16 v[248:251], v[128:131], v[128:131], v[248:251]
    s_waitcnt lgkmcnt(0)
    s_barrier
    v_mfma_f32_16x16x32_bf16 v[20:23], v[172:175], v[156:159], v[20:23]
    ds_read_b128 v[116:119], v12 offset:0
    v_mfma_f32_16x16x32_bf16 v[44:47], v[172:175], v[160:163], v[44:47]
    ds_read_b64_tr_b16 v[132:133], v14 offset:0
    v_mfma_f32_16x16x32_bf16 v[68:71], v[172:175], v[164:167], v[68:71]
    v_mfma_f32_16x16x32_bf16 v[92:95], v[172:175], v[168:171], v[92:95]
    ds_read_b64_tr_b16 v[134:135], v14 offset:512
    v_mfma_f32_16x16x32_bf16 v[24:27], v[176:179], v[156:159], v[24:27]
    ds_read_b64_tr_b16 v[136:137], v15 offset:0
    v_mfma_f32_16x16x32_bf16 v[48:51], v[176:179], v[160:163], v[48:51]
    v_mfma_f32_16x16x32_bf16 v[72:75], v[176:179], v[164:167], v[72:75]
    ds_read_b64_tr_b16 v[138:139], v15 offset:512
    v_mfma_f32_16x16x32_bf16 v[96:99], v[176:179], v[168:171], v[96:99]
    v_mfma_f32_16x16x32_bf16 v[28:31], v[180:183], v[156:159], v[28:31]
    ds_read_b128 v[120:123], v12 offset:2048
    v_mfma_f32_16x16x32_bf16 v[52:55], v[180:183], v[160:163], v[52:55]
    ds_read_b128 v[124:127], v12 offset:4096
    v_mfma_f32_16x16x32_bf16 v[76:79], v[180:183], v[164:167], v[76:79]
    v_mfma_f32_16x16x32_bf16 v[100:103], v[180:183], v[168:171], v[100:103]
    ds_read_b128 v[128:131], v12 offset:6144
    v_mfma_f32_16x16x32_bf16 v[32:35], v[184:187], v[156:159], v[32:35]
    v_mfma_f32_16x16x32_bf16 v[56:59], v[184:187], v[160:163], v[56:59]
    ds_read_b64_tr_b16 v[140:141], v14 offset:1024
    v_mfma_f32_16x16x32_bf16 v[80:83], v[184:187], v[164:167], v[80:83]
    ds_read_b64_tr_b16 v[142:143], v14 offset:1536
    v_mfma_f32_16x16x32_bf16 v[104:107], v[184:187], v[168:171], v[104:107]
    v_mfma_f32_16x16x32_bf16 v[36:39], v[156:159], v[188:191], v[36:39]
    ds_read_b64_tr_b16 v[144:145], v15 offset:1024
    v_mfma_f32_16x16x32_bf16 v[60:63], v[160:163], v[188:191], v[60:63]
    ds_read_b64_tr_b16 v[146:147], v15 offset:1536
    v_mfma_f32_16x16x32_bf16 v[84:87], v[164:167], v[188:191], v[84:87]
    v_mfma_f32_16x16x32_bf16 v[108:111], v[168:171], v[188:191], v[108:111]
    ds_read_b64_tr_b16 v[148:149], v14 offset:2048
    v_mfma_f32_16x16x32_bf16 v[40:43], v[156:159], v[192:195], v[40:43]
    v_mfma_f32_16x16x32_bf16 v[64:67], v[160:163], v[192:195], v[64:67]
    ds_read_b64_tr_b16 v[150:151], v14 offset:2560
    v_mfma_f32_16x16x32_bf16 v[88:91], v[164:167], v[192:195], v[88:91]
    ds_read_b64_tr_b16 v[152:153], v15 offset:2048
    v_mfma_f32_16x16x32_bf16 v[112:115], v[168:171], v[192:195], v[112:115]
    v_mfma_f32_16x16x32_bf16 v[196:199], v[172:175], v[252:255], v[196:199]
    ds_read_b64_tr_b16 v[154:155], v15 offset:2560
    v_mfma_f32_16x16x32_bf16 v[200:203], v[176:179], v[252:255], v[200:203]
    s_sub_u32 s46, s46, 1
    s_cmp_lg_u32 s46, 0
    v_mfma_f32_16x16x32_bf16 v[204:207], v[180:183], v[252:255], v[204:207]
    v_mfma_f32_16x16x32_bf16 v[208:211], v[184:187], v[252:255], v[208:211]
    v_mfma_f32_16x16x32_bf16 v[212:215], v[188:191], v[252:255], v[212:215]
    v_mfma_f32_16x16x32_bf16 v[216:219], v[192:195], v[252:255], v[216:219]
    s_cbranch_scc1 L_qkv_cloopb
    s_waitcnt lgkmcnt(0)
    v_mfma_f32_16x16x32_bf16 v[20:23], v[132:135], v[116:119], v[20:23]
    ds_read_b128 v[156:159], v13 offset:0
    v_mfma_f32_16x16x32_bf16 v[44:47], v[132:135], v[120:123], v[44:47]
    ds_read_b64_tr_b16 v[172:173], v14 offset:12288
    v_mfma_f32_16x16x32_bf16 v[68:71], v[132:135], v[124:127], v[68:71]
    v_mfma_f32_16x16x32_bf16 v[92:95], v[132:135], v[128:131], v[92:95]
    ds_read_b64_tr_b16 v[174:175], v14 offset:12800
    v_mfma_f32_16x16x32_bf16 v[24:27], v[136:139], v[116:119], v[24:27]
    v_mfma_f32_16x16x32_bf16 v[48:51], v[136:139], v[120:123], v[48:51]
    ds_read_b64_tr_b16 v[176:177], v15 offset:12288
    v_mfma_f32_16x16x32_bf16 v[72:75], v[136:139], v[124:127], v[72:75]
    v_mfma_f32_16x16x32_bf16 v[96:99], v[136:139], v[128:131], v[96:99]
    ds_read_b64_tr_b16 v[178:179], v15 offset:12800
    v_mfma_f32_16x16x32_bf16 v[28:31], v[140:143], v[116:119], v[28:31]
    ds_read_b128 v[160:163], v13 offset:2048
    v_mfma_f32_16x16x32_bf16 v[52:55], v[140:143], v[120:123], v[52:55]
    v_mfma_f32_16x16x32_bf16 v[76:79], v[140:143], v[124:127], v[76:79]
    ds_read_b128 v[164:167], v13 offset:4096
    v_mfma_f32_16x16x32_bf16 v[100:103], v[140:143], v[128:131], v[100:103]
    v_mfma_f32_16x16x32_bf16 v[32:35], v[144:147], v[116:119], v[32:35]
    ds_read_b128 v[168:171], v13 offset:6144
    v_mfma_f32_16x16x32_bf16 v[56:59], v[144:147], v[120:123], v[56:59]
    v_mfma_f32_16x16x32_bf16 v[80:83], v[144:147], v[124:127], v[80:83]
    ds_read_b64_tr_b16 v[180:181], v14 offset:13312
    v_mfma_f32_16x16x32_bf16 v[104:107], v[144:147], v[128:131], v[104:107]
    ds_read_b64_tr_b16 v[182:183], v14 offset:13824
    v_mfma_f32_16x16x32_bf16 v[36:39], v[116:119], v[148:151], v[36:39]
    v_mfma_f32_16x16x32_bf16 v[60:63], v[120:123], v[148:151], v[60:63]
    ds_read_b64_tr_b16 v[184:185], v15 offset:13312
    v_mfma_f32_16x16x32_bf16 v[84:87], v[124:127], v[148:151], v[84:87]
    v_mfma_f32_16x16x32_bf16 v[108:111], v[128:131], v[148:151], v[108:111]
    ds_read_b64_tr_b16 v[186:187], v15 offset:13824
    v_mfma_f32_16x16x32_bf16 v[40:43], v[116:119], v[152:155], v[40:43]
    v_mfma_f32_16x16x32_bf16 v[64:67], v[120:123], v[152:155], v[64:67]
    ds_read_b64_tr_b16 v[188:189], v14 offset:14336
    v_mfma_f32_16x16x32_bf16 v[88:91], v[124:127], v[152:155], v[88:91]
    ds_read_b64_tr_b16 v[190:191], v14 offset:14848
    v_mfma_f32_16x16x32_bf16 v[112:115], v[128:131], v[152:155], v[112:115]
    v_mfma_f32_16x16x32_bf16 v[220:223], v[252:255], v[116:119], v[220:223]
    ds_read_b64_tr_b16 v[192:193], v15 offset:14336
    v_mfma_f32_16x16x32_bf16 v[236:239], v[116:119], v[116:119], v[236:239]
    v_mfma_f32_16x16x32_bf16 v[224:227], v[252:255], v[120:123], v[224:227]
    ds_read_b64_tr_b16 v[194:195], v15 offset:14848
    v_mfma_f32_16x16x32_bf16 v[240:243], v[120:123], v[120:123], v[240:243]
    v_mfma_f32_16x16x32_bf16 v[228:231], v[252:255], v[124:127], v[228:231]
    v_mfma_f32_16x16x32_bf16 v[244:247], v[124:127], v[124:127], v[244:247]
    v_mfma_f32_16x16x32_bf16 v[232:235], v[252:255], v[128:131], v[232:235]
    v_mfma_f32_16x16x32_bf16 v[248:251], v[128:131], v[128:131], v[248:251]
    s_waitcnt lgkmcnt(0)
    v_mfma_f32_16x16x32_bf16 v[196:199], v[172:175], v[252:255], v[196:199]
    v_mfma_f32_16x16x32_bf16 v[200:203], v[176:179], v[252:255], v[200:203]
    v_mfma_f32_16x16x32_bf16 v[204:207], v[180:183], v[252:255], v[204:207]
    v_mfma_f32_16x16x32_bf16 v[208:211], v[184:187], v[252:255], v[208:211]
    v_mfma_f32_16x16x32_bf16 v[212:215], v[188:191], v[252:255], v[212:215]
    v_mfma_f32_16x16x32_bf16 v[216:219], v[192:195], v[252:255], v[216:219]
    v_mfma_f32_16x16x32_bf16 v[20:23], v[172:175], v[156:159], v[20:23]
    v_mfma_f32_16x16x32_bf16 v[44:47], v[172:175], v[160:163], v[44:47]
    v_mfma_f32_16x16x32_bf16 v[68:71], v[172:175], v[164:167], v[68:71]
    v_mfma_f32_16x16x32_bf16 v[92:95], v[172:175], v[168:171], v[92:95]
    v_mfma_f32_16x16x32_bf16 v[24:27], v[176:179], v[156:159], v[24:27]
    v_mfma_f32_16x16x32_bf16 v[48:51], v[176:179], v[160:163], v[48:51]
    v_mfma_f32_16x16x32_bf16 v[72:75], v[176:179], v[164:167], v[72:75]
    v_mfma_f32_16x16x32_bf16 v[96:99], v[176:179], v[168:171], v[96:99]
    v_mfma_f32_16x16x32_bf16 v[28:31], v[180:183], v[156:159], v[28:31]
    v_mfma_f32_16x16x32_bf16 v[52:55], v[180:183], v[160:163], v[52:55]
    v_mfma_f32_16x16x32_bf16 v[76:79], v[180:183], v[164:167], v[76:79]
    v_mfma_f32_16x16x32_bf16 v[100:103], v[180:183], v[168:171], v[100:103]
    v_mfma_f32_16x16x32_bf16 v[32:35], v[184:187], v[156:159], v[32:35]
    v_mfma_f32_16x16x32_bf16 v[56:59], v[184:187], v[160:163], v[56:59]
    v_mfma_f32_16x16x32_bf16 v[80:83], v[184:187], v[164:167], v[80:83]
    v_mfma_f32_16x16x32_bf16 v[104:107], v[184:187], v[168:171], v[104:107]
    v_mfma_f32_16x16x32_bf16 v[36:39], v[156:159], v[188:191], v[36:39]
    v_mfma_f32_16x16x32_bf16 v[60:63], v[160:163], v[188:191], v[60:63]
    v_mfma_f32_16x16x32_bf16 v[84:87], v[164:167], v[188:191], v[84:87]
    v_mfma_f32_16x16x32_bf16 v[108:111], v[168:171], v[188:191], v[108:111]
    v_mfma_f32_16x16x32_bf16 v[40:43], v[156:159], v[192:195], v[40:43]
    v_mfma_f32_16x16x32_bf16 v[64:67], v[160:163], v[192:195], v[64:67]
    v_mfma_f32_16x16x32_bf16 v[88:91], v[164:167], v[192:195], v[88:91]
    v_mfma_f32_16x16x32_bf16 v[112:115], v[168:171], v[192:195], v[112:115]
L_qkv_sle10:
    s_nop 7
    s_lshl_b32 s43, s51, 10
    s_lshl_b32 s44, s52, 7
    s_add_u32 s44, s44, s43
    v_lshl_add_u32 v3, v2, 4, s44
    s_lshl_b32 s44, s52, 6
    s_add_u32 s44, s44, s43
    v_lshl_add_u32 v4, v2, 4, s44
    v_and_b32 v5, 3, v1
    v_cmp_eq_u32 vcc, 1, v5
    s_nop 1
    v_cndmask_b32 v236, v236, v237, vcc
    v_cndmask_b32 v240, v240, v241, vcc
    v_cndmask_b32 v244, v244, v245, vcc
    v_cndmask_b32 v248, v248, v249, vcc
    v_cmp_eq_u32 vcc, 2, v5
    s_nop 1
    v_cndmask_b32 v236, v236, v238, vcc
    v_cndmask_b32 v240, v240, v242, vcc
    v_cndmask_b32 v244, v244, v246, vcc
    v_cndmask_b32 v248, v248, v250, vcc
    v_cmp_eq_u32 vcc, 3, v5
    s_nop 1
    v_cndmask_b32 v236, v236, v239, vcc
    v_cndmask_b32 v240, v240, v243, vcc
    v_cndmask_b32 v244, v244, v247, vcc
    v_cndmask_b32 v248, v248, v251, vcc
    v_mov_b32 v221, v236
    v_mov_b32 v225, v240
    v_mov_b32 v229, v244
    v_mov_b32 v233, v248
    s_lshl_b32 s43, s52, 10
    s_lshl_b32 s44, s51, 9
    s_add_u32 s43, s43, s44
    v_lshl_add_u32 v6, v1, 3, s43
    v_lshrrev_b32 v5, 2, v1
    v_cmp_eq_u32 vcc, v5, v2
    s_and_saveexec_b64 s[62:63], vcc
    ds_write_b64 v6, v[220:221] offset:6144
    ds_write_b64 v6, v[224:225] offset:6272
    ds_write_b64 v6, v[228:229] offset:6400
    ds_write_b64 v6, v[232:233] offset:6528
    s_mov_b64 exec, -1
    v_cmp_eq_u32 vcc, 0, v1
    s_and_saveexec_b64 s[62:63], vcc
    ds_write_b128 v3, v[196:199] offset:4096
    ds_write_b128 v3, v[200:203] offset:4160
    ds_write_b128 v3, v[204:207] offset:4352
    ds_write_b128 v3, v[208:211] offset:4416
    ds_write_b128 v3, v[212:215] offset:4608
    ds_write_b128 v3, v[216:219] offset:4672
    s_mov_b64 exec, -1
    s_waitcnt lgkmcnt(0)
    s_barrier
    s_branch L_qkv_join
L_qkv_ool18:
    s_barrier
    s_lshl_b32 s43, s51, 8
    v_lshl_add_u32 v1, v0, 2, s43
    ds_read_b32 v74, v1 offset:4096
    ds_read_b32 v75, v1 offset:5120
    v_and_b32 v1, 31, v0
    v_lshl_add_u32 v1, v1, 3, s43
    v_lshrrev_b32 v2, 5, v0
    v_lshl_add_u32 v1, v2, 10, v1
    ds_read_b64 v[72:73], v1 offset:6144
    s_cmp_eq_u32 s41, 0
    s_mov_b32 s44, 2146435072
    s_cselect_b32 s44, 1048576, s44
    s_cmp_eq_u32 s51, 3
    s_cselect_b32 s44, 2146435072, s44
    s_waitcnt vmcnt(0) lgkmcnt(0)
    v_add_f32 v56, v74, v75
    buffer_store_dword v56, v47, s[24:27], s44 offen sc1
    s_branch L_qkv_back19
L_qkv_ool20:
    v_mov_b32 v1, v72
    v_mov_b32 v2, v73
    v_mov_b32 v3, v1
    v_mov_b32 v4, v2
    s_nop 1
    v_permlane32_swap_b32 v1, v3
    v_permlane32_swap_b32 v2, v4
    v_add_f32 v1, v1, v3
    v_add_f32 v2, v2, v4
    v_mul_f32 v1, 0x3a800000, v1
    v_mul_f32 v2, 0x3a800000, v2
    v_fma_f32 v2, -v1, v1, v2
    v_max_f32 v2, 0, v2
    s_branch L_qkv_back21
L_sync_qkv:
    s_load_dwordx2 s[4:5], s[0:1], 80
    s_cmp_eq_u32 s3, 0
    s_cbranch_scc1 L_syncqkv_nn1
    s_load_dwordx2 s[6:7], s[0:1], 72
    s_waitcnt lgkmcnt(0)
    s_mov_b32 s8, s6
    s_and_b32 s9, s7, 0xffff
    s_mov_b32 s10, 256
    s_mov_b32 s11, 131072
    v_mov_b32 v1, 0
    s_mov_b32 s16, 0x400000
L_syncqkv_nq2:
    buffer_load_dword v2, v1, s[8:11], 0 offen sc1
    s_waitcnt vmcnt(0)
    v_readfirstlane_b32 s95, v2
    s_sub_u32 s16, s16, 1
    s_cbranch_scc1 L_syncqkv_nn1
    s_cmp_eq_u32 s95, 0
    s_cbranch_scc1 L_syncqkv_nq2
L_syncqkv_nn1:
    s_waitcnt vmcnt(0) lgkmcnt(0)
    s_barrier
    s_add_u32 s8, s4, 65011712
    s_addc_u32 s9, s5, 0
    s_and_b32 s9, s9, 0xffff
    s_mov_b32 s10, 1048576
    s_mov_b32 s11, 131072
    v_mbcnt_lo_u32_b32 v0, -1, 0
    v_mbcnt_hi_u32_b32 v0, -1, v0
    s_xor_b32 s12, s3, 1
    s_mul_i32 s12, s12, 5
    s_add_u32 s12, s12, 0
    s_lshl_b32 s12, s12, 15
    s_cmp_lg_u32 s97, 0
    s_cbranch_scc1 L_syncqkv_go3
    s_lshl_b32 s13, s96, 7
    s_add_u32 s13, s12, s13
    v_mov_b32 v1, 0
    v_mov_b32 v2, s95
    s_mov_b64 exec, 1
    buffer_store_dword v2, v1, s[8:11], s13 offen sc1
    s_mov_b64 exec, -1
L_syncqkv_go3:
    s_and_b32 s14, s2, 7
    s_lshr_b32 s15, s2, 3
    s_lshl_b32 s13, s14, 1
    s_lshr_b32 s15, s2, 7
    s_add_u32 s13, s13, s15
    s_lshl_b32 s13, s13, 11
    s_add_u32 s99, s12, s13
    s_lshl_b32 s13, s97, 6
    v_or_b32 v0, s13, v0
    s_add_u32 s98, s98, 1
    s_branch attn_run
ce_qkv:
.p2align 8
cs_wo:
.globl wo_b_kernel
.p2align 8
.type wo_b_kernel,@function
wo_b_kernel:
    s_mov_b32 s3, 0
    s_branch wo_body
.globl wo_a_kernel
.p2align 8
.type wo_a_kernel,@function
wo_a_kernel:
    s_mov_b32 s3, 1
    s_mov_b32 s98, 0
    s_mov_b32 s99, -1
wo_body:
    s_cmp_ge_u32 s2, 256
    s_cbranch_scc1 L_wo_end
wo_run:
    s_load_dwordx2 s[4:5], s[0:1], 0
    s_load_dwordx2 s[6:7], s[0:1], 16
    s_load_dwordx2 s[30:31], s[0:1], 80
    s_load_dwordx2 s[32:33], s[0:1], 64
    s_load_dwordx2 s[34:35], s[0:1], 56
    s_xor_b32 s29, s3, 1
    s_mul_i32 s29, s29, 134217728
    v_lshrrev_b32 v1, 6, v0
    v_and_b32 v0, 63, v0
    v_readfirstlane_b32 s40, v1
    s_and_b32 s43, s2, 7
    s_lshr_b32 s44, s2, 3
    s_and_b32 s41, s43, 3
    s_lshl_b32 s41, s41, 2
    s_and_b32 s42, s44, 3
    s_add_u32 s41, s41, s42
    s_lshr_b32 s42, s43, 2
    s_lshl_b32 s42, s42, 3
    s_lshr_b32 s44, s44, 2
    s_add_u32 s42, s42, s44
    s_mov_b32 s97, s40
    s_lshl_b32 s96, s41, 4
    s_add_u32 s96, s96, s42
    s_load_dwordx2 s[56:57], s[0:1], 32
    s_cmp_ge_u32 s40, 4
    s_cbranch_scc0 L_wo_compute
L_wo_loader:
    s_sub_u32 s51, s40, 4
    v_lshrrev_b32 v1, 3, v0
    v_lshrrev_b32 v2, 1, v1
    s_and_b32 s43, s51, 1
    s_lshl_b32 s44, s43, 2
    v_add_u32 v2, s44, v2
    v_and_b32 v3, 7, v0
    v_xor_b32 v2, v2, v3
    v_lshlrev_b32 v2, 4, v2
    s_lshl_b32 s44, s51, 3
    v_add_u32 v1, s44, v1
    s_lshl_b32 s46, s41, 7
    v_add_u32 v1, s46, v1
    v_lshrrev_b32 v3, 6, v2
    v_and_b32 v4, 48, v2
    v_lshl_add_u32 v4, v3, 17, v4
    v_lshl_add_u32 v8, v1, 6, v4
    v_add_u32 v9, 2048, v8
    v_add_u32 v10, 4096, v8
    v_add_u32 v11, 6144, v8
    s_cmp_lg_u32 s3, 0
    s_cbranch_scc1 L_wo_xr5
    v_lshrrev_b32 v3, 6, v2
    v_and_b32 v4, 48, v2
    v_lshl_add_u32 v4, v3, 17, v4
    v_lshl_add_u32 v40, v1, 6, v4
    v_add_u32 v41, 2048, v40
    v_add_u32 v42, 4096, v40
    v_add_u32 v43, 6144, v40
    s_branch L_wo_xj6
L_wo_xr5:
    v_lshl_add_u32 v40, v1, 11, v2
    v_add_u32 v41, 65536, v40
    v_add_u32 v42, 131072, v40
    v_add_u32 v43, 196608, v40
L_wo_xj6:
    s_cmp_lg_u32 s3, 0
    s_mov_b32 s61, 262144
    s_cselect_b32 s61, 128, s61
    v_lshrrev_b32 v1, 5, v0
    v_bfe_u32 v2, v0, 2, 2
    v_lshl_add_u32 v1, v1, 2, v2
    v_add_u32 v1, s44, v1
    v_mul_u32_u24 v1, 2048, v1
    v_and_b32 v2, 3, v0
    s_lshl_b32 s43, s43, 1
    v_xor_b32 v2, s43, v2
    v_bfe_u32 v3, v0, 4, 1
    v_lshl_add_u32 v2, v3, 2, v2
    v_lshl_add_u32 v1, v2, 4, v1
    s_lshl_b32 s43, s42, 7
    v_add_u32 v1, s43, v1
    v_add_u32 v12, 0, v1
    v_add_u32 v13, 65536, v1
    s_lshl_b32 s53, s51, 10
    s_mul_i32 s54, s51, 1024
    s_add_u32 s54, s54, 16384
    s_mov_b32 s45, 0
    s_mov_b32 s47, 0
    s_mov_b32 s48, 0
    s_waitcnt lgkmcnt(0)
    s_add_u32 s8, s30, s29
    s_addc_u32 s9, s31, 0
    s_add_u32 s8, s8, 58720256
    s_addc_u32 s9, s9, 0
    s_and_b32 s9, s9, 0xffff
    s_mov_b32 s10, 5242880
    s_mov_b32 s11, 131072
    s_mov_b32 s12, s6
    s_and_b32 s13, s7, 0xffff
    s_mov_b32 s14, 2097152
    s_mov_b32 s15, 131072
    s_add_u32 s43, s30, 50331648
    s_addc_u32 s44, s31, 0
    s_cmp_lg_u32 s3, 0
    s_cselect_b32 s20, s4, s43
    s_cselect_b32 s21, s5, s44
    s_and_b32 s21, s21, 0xffff
    s_mov_b32 s22, 4194304
    s_mov_b32 s23, 131072
    s_mov_b32 s46, 2
L_wo_wp7:
    s_add_u32 s49, s45, s53
    s_add_u32 s50, s45, s54
    s_add_u32 m0, s50, 0
    s_nop 0
    buffer_load_dwordx4 v12, s[12:15], s48 offen lds
    s_add_u32 m0, s50, 4096
    s_nop 0
    buffer_load_dwordx4 v13, s[12:15], s48 offen lds
    s_add_u32 s48, s48, 131072
    s_add_u32 s45, s45, 24576
    s_cmp_eq_u32 s45, 147456
    s_cselect_b32 s45, 0, s45
    s_sub_u32 s46, s46, 1
    s_cmp_lg_u32 s46, 0
    s_cbranch_scc1 L_wo_wp7
    s_cmp_eq_u32 s99, -1
    s_cbranch_scc1 L_wo_dwe8
    s_cmp_lg_u32 s97, 4
    s_cbranch_scc1 L_wo_dwb9
    s_add_u32 s64, s30, 65011712
    s_addc_u32 s65, s31, 0
    s_and_b32 s65, s65, 0xffff
    s_mov_b32 s66, 1048576
    s_mov_b32 s67, 131072
    v_lshlrev_b32 v76, 7, v0
    s_mov_b32 s46, 0x400000
    s_mov_b64 exec, 0xffffffff
L_wo_dwp10:
    buffer_load_dword v77, v76, s[64:67], s99 offen sc1
    s_waitcnt vmcnt(0)
    v_cmp_ne_u32 vcc, s95, v77
    s_sub_u32 s46, s46, 1
    s_cbranch_scc1 L_wo_dwg11
    s_nop 1
    s_cbranch_vccz L_wo_dwg11
    s_sleep 1
    s_branch L_wo_dwp10
L_wo_dwg11:
    s_mov_b64 exec, -1
L_wo_dwb9:
    s_barrier
L_wo_dwe8:
    s_mov_b32 s45, 0
    s_add_u32 s49, s45, s53
    s_add_u32 s50, s45, s54
    s_add_u32 m0, s49, 0
    s_nop 0
    buffer_load_dwordx4 v8, s[8:11], s47 offen lds
    s_add_u32 m0, s49, 4096
    s_nop 0
    buffer_load_dwordx4 v9, s[8:11], s47 offen lds
    s_add_u32 m0, s49, 8192
    s_nop 0
    buffer_load_dwordx4 v10, s[8:11], s47 offen lds
    s_add_u32 m0, s49, 12288
    s_nop 0
    buffer_load_dwordx4 v11, s[8:11], s47 offen lds
    s_add_u32 s47, s47, 262144
    s_add_u32 s45, s45, 24576
    s_cmp_eq_u32 s45, 147456
    s_cselect_b32 s45, 0, s45
    s_add_u32 s49, s45, s53
    s_add_u32 s50, s45, s54
    s_add_u32 m0, s49, 0
    s_nop 0
    buffer_load_dwordx4 v8, s[8:11], s47 offen lds
    s_add_u32 m0, s49, 4096
    s_nop 0
    buffer_load_dwordx4 v9, s[8:11], s47 offen lds
    s_add_u32 m0, s49, 8192
    s_nop 0
    buffer_load_dwordx4 v10, s[8:11], s47 offen lds
    s_add_u32 m0, s49, 12288
    s_nop 0
    buffer_load_dwordx4 v11, s[8:11], s47 offen lds
    s_add_u32 s47, s47, 262144
    s_add_u32 s45, s45, 24576
    s_cmp_eq_u32 s45, 147456
    s_cselect_b32 s45, 0, s45
    s_waitcnt vmcnt(4)
    s_barrier
    s_add_u32 s49, s45, s53
    s_add_u32 s50, s45, s54
    s_add_u32 m0, s49, 0
    s_nop 0
    buffer_load_dwordx4 v8, s[8:11], s47 offen lds
    s_add_u32 m0, s49, 4096
    s_nop 0
    buffer_load_dwordx4 v9, s[8:11], s47 offen lds
    s_add_u32 m0, s50, 0
    s_nop 0
    buffer_load_dwordx4 v12, s[12:15], s48 offen lds
    s_add_u32 m0, s49, 8192
    s_nop 0
    buffer_load_dwordx4 v10, s[8:11], s47 offen lds
    s_add_u32 m0, s49, 12288
    s_nop 0
    buffer_load_dwordx4 v11, s[8:11], s47 offen lds
    s_add_u32 m0, s50, 4096
    s_nop 0
    buffer_load_dwordx4 v13, s[12:15], s48 offen lds
    s_add_u32 s47, s47, 262144
    s_add_u32 s48, s48, 131072
    s_add_u32 s45, s45, 24576
    s_cmp_eq_u32 s45, 147456
    s_cselect_b32 s45, 0, s45
    s_add_u32 s49, s45, s53
    s_add_u32 s50, s45, s54
    s_add_u32 m0, s49, 0
    s_nop 0
    buffer_load_dwordx4 v8, s[8:11], s47 offen lds
    s_add_u32 m0, s49, 4096
    s_nop 0
    buffer_load_dwordx4 v9, s[8:11], s47 offen lds
    s_add_u32 m0, s50, 0
    s_nop 0
    buffer_load_dwordx4 v12, s[12:15], s48 offen lds
    s_add_u32 m0, s49, 8192
    s_nop 0
    buffer_load_dwordx4 v10, s[8:11], s47 offen lds
    s_add_u32 m0, s49, 12288
    s_nop 0
    buffer_load_dwordx4 v11, s[8:11], s47 offen lds
    s_add_u32 m0, s50, 4096
    s_nop 0
    buffer_load_dwordx4 v13, s[12:15], s48 offen lds
    s_add_u32 s47, s47, 262144
    s_add_u32 s48, s48, 131072
    s_add_u32 s45, s45, 24576
    s_cmp_eq_u32 s45, 147456
    s_cselect_b32 s45, 0, s45
    s_mov_b32 s46, 12
L_wo_lloop:
    s_waitcnt vmcnt(12)
    s_barrier
    s_add_u32 s49, s45, s53
    s_add_u32 s50, s45, s54
    s_add_u32 m0, s49, 0
    s_nop 0
    buffer_load_dwordx4 v8, s[8:11], s47 offen lds
    s_add_u32 m0, s49, 4096
    s_nop 0
    buffer_load_dwordx4 v9, s[8:11], s47 offen lds
    s_add_u32 m0, s50, 0
    s_nop 0
    buffer_load_dwordx4 v12, s[12:15], s48 offen lds
    s_add_u32 m0, s49, 8192
    s_nop 0
    buffer_load_dwordx4 v10, s[8:11], s47 offen lds
    s_add_u32 m0, s49, 12288
    s_nop 0
    buffer_load_dwordx4 v11, s[8:11], s47 offen lds
    s_add_u32 m0, s50, 4096
    s_nop 0
    buffer_load_dwordx4 v13, s[12:15], s48 offen lds
    s_add_u32 s47, s47, 262144
    s_add_u32 s48, s48, 131072
    s_add_u32 s45, s45, 24576
    s_cmp_eq_u32 s45, 147456
    s_cselect_b32 s45, 0, s45
    s_sub_u32 s46, s46, 1
    s_cmp_lg_u32 s46, 0
    s_cbranch_scc1 L_wo_lloop
    s_waitcnt vmcnt(12)
    s_barrier
    s_add_u32 s49, s45, s53
    s_mul_i32 s47, s42, s61
    s_add_u32 m0, s49, 0
    s_nop 0
    buffer_load_dwordx4 v40, s[20:23], s47 offen lds
    s_add_u32 m0, s49, 4096
    s_nop 0
    buffer_load_dwordx4 v41, s[20:23], s47 offen lds
    s_add_u32 m0, s49, 8192
    s_nop 0
    buffer_load_dwordx4 v42, s[20:23], s47 offen lds
    s_add_u32 m0, s49, 12288
    s_nop 0
    buffer_load_dwordx4 v43, s[20:23], s47 offen lds
    s_waitcnt vmcnt(10)
    s_barrier
    s_waitcnt vmcnt(4)
    s_barrier
    s_waitcnt vmcnt(0)
    s_barrier
    s_mov_b32 s60, s56
    s_and_b32 s61, s57, 0xffff
    s_mov_b32 s62, 7340032
    s_mov_b32 s63, 131072
    s_lshr_b32 s43, s2, 3
    s_and_b32 s43, s43, 31
    s_and_b32 s44, s2, 7
    s_lshl_b32 s43, s43, 5
    v_and_b32 v1, 31, v0
    v_add_u32 v1, s43, v1
    v_mul_u32_u24 v5, 7168, v1
    s_lshr_b32 s44, s44, 1
    s_mul_i32 s43, s44, 1536
    s_bitcmp1_b32 s44, 0
    s_cselect_b32 s44, 7, 3
    s_lshl_b32 s44, s44, 7
    s_add_u32 s43, s43, s44
    v_add_u32 v5, s43, v5
    s_sub_u32 s44, 6528, s43
    s_and_b32 s43, s2, 2
    s_cmp_eq_u32 s43, 0
    s_cselect_b32 s44, 1024, s44
    v_lshrrev_b32 v1, 5, v0
    v_mul_lo_u32 v1, v1, s44
    v_add_u32 v5, v5, v1
    s_cmp_eq_u32 s51, 0
    s_cselect_b32 s44, 64, 0
    v_cmp_gt_u32 vcc, s44, v0
    v_mov_b32 v1, 2146435072
    s_nop 0
    v_cndmask_b32 v5, v1, v5, vcc
    buffer_load_dword v6, v5, s[60:63], 0 offen
    s_lshr_b32 s43, s2, 3
    s_lshl_b32 s43, s43, 2
    s_add_u32 s43, s43, s51
    s_cmp_ge_u32 s43, 2
    s_cbranch_scc1 L_wo_nct13
    s_getpc_b64 s[64:65]
L_wo_pc12:
    s_sub_u32 s64, s64, L_wo_pc12-code_start
    s_subb_u32 s65, s65, 0
    v_lshl_add_u32 v2, s43, 6, v0
    v_lshlrev_b32 v2, 7, v2
    v_add_u32 v2, cs_w1-code_start, v2
    v_min_u32 v2, ce_w1-code_start-4, v2
    v_mov_b32 v3, s65
    v_add_co_u32 v2, vcc, s64, v2
    s_nop 1
    v_addc_co_u32 v3, vcc, 0, v3, vcc
    global_load_dword v7, v[2:3], off
L_wo_nct13:
    s_barrier
    s_branch L_sync_wo
L_wo_end:
    s_endpgm
L_wo_compute:
    s_lshr_b32 s51, s40, 1
    s_and_b32 s52, s40, 1
    v_and_b32 v1, 15, v0
    v_lshrrev_b32 v2, 4, v0
    v_lshrrev_b32 v3, 1, v1
    v_xor_b32 v3, v3, v2
    v_lshlrev_b32 v3, 4, v3
    v_lshl_add_u32 v7, v1, 7, v3
    s_lshl_b32 s43, s51, 13
    v_add_u32 v7, s43, v7
    v_xor_b32 v8, 64, v7
    v_lshrrev_b32 v3, 2, v1
    v_and_b32 v4, 3, v1
    v_lshlrev_b32 v3, 6, v3
    v_lshl_add_u32 v3, v4, 3, v3
    v_and_b32 v4, 1, v2
    v_lshl_add_u32 v5, v4, 5, v3
    v_mul_u32_u24 v6, 1024, v2
    v_add_u32 v9, v5, v6
    s_lshl_b32 s43, s52, 8
    s_add_u32 s43, s43, 16384
    v_add_u32 v9, s43, v9
    v_xor_b32 v10, 32, v9
    s_waitcnt lgkmcnt(0)
    s_add_u32 s16, s30, s29
    s_addc_u32 s17, s31, 0
    s_add_u32 s16, s16, 16777216
    s_addc_u32 s17, s17, 0
    s_and_b32 s17, s17, 0xffff
    s_mov_b32 s18, 4194304
    s_mov_b32 s19, 131072
    s_add_u32 s24, s30, 37748736
    s_addc_u32 s25, s31, 0
    s_and_b32 s25, s25, 0xffff
    s_mov_b32 s26, 2097152
    s_mov_b32 s27, 131072
    s_mov_b32 s36, s34
    s_and_b32 s37, s35, 0xffff
    s_mov_b32 s38, 2048
    s_mov_b32 s39, 131072
    v_lshrrev_b32 v3, 3, v1
    v_sub_u32 v3, v2, v3
    v_and_b32 v4, 1, v1
    v_lshlrev_b32 v4, 4, v4
    v_mov_b32 v5, 0x3f80
    v_lshlrev_b32 v4, v4, v5
    v_bfe_u32 v5, v1, 1, 2
    v_lshl_add_u32 v3, v3, 1, v5
    v_lshrrev_b32 v5, 3, v1
    v_xor_b32 v5, v5, v2
    v_and_b32 v5, 1, v5
    v_lshl_add_u32 v3, v5, 8, v3
    v_cmp_eq_u32 vcc, 0, v3
    s_nop 1
    v_cndmask_b32 v148, 0, v4, vcc
    v_cmp_eq_u32 vcc, 1, v3
    s_nop 1
    v_cndmask_b32 v149, 0, v4, vcc
    v_cmp_eq_u32 vcc, 2, v3
    s_nop 1
    v_cndmask_b32 v150, 0, v4, vcc
    v_cmp_eq_u32 vcc, 3, v3
    s_nop 1
    v_cndmask_b32 v151, 0, v4, vcc
    v_cmp_eq_u32 vcc, 4, v3
    s_nop 1
    v_cndmask_b32 v152, 0, v4, vcc
    v_cmp_eq_u32 vcc, 5, v3
    s_nop 1
    v_cndmask_b32 v153, 0, v4, vcc
    v_cmp_eq_u32 vcc, 6, v3
    s_nop 1
    v_cndmask_b32 v154, 0, v4, vcc
    v_cmp_eq_u32 vcc, 7, v3
    s_nop 1
    v_cndmask_b32 v155, 0, v4, vcc
    s_lshl_b32 s43, s52, 6
    v_xor_b32 v157, s43, v7
    v_mov_b32 v20, 0
    v_mov_b32 v21, 0
    v_mov_b32 v22, 0
    v_mov_b32 v23, 0
    v_mov_b32 v24, 0
    v_mov_b32 v25, 0
    v_mov_b32 v26, 0
    v_mov_b32 v27, 0
    v_mov_b32 v28, 0
    v_mov_b32 v29, 0
    v_mov_b32 v30, 0
    v_mov_b32 v31, 0
    v_mov_b32 v32, 0
    v_mov_b32 v33, 0
    v_mov_b32 v34, 0
    v_mov_b32 v35, 0
    v_mov_b32 v36, 0
    v_mov_b32 v37, 0
    v_mov_b32 v38, 0
    v_mov_b32 v39, 0
    v_mov_b32 v40, 0
    v_mov_b32 v41, 0
    v_mov_b32 v42, 0
    v_mov_b32 v43, 0
    v_mov_b32 v44, 0
    v_mov_b32 v45, 0
    v_mov_b32 v46, 0
    v_mov_b32 v47, 0
    v_mov_b32 v48, 0
    v_mov_b32 v49, 0
    v_mov_b32 v50, 0
    v_mov_b32 v51, 0
    s_mov_b32 s45, 0
    s_cmp_eq_u32 s99, -1
    s_cbranch_scc1 L_wo_dwe1
    s_barrier
L_wo_dwe1:
    s_mov_b32 s46, 7
    v_add_u32 v12, s45, v7
    v_add_u32 v13, s45, v8
    v_add_u32 v14, s45, v9
    v_add_u32 v15, s45, v10
    s_barrier
    ds_read_b128 v[52:55], v12 offset:0
    ds_read_b64_tr_b16 v[68:69], v14 offset:0
    ds_read_b64_tr_b16 v[70:71], v14 offset:512
    ds_read_b64_tr_b16 v[72:73], v15 offset:0
    ds_read_b64_tr_b16 v[74:75], v15 offset:512
    ds_read_b128 v[56:59], v12 offset:2048
    ds_read_b128 v[60:63], v12 offset:4096
    ds_read_b128 v[64:67], v12 offset:6144
    ds_read_b128 v[76:79], v13 offset:0
    ds_read_b64_tr_b16 v[92:93], v14 offset:4096
    ds_read_b64_tr_b16 v[94:95], v14 offset:4608
    ds_read_b64_tr_b16 v[96:97], v15 offset:4096
    ds_read_b64_tr_b16 v[98:99], v15 offset:4608
    ds_read_b128 v[80:83], v13 offset:2048
    ds_read_b128 v[84:87], v13 offset:4096
    ds_read_b128 v[88:91], v13 offset:6144
    s_add_u32 s45, s45, 24576
    s_cmp_eq_u32 s45, 147456
    s_cselect_b32 s45, 0, s45
L_wo_cloop:
    v_add_u32 v12, s45, v7
    v_add_u32 v13, s45, v8
    v_add_u32 v14, s45, v9
    v_add_u32 v15, s45, v10
    s_waitcnt lgkmcnt(0)
    s_barrier
    v_mfma_f32_16x16x32_bf16 v[20:23], v[68:71], v[52:55], v[20:23]
    ds_read_b128 v[100:103], v12 offset:0
    v_mfma_f32_16x16x32_bf16 v[28:31], v[68:71], v[56:59], v[28:31]
    ds_read_b64_tr_b16 v[116:117], v14 offset:0
    v_mfma_f32_16x16x32_bf16 v[36:39], v[68:71], v[60:63], v[36:39]
    ds_read_b64_tr_b16 v[118:119], v14 offset:512
    v_mfma_f32_16x16x32_bf16 v[44:47], v[68:71], v[64:67], v[44:47]
    ds_read_b64_tr_b16 v[120:121], v15 offset:0
    v_mfma_f32_16x16x32_bf16 v[24:27], v[72:75], v[52:55], v[24:27]
    ds_read_b64_tr_b16 v[122:123], v15 offset:512
    v_mfma_f32_16x16x32_bf16 v[32:35], v[72:75], v[56:59], v[32:35]
    ds_read_b128 v[104:107], v12 offset:2048
    v_mfma_f32_16x16x32_bf16 v[40:43], v[72:75], v[60:63], v[40:43]
    ds_read_b128 v[108:111], v12 offset:4096
    v_mfma_f32_16x16x32_bf16 v[48:51], v[72:75], v[64:67], v[48:51]
    ds_read_b128 v[112:115], v12 offset:6144
    v_mfma_f32_16x16x32_bf16 v[20:23], v[92:95], v[76:79], v[20:23]
    ds_read_b128 v[124:127], v13 offset:0
    v_mfma_f32_16x16x32_bf16 v[28:31], v[92:95], v[80:83], v[28:31]
    ds_read_b64_tr_b16 v[140:141], v14 offset:4096
    v_mfma_f32_16x16x32_bf16 v[36:39], v[92:95], v[84:87], v[36:39]
    ds_read_b64_tr_b16 v[142:143], v14 offset:4608
    v_mfma_f32_16x16x32_bf16 v[44:47], v[92:95], v[88:91], v[44:47]
    ds_read_b64_tr_b16 v[144:145], v15 offset:4096
    v_mfma_f32_16x16x32_bf16 v[24:27], v[96:99], v[76:79], v[24:27]
    ds_read_b64_tr_b16 v[146:147], v15 offset:4608
    v_mfma_f32_16x16x32_bf16 v[32:35], v[96:99], v[80:83], v[32:35]
    ds_read_b128 v[128:131], v13 offset:2048
    v_mfma_f32_16x16x32_bf16 v[40:43], v[96:99], v[84:87], v[40:43]
    ds_read_b128 v[132:135], v13 offset:4096
    v_mfma_f32_16x16x32_bf16 v[48:51], v[96:99], v[88:91], v[48:51]
    ds_read_b128 v[136:139], v13 offset:6144
    s_add_u32 s45, s45, 24576
    s_cmp_eq_u32 s45, 147456
    s_cselect_b32 s45, 0, s45
    v_add_u32 v12, s45, v7
    v_add_u32 v13, s45, v8
    v_add_u32 v14, s45, v9
    v_add_u32 v15, s45, v10
    s_waitcnt lgkmcnt(0)
    s_barrier
    v_mfma_f32_16x16x32_bf16 v[20:23], v[116:119], v[100:103], v[20:23]
    ds_read_b128 v[52:55], v12 offset:0
    v_mfma_f32_16x16x32_bf16 v[28:31], v[116:119], v[104:107], v[28:31]
    ds_read_b64_tr_b16 v[68:69], v14 offset:0
    v_mfma_f32_16x16x32_bf16 v[36:39], v[116:119], v[108:111], v[36:39]
    ds_read_b64_tr_b16 v[70:71], v14 offset:512
    v_mfma_f32_16x16x32_bf16 v[44:47], v[116:119], v[112:115], v[44:47]
    ds_read_b64_tr_b16 v[72:73], v15 offset:0
    v_mfma_f32_16x16x32_bf16 v[24:27], v[120:123], v[100:103], v[24:27]
    ds_read_b64_tr_b16 v[74:75], v15 offset:512
    v_mfma_f32_16x16x32_bf16 v[32:35], v[120:123], v[104:107], v[32:35]
    ds_read_b128 v[56:59], v12 offset:2048
    v_mfma_f32_16x16x32_bf16 v[40:43], v[120:123], v[108:111], v[40:43]
    ds_read_b128 v[60:63], v12 offset:4096
    v_mfma_f32_16x16x32_bf16 v[48:51], v[120:123], v[112:115], v[48:51]
    ds_read_b128 v[64:67], v12 offset:6144
    v_mfma_f32_16x16x32_bf16 v[20:23], v[140:143], v[124:127], v[20:23]
    ds_read_b128 v[76:79], v13 offset:0
    v_mfma_f32_16x16x32_bf16 v[28:31], v[140:143], v[128:131], v[28:31]
    ds_read_b64_tr_b16 v[92:93], v14 offset:4096
    v_mfma_f32_16x16x32_bf16 v[36:39], v[140:143], v[132:135], v[36:39]
    ds_read_b64_tr_b16 v[94:95], v14 offset:4608
    v_mfma_f32_16x16x32_bf16 v[44:47], v[140:143], v[136:139], v[44:47]
    ds_read_b64_tr_b16 v[96:97], v15 offset:4096
    v_mfma_f32_16x16x32_bf16 v[24:27], v[144:147], v[124:127], v[24:27]
    ds_read_b64_tr_b16 v[98:99], v15 offset:4608
    v_mfma_f32_16x16x32_bf16 v[32:35], v[144:147], v[128:131], v[32:35]
    ds_read_b128 v[80:83], v13 offset:2048
    v_mfma_f32_16x16x32_bf16 v[40:43], v[144:147], v[132:135], v[40:43]
    ds_read_b128 v[84:87], v13 offset:4096
    v_mfma_f32_16x16x32_bf16 v[48:51], v[144:147], v[136:139], v[48:51]
    ds_read_b128 v[88:91], v13 offset:6144
    s_add_u32 s45, s45, 24576
    s_cmp_eq_u32 s45, 147456
    s_cselect_b32 s45, 0, s45
    s_sub_u32 s46, s46, 1
    s_cmp_lg_u32 s46, 0
    s_cbranch_scc1 L_wo_cloop
    v_add_u32 v12, s45, v7
    v_add_u32 v13, s45, v8
    v_add_u32 v14, s45, v9
    v_add_u32 v15, s45, v10
    s_waitcnt lgkmcnt(0)
    s_barrier
    v_mfma_f32_16x16x32_bf16 v[20:23], v[68:71], v[52:55], v[20:23]
    ds_read_b128 v[100:103], v12 offset:0
    v_mfma_f32_16x16x32_bf16 v[28:31], v[68:71], v[56:59], v[28:31]
    ds_read_b64_tr_b16 v[116:117], v14 offset:0
    v_mfma_f32_16x16x32_bf16 v[36:39], v[68:71], v[60:63], v[36:39]
    ds_read_b64_tr_b16 v[118:119], v14 offset:512
    v_mfma_f32_16x16x32_bf16 v[44:47], v[68:71], v[64:67], v[44:47]
    ds_read_b64_tr_b16 v[120:121], v15 offset:0
    v_mfma_f32_16x16x32_bf16 v[24:27], v[72:75], v[52:55], v[24:27]
    ds_read_b64_tr_b16 v[122:123], v15 offset:512
    v_mfma_f32_16x16x32_bf16 v[32:35], v[72:75], v[56:59], v[32:35]
    ds_read_b128 v[104:107], v12 offset:2048
    v_mfma_f32_16x16x32_bf16 v[40:43], v[72:75], v[60:63], v[40:43]
    ds_read_b128 v[108:111], v12 offset:4096
    v_mfma_f32_16x16x32_bf16 v[48:51], v[72:75], v[64:67], v[48:51]
    ds_read_b128 v[112:115], v12 offset:6144
    v_mfma_f32_16x16x32_bf16 v[20:23], v[92:95], v[76:79], v[20:23]
    ds_read_b128 v[124:127], v13 offset:0
    v_mfma_f32_16x16x32_bf16 v[28:31], v[92:95], v[80:83], v[28:31]
    ds_read_b64_tr_b16 v[140:141], v14 offset:4096
    v_mfma_f32_16x16x32_bf16 v[36:39], v[92:95], v[84:87], v[36:39]
    ds_read_b64_tr_b16 v[142:143], v14 offset:4608
    v_mfma_f32_16x16x32_bf16 v[44:47], v[92:95], v[88:91], v[44:47]
    ds_read_b64_tr_b16 v[144:145], v15 offset:4096
    v_mfma_f32_16x16x32_bf16 v[24:27], v[96:99], v[76:79], v[24:27]
    ds_read_b64_tr_b16 v[146:147], v15 offset:4608
    v_mfma_f32_16x16x32_bf16 v[32:35], v[96:99], v[80:83], v[32:35]
    ds_read_b128 v[128:131], v13 offset:2048
    v_mfma_f32_16x16x32_bf16 v[40:43], v[96:99], v[84:87], v[40:43]
    ds_read_b128 v[132:135], v13 offset:4096
    v_mfma_f32_16x16x32_bf16 v[48:51], v[96:99], v[88:91], v[48:51]
    ds_read_b128 v[136:139], v13 offset:6144
    s_add_u32 s45, s45, 24576
    s_cmp_eq_u32 s45, 147456
    s_cselect_b32 s45, 0, s45
    s_waitcnt lgkmcnt(0)
    s_barrier
    v_add_u32 v156, s45, v157
    v_mfma_f32_16x16x32_bf16 v[20:23], v[116:119], v[100:103], v[20:23]
    ds_read_b128 v[52:55], v156 offset:0
    v_mfma_f32_16x16x32_bf16 v[28:31], v[116:119], v[104:107], v[28:31]
    v_mfma_f32_16x16x32_bf16 v[36:39], v[116:119], v[108:111], v[36:39]
    v_mfma_f32_16x16x32_bf16 v[44:47], v[116:119], v[112:115], v[44:47]
    ds_read_b128 v[56:59], v156 offset:2048
    v_mfma_f32_16x16x32_bf16 v[24:27], v[120:123], v[100:103], v[24:27]
    v_mfma_f32_16x16x32_bf16 v[32:35], v[120:123], v[104:107], v[32:35]
    v_mfma_f32_16x16x32_bf16 v[40:43], v[120:123], v[108:111], v[40:43]
    ds_read_b128 v[60:63], v156 offset:4096
    v_mfma_f32_16x16x32_bf16 v[48:51], v[120:123], v[112:115], v[48:51]
    v_mfma_f32_16x16x32_bf16 v[20:23], v[140:143], v[124:127], v[20:23]
    v_mfma_f32_16x16x32_bf16 v[28:31], v[140:143], v[128:131], v[28:31]
    ds_read_b128 v[64:67], v156 offset:6144
    v_mfma_f32_16x16x32_bf16 v[36:39], v[140:143], v[132:135], v[36:39]
    v_mfma_f32_16x16x32_bf16 v[44:47], v[140:143], v[136:139], v[44:47]
    v_mfma_f32_16x16x32_bf16 v[24:27], v[144:147], v[124:127], v[24:27]
    v_mfma_f32_16x16x32_bf16 v[32:35], v[144:147], v[128:131], v[32:35]
    v_mfma_f32_16x16x32_bf16 v[40:43], v[144:147], v[132:135], v[40:43]
    v_mfma_f32_16x16x32_bf16 v[48:51], v[144:147], v[136:139], v[48:51]
    s_waitcnt lgkmcnt(0)
    v_mfma_f32_16x16x32_bf16 v[20:23], v[148:151], v[52:55], v[20:23]
    v_mfma_f32_16x16x32_bf16 v[28:31], v[148:151], v[56:59], v[28:31]
    v_mfma_f32_16x16x32_bf16 v[36:39], v[148:151], v[60:63], v[36:39]
    v_mfma_f32_16x16x32_bf16 v[44:47], v[148:151], v[64:67], v[44:47]
    v_mfma_f32_16x16x32_bf16 v[24:27], v[152:155], v[52:55], v[24:27]
    v_mfma_f32_16x16x32_bf16 v[32:35], v[152:155], v[56:59], v[32:35]
    v_mfma_f32_16x16x32_bf16 v[40:43], v[152:155], v[60:63], v[40:43]
    v_mfma_f32_16x16x32_bf16 v[48:51], v[152:155], v[64:67], v[48:51]
    s_nop 7
    s_lshl_b32 s43, s41, 7
    s_lshl_b32 s44, s51, 6
    s_add_u32 s43, s43, s44
    v_add_u32 v4, s43, v1
    v_and_b32 v5, 1, v2
    v_lshlrev_b32 v5, 5, v5
    v_lshrrev_b32 v6, 1, v2
    v_lshl_add_u32 v5, v6, 4, v5
    v_lshl_add_u32 v3, v4, 6, v5
    v_lshl_add_u32 v4, v4, 11, v5
    s_lshl_b32 s43, s42, 1
    s_add_u32 s43, s43, s52
    s_lshl_b32 s44, s43, 17
    s_lshl_b32 s43, s43, 6
    v_add_u32 v4, s43, v4
    v_add_u32 v3, s44, v3
    v_cvt_pk_bf16_f32 v52, v20, v21
    v_cvt_pk_bf16_f32 v53, v22, v23
    v_cvt_pk_bf16_f32 v54, v24, v25
    v_cvt_pk_bf16_f32 v55, v26, v27
    s_nop 1
    v_permlane16_swap_b32 v52, v54
    v_permlane16_swap_b32 v53, v55
    buffer_store_dwordx4 v[52:55], v3, s[16:19], 0 offen offset:0 sc1
    v_cvt_pk_bf16_f32 v56, v28, v29
    v_cvt_pk_bf16_f32 v57, v30, v31
    v_cvt_pk_bf16_f32 v58, v32, v33
    v_cvt_pk_bf16_f32 v59, v34, v35
    s_nop 1
    v_permlane16_swap_b32 v56, v58
    v_permlane16_swap_b32 v57, v59
    buffer_store_dwordx4 v[56:59], v3, s[16:19], 0 offen offset:1024 sc1
    v_cvt_pk_bf16_f32 v60, v36, v37
    v_cvt_pk_bf16_f32 v61, v38, v39
    v_cvt_pk_bf16_f32 v62, v40, v41
    v_cvt_pk_bf16_f32 v63, v42, v43
    s_nop 1
    v_permlane16_swap_b32 v60, v62
    v_permlane16_swap_b32 v61, v63
    buffer_store_dwordx4 v[60:63], v3, s[16:19], 0 offen offset:2048 sc1
    v_cvt_pk_bf16_f32 v64, v44, v45
    v_cvt_pk_bf16_f32 v65, v46, v47
    v_cvt_pk_bf16_f32 v66, v48, v49
    v_cvt_pk_bf16_f32 v67, v50, v51
    s_nop 1
    v_permlane16_swap_b32 v64, v66
    v_permlane16_swap_b32 v65, v67
    buffer_store_dwordx4 v[64:67], v3, s[16:19], 0 offen offset:3072 sc1
    v_lshlrev_b32 v76, 16, v52
    v_and_b32 v77, 0xffff0000, v52
    v_lshlrev_b32 v78, 16, v53
    v_and_b32 v79, 0xffff0000, v53
    v_lshlrev_b32 v80, 16, v54
    v_and_b32 v81, 0xffff0000, v54
    v_lshlrev_b32 v82, 16, v55
    v_and_b32 v83, 0xffff0000, v55
    v_pk_add_f32 v[84:85], v[76:77], v[78:79]
    v_pk_add_f32 v[86:87], v[80:81], v[82:83]
    v_pk_add_f32 v[84:85], v[84:85], v[86:87]
    v_add_f32 v84, v84, v85
    v_mul_f32 v68, 0.125, v84
    v_mul_f32 v84, 0xbe000000, v84
    v_pk_add_f32 v[76:77], v[76:77], v[84:85] op_sel_hi:[1,0]
    v_pk_add_f32 v[78:79], v[78:79], v[84:85] op_sel_hi:[1,0]
    v_pk_add_f32 v[80:81], v[80:81], v[84:85] op_sel_hi:[1,0]
    v_pk_add_f32 v[82:83], v[82:83], v[84:85] op_sel_hi:[1,0]
    v_pk_mul_f32 v[86:87], v[76:77], v[76:77]
    v_pk_fma_f32 v[86:87], v[78:79], v[78:79], v[86:87]
    v_pk_fma_f32 v[86:87], v[80:81], v[80:81], v[86:87]
    v_pk_fma_f32 v[86:87], v[82:83], v[82:83], v[86:87]
    v_add_f32 v72, v86, v87
    v_lshlrev_b32 v76, 16, v56
    v_and_b32 v77, 0xffff0000, v56
    v_lshlrev_b32 v78, 16, v57
    v_and_b32 v79, 0xffff0000, v57
    v_lshlrev_b32 v80, 16, v58
    v_and_b32 v81, 0xffff0000, v58
    v_lshlrev_b32 v82, 16, v59
    v_and_b32 v83, 0xffff0000, v59
    v_pk_add_f32 v[84:85], v[76:77], v[78:79]
    v_pk_add_f32 v[86:87], v[80:81], v[82:83]
    v_pk_add_f32 v[84:85], v[84:85], v[86:87]
    v_add_f32 v84, v84, v85
    v_mul_f32 v69, 0.125, v84
    v_mul_f32 v84, 0xbe000000, v84
    v_pk_add_f32 v[76:77], v[76:77], v[84:85] op_sel_hi:[1,0]
    v_pk_add_f32 v[78:79], v[78:79], v[84:85] op_sel_hi:[1,0]
    v_pk_add_f32 v[80:81], v[80:81], v[84:85] op_sel_hi:[1,0]
    v_pk_add_f32 v[82:83], v[82:83], v[84:85] op_sel_hi:[1,0]
    v_pk_mul_f32 v[86:87], v[76:77], v[76:77]
    v_pk_fma_f32 v[86:87], v[78:79], v[78:79], v[86:87]
    v_pk_fma_f32 v[86:87], v[80:81], v[80:81], v[86:87]
    v_pk_fma_f32 v[86:87], v[82:83], v[82:83], v[86:87]
    v_add_f32 v73, v86, v87
    v_lshlrev_b32 v76, 16, v60
    v_and_b32 v77, 0xffff0000, v60
    v_lshlrev_b32 v78, 16, v61
    v_and_b32 v79, 0xffff0000, v61
    v_lshlrev_b32 v80, 16, v62
    v_and_b32 v81, 0xffff0000, v62
    v_lshlrev_b32 v82, 16, v63
    v_and_b32 v83, 0xffff0000, v63
    v_pk_add_f32 v[84:85], v[76:77], v[78:79]
    v_pk_add_f32 v[86:87], v[80:81], v[82:83]
    v_pk_add_f32 v[84:85], v[84:85], v[86:87]
    v_add_f32 v84, v84, v85
    v_mul_f32 v70, 0.125, v84
    v_mul_f32 v84, 0xbe000000, v84
    v_pk_add_f32 v[76:77], v[76:77], v[84:85] op_sel_hi:[1,0]
    v_pk_add_f32 v[78:79], v[78:79], v[84:85] op_sel_hi:[1,0]
    v_pk_add_f32 v[80:81], v[80:81], v[84:85] op_sel_hi:[1,0]
    v_pk_add_f32 v[82:83], v[82:83], v[84:85] op_sel_hi:[1,0]
    v_pk_mul_f32 v[86:87], v[76:77], v[76:77]
    v_pk_fma_f32 v[86:87], v[78:79], v[78:79], v[86:87]
    v_pk_fma_f32 v[86:87], v[80:81], v[80:81], v[86:87]
    v_pk_fma_f32 v[86:87], v[82:83], v[82:83], v[86:87]
    v_add_f32 v74, v86, v87
    v_lshlrev_b32 v76, 16, v64
    v_and_b32 v77, 0xffff0000, v64
    v_lshlrev_b32 v78, 16, v65
    v_and_b32 v79, 0xffff0000, v65
    v_lshlrev_b32 v80, 16, v66
    v_and_b32 v81, 0xffff0000, v66
    v_lshlrev_b32 v82, 16, v67
    v_and_b32 v83, 0xffff0000, v67
    v_pk_add_f32 v[84:85], v[76:77], v[78:79]
    v_pk_add_f32 v[86:87], v[80:81], v[82:83]
    v_pk_add_f32 v[84:85], v[84:85], v[86:87]
    v_add_f32 v84, v84, v85
    v_mul_f32 v71, 0.125, v84
    v_mul_f32 v84, 0xbe000000, v84
    v_pk_add_f32 v[76:77], v[76:77], v[84:85] op_sel_hi:[1,0]
    v_pk_add_f32 v[78:79], v[78:79], v[84:85] op_sel_hi:[1,0]
    v_pk_add_f32 v[80:81], v[80:81], v[84:85] op_sel_hi:[1,0]
    v_pk_add_f32 v[82:83], v[82:83], v[84:85] op_sel_hi:[1,0]
    v_pk_mul_f32 v[86:87], v[76:77], v[76:77]
    v_pk_fma_f32 v[86:87], v[78:79], v[78:79], v[86:87]
    v_pk_fma_f32 v[86:87], v[80:81], v[80:81], v[86:87]
    v_pk_fma_f32 v[86:87], v[82:83], v[82:83], v[86:87]
    v_add_f32 v75, v86, v87
    s_nop 1
    v_permlane16_swap_b32 v68, v69
    v_permlane16_swap_b32 v72, v73
    v_permlane16_swap_b32 v70, v71
    v_permlane16_swap_b32 v74, v75
    v_sub_f32 v84, v68, v69
    v_add_f32 v68, v68, v69
    v_add_f32 v72, v72, v73
    v_mul_f32 v85, 0x40800000, v84
    v_mul_f32 v68, 0.5, v68
    v_fmac_f32 v72, v84, v85
    v_sub_f32 v84, v70, v71
    v_add_f32 v70, v70, v71
    v_add_f32 v74, v74, v75
    v_mul_f32 v85, 0x40800000, v84
    v_mul_f32 v70, 0.5, v70
    v_fmac_f32 v74, v84, v85
    s_nop 1
    v_permlane32_swap_b32 v68, v70
    v_permlane32_swap_b32 v72, v74
    v_sub_f32 v84, v68, v70
    v_add_f32 v68, v68, v70
    v_add_f32 v72, v72, v74
    v_mul_f32 v85, 0x41000000, v84
    v_mul_f32 v68, 0.5, v68
    v_fmac_f32 v72, v84, v85
    v_mov_b32 v69, v72
    s_lshl_b32 s43, s51, 9
    v_lshl_add_u32 v5, v0, 3, s43
    s_cmp_eq_u32 s52, 0
    s_cbranch_scc1 L_wo_w0
    ds_write_b64 v5, v[68:69] offset:4096
    s_waitcnt lgkmcnt(0)
    s_barrier
    s_branch L_sync_wo
L_wo_w0:
    s_barrier
    ds_read_b64 v[70:71], v5 offset:4096
    s_waitcnt lgkmcnt(0)
    v_sub_f32 v84, v68, v70
    v_add_f32 v68, v68, v70
    v_add_f32 v69, v69, v71
    v_mul_f32 v85, 0x41800000, v84
    v_mul_f32 v68, 0.5, v68
    v_fmac_f32 v69, v84, v85
    s_lshl_b32 s43, s41, 7
    s_lshl_b32 s44, s51, 6
    s_add_u32 s43, s43, s44
    v_add_u32 v5, s43, v0
    v_lshlrev_b32 v5, 3, v5
    s_lshl_b32 s43, s42, 14
    s_add_u32 s43, s43, 262144
    s_lshl_b32 s44, s3, 18
    s_add_u32 s43, s43, s44
    buffer_store_dwordx2 v[68:69], v5, s[24:27], s43 offen sc1
    s_branch L_sync_wo
L_sync_wo:
    s_load_dwordx2 s[4:5], s[0:1], 80
    s_waitcnt vmcnt(0) lgkmcnt(0)
    s_barrier
    s_add_u32 s8, s4, 65011712
    s_addc_u32 s9, s5, 0
    s_and_b32 s9, s9, 0xffff
    s_mov_b32 s10, 1048576
    s_mov_b32 s11, 131072
    v_mbcnt_lo_u32_b32 v0, -1, 0
    v_mbcnt_hi_u32_b32 v0, -1, v0
    s_xor_b32 s12, s3, 1
    s_mul_i32 s12, s12, 5
    s_add_u32 s12, s12, 2
    s_lshl_b32 s12, s12, 15
    s_cmp_lg_u32 s97, 0
    s_cbranch_scc1 L_syncwo_go1
    s_lshl_b32 s13, s96, 7
    s_add_u32 s13, s12, s13
    v_mov_b32 v1, 0
    v_mov_b32 v2, s95
    s_mov_b64 exec, 1
    buffer_store_dword v2, v1, s[8:11], s13 offen sc1
    s_mov_b64 exec, -1
L_syncwo_go1:
    s_and_b32 s14, s2, 7
    s_lshr_b32 s15, s2, 3
    s_and_b32 s13, s14, 1
    s_lshl_b32 s13, s13, 3
    s_and_b32 s15, s15, 7
    s_add_u32 s13, s13, s15
    s_lshl_b32 s13, s13, 11
    s_add_u32 s99, s12, s13
    s_lshl_b32 s13, s97, 6
    v_or_b32 v0, s13, v0
    s_add_u32 s98, s98, 1
    s_branch w1_run
ce_wo:
.p2align 8
cs_w1:
.globl w1_b_kernel
.p2align 8
.type w1_b_kernel,@function
w1_b_kernel:
    s_mov_b32 s3, 0
    s_branch w1_body
.globl w1_a_kernel
.p2align 8
.type w1_a_kernel,@function
w1_a_kernel:
    s_mov_b32 s3, 1
    s_mov_b32 s98, 0
    s_mov_b32 s99, -1
w1_body:
    s_cmp_ge_u32 s2, 256
    s_cbranch_scc1 L_w1_end
w1_run:
    s_load_dwordx2 s[6:7], s[0:1], 32
    s_load_dwordx2 s[30:31], s[0:1], 80
    s_load_dwordx2 s[32:33], s[0:1], 64
    s_load_dwordx2 s[34:35], s[0:1], 40
    s_xor_b32 s29, s3, 1
    s_mul_i32 s29, s29, 134217728
    v_lshrrev_b32 v1, 6, v0
    v_and_b32 v0, 63, v0
    v_readfirstlane_b32 s40, v1
    s_and_b32 s43, s2, 7
    s_lshr_b32 s44, s2, 3
    s_and_b32 s41, s43, 1
    s_lshl_b32 s41, s41, 3
    s_and_b32 s42, s44, 7
    s_add_u32 s41, s41, s42
    s_lshr_b32 s42, s43, 1
    s_lshl_b32 s42, s42, 2
    s_lshr_b32 s44, s44, 3
    s_add_u32 s42, s42, s44
    s_mov_b32 s97, s40
    s_lshl_b32 s96, s41, 4
    s_add_u32 s96, s96, s42
    s_load_dwordx2 s[56:57], s[0:1], 48
    s_cmp_ge_u32 s40, 4
    s_cbranch_scc0 L_w1_compute
L_w1_loader:
    s_sub_u32 s51, s40, 4
    v_lshrrev_b32 v1, 3, v0
    v_lshrrev_b32 v2, 1, v1
    s_and_b32 s43, s51, 1
    s_lshl_b32 s44, s43, 2
    v_add_u32 v2, s44, v2
    v_and_b32 v3, 7, v0
    v_xor_b32 v2, v2, v3
    v_lshlrev_b32 v2, 4, v2
    s_lshl_b32 s44, s51, 3
    v_add_u32 v1, s44, v1
    s_lshl_b32 s46, s41, 7
    v_add_u32 v1, s46, v1
    v_lshrrev_b32 v3, 6, v2
    v_and_b32 v4, 48, v2
    v_lshl_add_u32 v4, v3, 17, v4
    v_lshl_add_u32 v8, v1, 6, v4
    v_add_u32 v9, 2048, v8
    v_add_u32 v10, 4096, v8
    v_add_u32 v11, 6144, v8
    s_cmp_lg_u32 s3, 0
    s_mov_b32 s61, 262144
    s_cselect_b32 s61, 128, s61
    v_lshrrev_b32 v1, 5, v0
    v_bfe_u32 v2, v0, 2, 2
    v_lshl_add_u32 v1, v1, 2, v2
    v_add_u32 v1, s44, v1
    v_mul_u32_u24 v1, 7168, v1
    v_and_b32 v2, 3, v0
    s_lshl_b32 s43, s43, 1
    v_xor_b32 v2, s43, v2
    v_bfe_u32 v3, v0, 4, 1
    v_lshl_add_u32 v2, v3, 2, v2
    v_lshl_add_u32 v1, v2, 4, v1
    s_mul_i32 s43, s42, 384
    v_add_u32 v1, s43, v1
    v_add_u32 v12, 0, v1
    v_add_u32 v13, 128, v1
    v_add_u32 v14, 256, v1
    v_add_u32 v15, 229376, v1
    v_add_u32 v16, 229504, v1
    v_add_u32 v17, 229632, v1
    v_lshrrev_b32 v1, 2, v0
    s_lshl_b32 s44, s51, 4
    v_add_u32 v1, s44, v1
    v_mul_u32_u24 v1, 7168, v1
    v_lshrrev_b32 v2, 5, v0
    v_lshlrev_b32 v2, 1, v2
    v_and_b32 v3, 3, v0
    v_xor_b32 v2, v2, v3
    v_lshl_add_u32 v1, v2, 4, v1
    s_lshl_b32 s43, s42, 6
    s_add_u32 s43, s43, 6144
    v_add_u32 v20, s43, v1
    s_lshl_b32 s53, s51, 10
    s_mul_i32 s54, s51, 3072
    s_add_u32 s54, s54, 16384
    s_mov_b32 s45, 0
    s_add_u32 s55, s41, s42
    s_and_b32 s55, s55, 15
    s_mul_i32 s55, s55, 1
    s_mul_i32 s55, s55, s3
    s_mov_b32 s55, 0
    s_mul_i32 s47, s55, 128
    s_mul_i32 s48, s55, 458752
    s_waitcnt lgkmcnt(0)
    s_add_u32 s8, s30, s29
    s_addc_u32 s9, s31, 0
    s_add_u32 s8, s8, 16777216
    s_addc_u32 s9, s9, 0
    s_and_b32 s9, s9, 0xffff
    s_mov_b32 s10, 4194304
    s_mov_b32 s11, 131072
    s_mov_b32 s12, s6
    s_and_b32 s13, s7, 0xffff
    s_mov_b32 s14, 7340032
    s_mov_b32 s15, 131072
    s_mov_b32 s46, 2
L_w1_wp7:
    s_add_u32 s49, s45, s53
    s_add_u32 s50, s45, s54
    s_add_u32 m0, s50, 0
    s_nop 0
    buffer_load_dwordx4 v12, s[12:15], s48 offen lds
    s_add_u32 m0, s50, 1024
    s_nop 0
    buffer_load_dwordx4 v13, s[12:15], s48 offen lds
    s_add_u32 m0, s50, 2048
    s_nop 0
    buffer_load_dwordx4 v14, s[12:15], s48 offen lds
    s_add_u32 m0, s50, 12288
    s_nop 0
    buffer_load_dwordx4 v15, s[12:15], s48 offen lds
    s_add_u32 m0, s50, 13312
    s_nop 0
    buffer_load_dwordx4 v16, s[12:15], s48 offen lds
    s_add_u32 m0, s50, 14336
    s_nop 0
    buffer_load_dwordx4 v17, s[12:15], s48 offen lds
    s_add_u32 m0, s49, 40960
    s_nop 0
    buffer_load_dwordx4 v20, s[12:15], s48 offen lds
    s_add_u32 s48, s48, 458752
    s_add_u32 s45, s45, 45056
    s_cmp_eq_u32 s45, 135168
    s_cselect_b32 s45, 0, s45
    s_sub_u32 s46, s46, 1
    s_cmp_lg_u32 s46, 0
    s_cbranch_scc1 L_w1_wp7
    s_cmp_eq_u32 s99, -1
    s_cbranch_scc1 L_w1_dwe8
    s_cmp_lg_u32 s97, 4
    s_cbranch_scc1 L_w1_dwb9
    s_add_u32 s64, s30, 65011712
    s_addc_u32 s65, s31, 0
    s_and_b32 s65, s65, 0xffff
    s_mov_b32 s66, 1048576
    s_mov_b32 s67, 131072
    v_lshlrev_b32 v76, 7, v0
    s_mov_b32 s46, 0x400000
    s_mov_b64 exec, 0xffff
L_w1_dwp10:
    buffer_load_dword v77, v76, s[64:67], s99 offen sc1
    s_waitcnt vmcnt(0)
    v_cmp_ne_u32 vcc, s95, v77
    s_sub_u32 s46, s46, 1
    s_cbranch_scc1 L_w1_dwg11
    s_nop 1
    s_cbranch_vccz L_w1_dwg11
    s_sleep 1
    s_branch L_w1_dwp10
L_w1_dwg11:
    s_mov_b64 exec, -1
L_w1_dwb9:
    s_barrier
L_w1_dwe8:
    s_mov_b32 s45, 0
    s_add_u32 s49, s45, s53
    s_add_u32 s50, s45, s54
    s_add_u32 m0, s49, 0
    s_nop 0
    buffer_load_dwordx4 v8, s[8:11], s47 offen lds
    s_add_u32 m0, s49, 4096
    s_nop 0
    buffer_load_dwordx4 v9, s[8:11], s47 offen lds
    s_add_u32 m0, s49, 8192
    s_nop 0
    buffer_load_dwordx4 v10, s[8:11], s47 offen lds
    s_add_u32 m0, s49, 12288
    s_nop 0
    buffer_load_dwordx4 v11, s[8:11], s47 offen lds
    s_add_u32 s47, s47, 262144
    s_add_u32 s45, s45, 45056
    s_cmp_eq_u32 s45, 135168
    s_cselect_b32 s45, 0, s45
    s_add_u32 s49, s45, s53
    s_add_u32 s50, s45, s54
    s_add_u32 m0, s49, 0
    s_nop 0
    buffer_load_dwordx4 v8, s[8:11], s47 offen lds
    s_add_u32 m0, s49, 4096
    s_nop 0
    buffer_load_dwordx4 v9, s[8:11], s47 offen lds
    s_add_u32 m0, s49, 8192
    s_nop 0
    buffer_load_dwordx4 v10, s[8:11], s47 offen lds
    s_add_u32 m0, s49, 12288
    s_nop 0
    buffer_load_dwordx4 v11, s[8:11], s47 offen lds
    s_add_u32 s47, s47, 262144
    s_add_u32 s45, s45, 45056
    s_cmp_eq_u32 s45, 135168
    s_cselect_b32 s45, 0, s45
    s_waitcnt vmcnt(4)
    s_barrier
    s_add_u32 s49, s45, s53
    s_add_u32 s50, s45, s54
    s_add_u32 m0, s49, 0
    s_nop 0
    buffer_load_dwordx4 v8, s[8:11], s47 offen lds
    s_add_u32 m0, s49, 4096
    s_nop 0
    buffer_load_dwordx4 v9, s[8:11], s47 offen lds
    s_add_u32 m0, s50, 0
    s_nop 0
    buffer_load_dwordx4 v12, s[12:15], s48 offen lds
    s_add_u32 m0, s50, 1024
    s_nop 0
    buffer_load_dwordx4 v13, s[12:15], s48 offen lds
    s_add_u32 m0, s50, 2048
    s_nop 0
    buffer_load_dwordx4 v14, s[12:15], s48 offen lds
    s_add_u32 m0, s49, 8192
    s_nop 0
    buffer_load_dwordx4 v10, s[8:11], s47 offen lds
    s_add_u32 m0, s49, 12288
    s_nop 0
    buffer_load_dwordx4 v11, s[8:11], s47 offen lds
    s_add_u32 m0, s50, 12288
    s_nop 0
    buffer_load_dwordx4 v15, s[12:15], s48 offen lds
    s_add_u32 m0, s50, 13312
    s_nop 0
    buffer_load_dwordx4 v16, s[12:15], s48 offen lds
    s_add_u32 m0, s50, 14336
    s_nop 0
    buffer_load_dwordx4 v17, s[12:15], s48 offen lds
    s_add_u32 m0, s49, 40960
    s_nop 0
    buffer_load_dwordx4 v20, s[12:15], s48 offen lds
    s_add_u32 s47, s47, 262144
    s_add_u32 s48, s48, 458752
    s_add_u32 s45, s45, 45056
    s_cmp_eq_u32 s45, 135168
    s_cselect_b32 s45, 0, s45
    s_mov_b32 s46, 13
L_w1_lloop:
    s_waitcnt vmcnt(11)
    s_barrier
    s_add_u32 s49, s45, s53
    s_add_u32 s50, s45, s54
    s_add_u32 m0, s49, 0
    s_nop 0
    buffer_load_dwordx4 v8, s[8:11], s47 offen lds
    s_add_u32 m0, s49, 4096
    s_nop 0
    buffer_load_dwordx4 v9, s[8:11], s47 offen lds
    s_add_u32 m0, s50, 0
    s_nop 0
    buffer_load_dwordx4 v12, s[12:15], s48 offen lds
    s_add_u32 m0, s50, 1024
    s_nop 0
    buffer_load_dwordx4 v13, s[12:15], s48 offen lds
    s_add_u32 m0, s50, 2048
    s_nop 0
    buffer_load_dwordx4 v14, s[12:15], s48 offen lds
    s_add_u32 m0, s49, 8192
    s_nop 0
    buffer_load_dwordx4 v10, s[8:11], s47 offen lds
    s_add_u32 m0, s49, 12288
    s_nop 0
    buffer_load_dwordx4 v11, s[8:11], s47 offen lds
    s_add_u32 m0, s50, 12288
    s_nop 0
    buffer_load_dwordx4 v15, s[12:15], s48 offen lds
    s_add_u32 m0, s50, 13312
    s_nop 0
    buffer_load_dwordx4 v16, s[12:15], s48 offen lds
    s_add_u32 m0, s50, 14336
    s_nop 0
    buffer_load_dwordx4 v17, s[12:15], s48 offen lds
    s_add_u32 m0, s49, 40960
    s_nop 0
    buffer_load_dwordx4 v20, s[12:15], s48 offen lds
    s_add_u32 s47, s47, 262144
    s_add_u32 s48, s48, 458752
    s_add_u32 s45, s45, 45056
    s_cmp_eq_u32 s45, 135168
    s_cselect_b32 s45, 0, s45
    s_sub_u32 s46, s46, 1
    s_cmp_lg_u32 s46, 0
    s_cbranch_scc1 L_w1_lloop
    s_add_u32 s24, s30, 37748736
    s_addc_u32 s25, s31, 0
    s_and_b32 s25, s25, 0xffff
    s_mov_b32 s26, 2097152
    s_mov_b32 s27, 131072
    s_mov_b32 s36, s34
    s_and_b32 s37, s35, 0xffff
    s_mov_b32 s38, 7168
    s_mov_b32 s39, 131072
    v_and_b32 v1, 31, v0
    s_lshl_b32 s43, s41, 7
    s_lshl_b32 s44, s51, 5
    s_add_u32 s43, s43, s44
    v_add_u32 v1, s43, v1
    v_lshlrev_b32 v1, 3, v1
    v_lshrrev_b32 v2, 5, v0
    v_lshl_add_u32 v1, v2, 17, v1
    s_lshl_b32 s43, s3, 18
    v_add_u32 v1, s43, v1
    s_mov_b32 s43, 262144
    buffer_load_dwordx2 v[24:25], v1, s[24:27], s43 offen
    s_mov_b32 s43, 278528
    buffer_load_dwordx2 v[26:27], v1, s[24:27], s43 offen
    s_mov_b32 s43, 294912
    buffer_load_dwordx2 v[28:29], v1, s[24:27], s43 offen
    s_mov_b32 s43, 311296
    buffer_load_dwordx2 v[30:31], v1, s[24:27], s43 offen
    s_mov_b32 s43, 327680
    buffer_load_dwordx2 v[32:33], v1, s[24:27], s43 offen
    s_mov_b32 s43, 344064
    buffer_load_dwordx2 v[34:35], v1, s[24:27], s43 offen
    s_mov_b32 s43, 360448
    buffer_load_dwordx2 v[36:37], v1, s[24:27], s43 offen
    s_mov_b32 s43, 376832
    buffer_load_dwordx2 v[38:39], v1, s[24:27], s43 offen
    s_mul_i32 s43, s42, 192
    s_lshl_b32 s44, s51, 6
    s_add_u32 s43, s43, s44
    s_lshl_b32 s44, s42, 5
    s_add_u32 s44, s44, 3072
    s_cmp_eq_u32 s51, 3
    s_cselect_b32 s43, s44, s43
    s_cselect_b32 s44, 31, 63
    v_and_b32 v2, s44, v0
    v_add_u32 v2, s43, v2
    v_lshlrev_b32 v3, 2, v2
    v_mov_b32 v47, v3
    s_cmp_lg_u32 s3, 0
    s_mov_b32 s43, 1310720
    s_cselect_b32 s43, 2146435072, s43
    buffer_load_dword v56, v3, s[24:27], s43 offen
    v_lshlrev_b32 v3, 1, v2
    buffer_load_ushort v48, v3, s[36:39], 0 offen
    s_waitcnt vmcnt(21)
    s_barrier
    s_waitcnt vmcnt(10)
    s_barrier
    s_cmp_lg_u32 s3, 0
    s_cbranch_scc1 L_w1_ool12
L_w1_back13:
    s_waitcnt vmcnt(0)
    v_add_f32 v1, v24, v26
    v_add_f32 v2, v28, v30
    v_add_f32 v3, v32, v34
    v_add_f32 v4, v36, v38
    v_add_f32 v1, v1, v2
    v_add_f32 v3, v3, v4
    v_add_f32 v1, v1, v3
    v_mul_f32 v1, 0.125, v1
    v_mov_b32 v2, 0
    v_sub_f32 v24, v24, v1
    v_fmac_f32 v2, v24, v24
    v_sub_f32 v26, v26, v1
    v_fmac_f32 v2, v26, v26
    v_sub_f32 v28, v28, v1
    v_fmac_f32 v2, v28, v28
    v_sub_f32 v30, v30, v1
    v_fmac_f32 v2, v30, v30
    v_sub_f32 v32, v32, v1
    v_fmac_f32 v2, v32, v32
    v_sub_f32 v34, v34, v1
    v_fmac_f32 v2, v34, v34
    v_sub_f32 v36, v36, v1
    v_fmac_f32 v2, v36, v36
    v_sub_f32 v38, v38, v1
    v_fmac_f32 v2, v38, v38
    v_mul_f32 v2, 0x42800000, v2
    v_add_f32 v2, v2, v25
    v_add_f32 v2, v2, v27
    v_add_f32 v2, v2, v29
    v_add_f32 v2, v2, v31
    v_add_f32 v2, v2, v33
    v_add_f32 v2, v2, v35
    v_add_f32 v2, v2, v37
    v_add_f32 v2, v2, v39
    v_mov_b32 v3, v1
    v_mov_b32 v4, v2
    s_nop 1
    v_permlane32_swap_b32 v1, v3
    v_permlane32_swap_b32 v2, v4
    v_sub_f32 v5, v1, v3
    v_add_f32 v1, v1, v3
    v_mul_f32 v1, 0.5, v1
    v_add_f32 v2, v2, v4
    v_mul_f32 v6, 0x43800000, v5
    v_fmac_f32 v2, v5, v6
    v_mul_f32 v2, 0x3a800000, v2
    v_add_f32 v3, 0x3727c5ac, v2
    v_rsq_f32 v50, v3
    s_nop 0
    v_mul_f32 v3, v50, v50
    v_mul_f32 v3, v3, v2
    v_add_f32 v3, 0x3727c5ac, v3
    v_rsq_f32 v3, v3
    s_nop 0
    v_mul_f32 v50, v50, v3
    v_mul_f32 v51, v50, v1
    v_sub_f32 v51, 0, v51
    v_lshlrev_b32 v48, 16, v48
    v_and_b32 v1, 31, v0
    s_lshl_b32 s43, s51, 8
    v_lshl_add_u32 v1, v1, 3, s43
    ds_write_b64 v1, v[50:51] offset:45056
    v_lshl_add_u32 v1, v0, 2, s43
    ds_write_b32 v1, v56 offset:46080
    ds_write_b32 v1, v48 offset:47104
    s_waitcnt lgkmcnt(0)
    s_barrier
    s_mov_b32 s60, s56
    s_and_b32 s61, s57, 0xffff
    s_mov_b32 s62, 7340032
    s_mov_b32 s63, 131072
    s_lshr_b32 s43, s2, 3
    s_and_b32 s43, s43, 31
    s_and_b32 s44, s2, 7
    s_mul_i32 s43, s43, 56
    s_lshr_b32 s44, s44, 2
    s_lshl_b32 s44, s44, 10
    s_add_u32 s44, s44, 384
    v_lshl_add_u32 v1, s51, 6, v0
    v_cmp_gt_u32 vcc, 56, v1
    v_add_u32 v1, s43, v1
    s_and_b32 s43, s2, 1
    s_mul_i32 s43, s43, 1792
    v_add_u32 v1, s43, v1
    v_mul_u32_u24 v5, 2048, v1
    v_add_u32 v5, s44, v5
    v_mov_b32 v1, 2146435072
    s_nop 0
    v_cndmask_b32 v5, v1, v5, vcc
    buffer_load_dword v6, v5, s[60:63], 0 offen
    s_lshr_b32 s43, s2, 3
    s_lshl_b32 s43, s43, 2
    s_add_u32 s43, s43, s51
    s_cmp_ge_u32 s43, 2
    s_cbranch_scc1 L_w1_nct15
    s_getpc_b64 s[64:65]
L_w1_pc14:
    s_sub_u32 s64, s64, L_w1_pc14-code_start
    s_subb_u32 s65, s65, 0
    v_lshl_add_u32 v2, s43, 6, v0
    v_lshlrev_b32 v2, 7, v2
    v_add_u32 v2, cs_w2-code_start, v2
    v_min_u32 v2, ce_w2-code_start-4, v2
    v_mov_b32 v3, s65
    v_add_co_u32 v2, vcc, s64, v2
    s_nop 1
    v_addc_co_u32 v3, vcc, 0, v3, vcc
    global_load_dword v7, v[2:3], off
L_w1_nct15:
    s_barrier
    s_branch L_sync_w1
L_w1_end:
    s_endpgm
L_w1_compute:
    s_lshr_b32 s51, s40, 1
    s_and_b32 s52, s40, 1
    v_and_b32 v1, 15, v0
    v_lshrrev_b32 v2, 4, v0
    v_lshrrev_b32 v3, 1, v1
    v_xor_b32 v3, v3, v2
    v_lshlrev_b32 v3, 4, v3
    v_lshl_add_u32 v7, v1, 7, v3
    s_lshl_b32 s43, s51, 13
    v_add_u32 v7, s43, v7
    v_xor_b32 v8, 64, v7
    v_lshrrev_b32 v3, 2, v1
    v_and_b32 v4, 3, v1
    v_lshlrev_b32 v3, 6, v3
    v_lshl_add_u32 v3, v4, 3, v3
    v_and_b32 v4, 1, v2
    v_lshl_add_u32 v5, v4, 5, v3
    v_mul_u32_u24 v6, 3072, v2
    v_add_u32 v9, v5, v6
    s_lshl_b32 s43, s52, 8
    s_add_u32 s43, s43, 16384
    v_add_u32 v9, s43, v9
    v_xor_b32 v10, 32, v9
    v_xor_b32 v4, s52, v4
    v_lshl_add_u32 v5, v4, 5, v3
    v_lshl_add_u32 v11, v2, 9, v5
    v_add_u32 v11, 40960, v11
    s_waitcnt lgkmcnt(0)
    s_add_u32 s16, s30, s29
    s_addc_u32 s17, s31, 0
    s_add_u32 s16, s16, 20971520
    s_addc_u32 s17, s17, 0
    s_and_b32 s17, s17, 0xffff
    s_mov_b32 s18, 14680064
    s_mov_b32 s19, 131072
    s_add_u32 s24, s30, 37748736
    s_addc_u32 s25, s31, 0
    s_and_b32 s25, s25, 0xffff
    s_mov_b32 s26, 2097152
    s_mov_b32 s27, 131072
    s_mov_b32 s36, s34
    s_and_b32 s37, s35, 0xffff
    s_mov_b32 s38, 7168
    s_mov_b32 s39, 131072
    v_mov_b32 v20, 0
    v_mov_b32 v21, 0
    v_mov_b32 v22, 0
    v_mov_b32 v23, 0
    v_mov_b32 v24, 0
    v_mov_b32 v25, 0
    v_mov_b32 v26, 0
    v_mov_b32 v27, 0
    v_mov_b32 v28, 0
    v_mov_b32 v29, 0
    v_mov_b32 v30, 0
    v_mov_b32 v31, 0
    v_mov_b32 v32, 0
    v_mov_b32 v33, 0
    v_mov_b32 v34, 0
    v_mov_b32 v35, 0
    v_mov_b32 v36, 0
    v_mov_b32 v37, 0
    v_mov_b32 v38, 0
    v_mov_b32 v39, 0
    v_mov_b32 v40, 0
    v_mov_b32 v41, 0
    v_mov_b32 v42, 0
    v_mov_b32 v43, 0
    v_mov_b32 v44, 0
    v_mov_b32 v45, 0
    v_mov_b32 v46, 0
    v_mov_b32 v47, 0
    v_mov_b32 v48, 0
    v_mov_b32 v49, 0
    v_mov_b32 v50, 0
    v_mov_b32 v51, 0
    v_mov_b32 v52, 0
    v_mov_b32 v53, 0
    v_mov_b32 v54, 0
    v_mov_b32 v55, 0
    v_mov_b32 v56, 0
    v_mov_b32 v57, 0
    v_mov_b32 v58, 0
    v_mov_b32 v59, 0
    v_mov_b32 v60, 0
    v_mov_b32 v61, 0
    v_mov_b32 v62, 0
    v_mov_b32 v63, 0
    v_mov_b32 v64, 0
    v_mov_b32 v65, 0
    v_mov_b32 v66, 0
    v_mov_b32 v67, 0
    v_mov_b32 v68, 0
    v_mov_b32 v69, 0
    v_mov_b32 v70, 0
    v_mov_b32 v71, 0
    v_mov_b32 v72, 0
    v_mov_b32 v73, 0
    v_mov_b32 v74, 0
    v_mov_b32 v75, 0
    v_mov_b32 v76, 0
    v_mov_b32 v77, 0
    v_mov_b32 v78, 0
    v_mov_b32 v79, 0
    v_mov_b32 v80, 0
    v_mov_b32 v81, 0
    v_mov_b32 v82, 0
    v_mov_b32 v83, 0
    v_mov_b32 v84, 0
    v_mov_b32 v85, 0
    v_mov_b32 v86, 0
    v_mov_b32 v87, 0
    v_mov_b32 v88, 0
    v_mov_b32 v89, 0
    v_mov_b32 v90, 0
    v_mov_b32 v91, 0
    v_mov_b32 v92, 0
    v_mov_b32 v93, 0
    v_mov_b32 v94, 0
    v_mov_b32 v95, 0
    v_mov_b32 v96, 0
    v_mov_b32 v97, 0
    v_mov_b32 v98, 0
    v_mov_b32 v99, 0
    v_mov_b32 v100, 0
    v_mov_b32 v101, 0
    v_mov_b32 v102, 0
    v_mov_b32 v103, 0
    v_mov_b32 v104, 0
    v_mov_b32 v105, 0
    v_mov_b32 v106, 0
    v_mov_b32 v107, 0
    v_mov_b32 v108, 0
    v_mov_b32 v109, 0
    v_mov_b32 v110, 0
    v_mov_b32 v111, 0
    v_mov_b32 v112, 0
    v_mov_b32 v113, 0
    v_mov_b32 v114, 0
    v_mov_b32 v115, 0
    v_mov_b32 v116, 0
    v_mov_b32 v117, 0
    v_mov_b32 v118, 0
    v_mov_b32 v119, 0
    v_mov_b32 v120, 0
    v_mov_b32 v121, 0
    v_mov_b32 v122, 0
    v_mov_b32 v123, 0
    v_mov_b32 v124, 0
    v_mov_b32 v125, 0
    v_mov_b32 v126, 0
    v_mov_b32 v127, 0
    v_mov_b32 v128, 0
    v_mov_b32 v129, 0
    v_mov_b32 v130, 0
    v_mov_b32 v131, 0
    s_mov_b32 s45, 0
    s_cmp_eq_u32 s99, -1
    s_cbranch_scc1 L_w1_dwe1
    s_barrier
L_w1_dwe1:
    v_mov_b32 v220, 0
    v_mov_b32 v221, 0
    v_mov_b32 v222, 0
    v_mov_b32 v223, 0
    v_mov_b32 v224, 0
    v_mov_b32 v225, 0
    v_mov_b32 v226, 0
    v_mov_b32 v227, 0
    v_mov_b32 v228, 0
    v_mov_b32 v229, 0
    v_mov_b32 v230, 0
    v_mov_b32 v231, 0
    v_mov_b32 v232, 0
    v_mov_b32 v233, 0
    v_mov_b32 v234, 0
    v_mov_b32 v235, 0
    v_mov_b32 v236, 0
    v_mov_b32 v237, 0
    v_mov_b32 v238, 0
    v_mov_b32 v239, 0
    v_mov_b32 v240, 0
    v_mov_b32 v241, 0
    v_mov_b32 v242, 0
    v_mov_b32 v243, 0
    v_mov_b32 v244, 0
    v_mov_b32 v245, 0
    v_mov_b32 v246, 0
    v_mov_b32 v247, 0
    v_mov_b32 v248, 0x3f803f80
    v_mov_b32 v249, 0x3f803f80
    v_mov_b32 v250, 0x3f803f80
    v_mov_b32 v251, 0x3f803f80
    s_mov_b32 s46, 15
    v_add_u32 v12, s45, v7
    v_add_u32 v13, s45, v8
    v_add_u32 v14, s45, v9
    v_add_u32 v15, s45, v10
    v_add_u32 v16, s45, v11
    s_barrier
    ds_read_b128 v[132:135], v12 offset:0
    ds_read_b64_tr_b16 v[148:149], v14 offset:0
    ds_read_b64_tr_b16 v[150:151], v14 offset:512
    ds_read_b64_tr_b16 v[152:153], v15 offset:0
    ds_read_b64_tr_b16 v[154:155], v15 offset:512
    ds_read_b128 v[136:139], v12 offset:2048
    ds_read_b128 v[140:143], v12 offset:4096
    ds_read_b128 v[144:147], v12 offset:6144
    ds_read_b64_tr_b16 v[156:157], v14 offset:1024
    ds_read_b64_tr_b16 v[158:159], v14 offset:1536
    ds_read_b64_tr_b16 v[160:161], v15 offset:1024
    ds_read_b64_tr_b16 v[162:163], v15 offset:1536
    ds_read_b64_tr_b16 v[164:165], v14 offset:2048
    ds_read_b64_tr_b16 v[166:167], v14 offset:2560
    ds_read_b64_tr_b16 v[168:169], v15 offset:2048
    ds_read_b64_tr_b16 v[170:171], v15 offset:2560
    ds_read_b64_tr_b16 v[172:173], v16 offset:0
    ds_read_b64_tr_b16 v[174:175], v16 offset:256
    s_cmp_lg_u32 s3, 0
    s_cbranch_scc1 L_w1_selfloops
L_w1_cloop:
    s_waitcnt lgkmcnt(0)
    v_mfma_f32_16x16x32_bf16 v[20:23], v[148:151], v[132:135], v[20:23]
    ds_read_b128 v[176:179], v13 offset:0
    v_mfma_f32_16x16x32_bf16 v[48:51], v[148:151], v[136:139], v[48:51]
    ds_read_b64_tr_b16 v[192:193], v14 offset:12288
    v_mfma_f32_16x16x32_bf16 v[76:79], v[148:151], v[140:143], v[76:79]
    ds_read_b64_tr_b16 v[194:195], v14 offset:12800
    v_mfma_f32_16x16x32_bf16 v[104:107], v[148:151], v[144:147], v[104:107]
    v_mfma_f32_16x16x32_bf16 v[24:27], v[152:155], v[132:135], v[24:27]
    ds_read_b64_tr_b16 v[196:197], v15 offset:12288
    v_mfma_f32_16x16x32_bf16 v[52:55], v[152:155], v[136:139], v[52:55]
    ds_read_b64_tr_b16 v[198:199], v15 offset:12800
    v_mfma_f32_16x16x32_bf16 v[80:83], v[152:155], v[140:143], v[80:83]
    ds_read_b128 v[180:183], v13 offset:2048
    v_mfma_f32_16x16x32_bf16 v[108:111], v[152:155], v[144:147], v[108:111]
    v_mfma_f32_16x16x32_bf16 v[28:31], v[156:159], v[132:135], v[28:31]
    ds_read_b128 v[184:187], v13 offset:4096
    v_mfma_f32_16x16x32_bf16 v[56:59], v[156:159], v[136:139], v[56:59]
    ds_read_b128 v[188:191], v13 offset:6144
    v_mfma_f32_16x16x32_bf16 v[84:87], v[156:159], v[140:143], v[84:87]
    ds_read_b64_tr_b16 v[200:201], v14 offset:13312
    v_mfma_f32_16x16x32_bf16 v[112:115], v[156:159], v[144:147], v[112:115]
    v_mfma_f32_16x16x32_bf16 v[32:35], v[160:163], v[132:135], v[32:35]
    ds_read_b64_tr_b16 v[202:203], v14 offset:13824
    v_mfma_f32_16x16x32_bf16 v[60:63], v[160:163], v[136:139], v[60:63]
    ds_read_b64_tr_b16 v[204:205], v15 offset:13312
    v_mfma_f32_16x16x32_bf16 v[88:91], v[160:163], v[140:143], v[88:91]
    ds_read_b64_tr_b16 v[206:207], v15 offset:13824
    v_mfma_f32_16x16x32_bf16 v[116:119], v[160:163], v[144:147], v[116:119]
    v_mfma_f32_16x16x32_bf16 v[36:39], v[164:167], v[132:135], v[36:39]
    ds_read_b64_tr_b16 v[208:209], v14 offset:14336
    v_mfma_f32_16x16x32_bf16 v[64:67], v[164:167], v[136:139], v[64:67]
    ds_read_b64_tr_b16 v[210:211], v14 offset:14848
    v_mfma_f32_16x16x32_bf16 v[92:95], v[164:167], v[140:143], v[92:95]
    ds_read_b64_tr_b16 v[212:213], v15 offset:14336
    v_mfma_f32_16x16x32_bf16 v[120:123], v[164:167], v[144:147], v[120:123]
    v_mfma_f32_16x16x32_bf16 v[40:43], v[168:171], v[132:135], v[40:43]
    ds_read_b64_tr_b16 v[214:215], v15 offset:14848
    v_mfma_f32_16x16x32_bf16 v[68:71], v[168:171], v[136:139], v[68:71]
    ds_read_b64_tr_b16 v[216:217], v16 offset:2048
    v_mfma_f32_16x16x32_bf16 v[96:99], v[168:171], v[140:143], v[96:99]
    ds_read_b64_tr_b16 v[218:219], v16 offset:2304
    v_mfma_f32_16x16x32_bf16 v[124:127], v[168:171], v[144:147], v[124:127]
    s_add_u32 s45, s45, 45056
    s_cmp_eq_u32 s45, 135168
    s_cselect_b32 s45, 0, s45
    v_add_u32 v12, s45, v7
    v_add_u32 v13, s45, v8
    v_add_u32 v14, s45, v9
    v_add_u32 v15, s45, v10
    v_add_u32 v16, s45, v11
    v_mfma_f32_16x16x32_bf16 v[44:47], v[172:175], v[132:135], v[44:47]
    v_mfma_f32_16x16x32_bf16 v[72:75], v[172:175], v[136:139], v[72:75]
    v_mfma_f32_16x16x32_bf16 v[100:103], v[172:175], v[140:143], v[100:103]
    v_mfma_f32_16x16x32_bf16 v[128:131], v[172:175], v[144:147], v[128:131]
    s_waitcnt lgkmcnt(0)
    s_barrier
    v_mfma_f32_16x16x32_bf16 v[20:23], v[192:195], v[176:179], v[20:23]
    ds_read_b128 v[132:135], v12 offset:0
    v_mfma_f32_16x16x32_bf16 v[48:51], v[192:195], v[180:183], v[48:51]
    ds_read_b64_tr_b16 v[148:149], v14 offset:0
    v_mfma_f32_16x16x32_bf16 v[76:79], v[192:195], v[184:187], v[76:79]
    ds_read_b64_tr_b16 v[150:151], v14 offset:512
    v_mfma_f32_16x16x32_bf16 v[104:107], v[192:195], v[188:191], v[104:107]
    v_mfma_f32_16x16x32_bf16 v[24:27], v[196:199], v[176:179], v[24:27]
    ds_read_b64_tr_b16 v[152:153], v15 offset:0
    v_mfma_f32_16x16x32_bf16 v[52:55], v[196:199], v[180:183], v[52:55]
    ds_read_b64_tr_b16 v[154:155], v15 offset:512
    v_mfma_f32_16x16x32_bf16 v[80:83], v[196:199], v[184:187], v[80:83]
    ds_read_b128 v[136:139], v12 offset:2048
    v_mfma_f32_16x16x32_bf16 v[108:111], v[196:199], v[188:191], v[108:111]
    v_mfma_f32_16x16x32_bf16 v[28:31], v[200:203], v[176:179], v[28:31]
    ds_read_b128 v[140:143], v12 offset:4096
    v_mfma_f32_16x16x32_bf16 v[56:59], v[200:203], v[180:183], v[56:59]
    ds_read_b128 v[144:147], v12 offset:6144
    v_mfma_f32_16x16x32_bf16 v[84:87], v[200:203], v[184:187], v[84:87]
    ds_read_b64_tr_b16 v[156:157], v14 offset:1024
    v_mfma_f32_16x16x32_bf16 v[112:115], v[200:203], v[188:191], v[112:115]
    v_mfma_f32_16x16x32_bf16 v[32:35], v[204:207], v[176:179], v[32:35]
    ds_read_b64_tr_b16 v[158:159], v14 offset:1536
    v_mfma_f32_16x16x32_bf16 v[60:63], v[204:207], v[180:183], v[60:63]
    ds_read_b64_tr_b16 v[160:161], v15 offset:1024
    v_mfma_f32_16x16x32_bf16 v[88:91], v[204:207], v[184:187], v[88:91]
    ds_read_b64_tr_b16 v[162:163], v15 offset:1536
    v_mfma_f32_16x16x32_bf16 v[116:119], v[204:207], v[188:191], v[116:119]
    v_mfma_f32_16x16x32_bf16 v[36:39], v[208:211], v[176:179], v[36:39]
    ds_read_b64_tr_b16 v[164:165], v14 offset:2048
    v_mfma_f32_16x16x32_bf16 v[64:67], v[208:211], v[180:183], v[64:67]
    ds_read_b64_tr_b16 v[166:167], v14 offset:2560
    v_mfma_f32_16x16x32_bf16 v[92:95], v[208:211], v[184:187], v[92:95]
    ds_read_b64_tr_b16 v[168:169], v15 offset:2048
    v_mfma_f32_16x16x32_bf16 v[120:123], v[208:211], v[188:191], v[120:123]
    v_mfma_f32_16x16x32_bf16 v[40:43], v[212:215], v[176:179], v[40:43]
    ds_read_b64_tr_b16 v[170:171], v15 offset:2560
    v_mfma_f32_16x16x32_bf16 v[68:71], v[212:215], v[180:183], v[68:71]
    ds_read_b64_tr_b16 v[172:173], v16 offset:0
    v_mfma_f32_16x16x32_bf16 v[96:99], v[212:215], v[184:187], v[96:99]
    ds_read_b64_tr_b16 v[174:175], v16 offset:256
    v_mfma_f32_16x16x32_bf16 v[124:127], v[212:215], v[188:191], v[124:127]
    s_sub_u32 s46, s46, 1
    s_cmp_lg_u32 s46, 0
    v_mfma_f32_16x16x32_bf16 v[44:47], v[216:219], v[176:179], v[44:47]
    v_mfma_f32_16x16x32_bf16 v[72:75], v[216:219], v[180:183], v[72:75]
    v_mfma_f32_16x16x32_bf16 v[100:103], v[216:219], v[184:187], v[100:103]
    v_mfma_f32_16x16x32_bf16 v[128:131], v[216:219], v[188:191], v[128:131]
    s_cbranch_scc1 L_w1_cloop
    s_waitcnt lgkmcnt(0)
    v_mfma_f32_16x16x32_bf16 v[20:23], v[148:151], v[132:135], v[20:23]
    ds_read_b128 v[176:179], v13 offset:0
    v_mfma_f32_16x16x32_bf16 v[48:51], v[148:151], v[136:139], v[48:51]
    ds_read_b64_tr_b16 v[192:193], v14 offset:12288
    v_mfma_f32_16x16x32_bf16 v[76:79], v[148:151], v[140:143], v[76:79]
    ds_read_b64_tr_b16 v[194:195], v14 offset:12800
    v_mfma_f32_16x16x32_bf16 v[104:107], v[148:151], v[144:147], v[104:107]
    v_mfma_f32_16x16x32_bf16 v[24:27], v[152:155], v[132:135], v[24:27]
    ds_read_b64_tr_b16 v[196:197], v15 offset:12288
    v_mfma_f32_16x16x32_bf16 v[52:55], v[152:155], v[136:139], v[52:55]
    ds_read_b64_tr_b16 v[198:199], v15 offset:12800
    v_mfma_f32_16x16x32_bf16 v[80:83], v[152:155], v[140:143], v[80:83]
    ds_read_b128 v[180:183], v13 offset:2048
    v_mfma_f32_16x16x32_bf16 v[108:111], v[152:155], v[144:147], v[108:111]
    v_mfma_f32_16x16x32_bf16 v[28:31], v[156:159], v[132:135], v[28:31]
    ds_read_b128 v[184:187], v13 offset:4096
    v_mfma_f32_16x16x32_bf16 v[56:59], v[156:159], v[136:139], v[56:59]
    ds_read_b128 v[188:191], v13 offset:6144
    v_mfma_f32_16x16x32_bf16 v[84:87], v[156:159], v[140:143], v[84:87]
    ds_read_b64_tr_b16 v[200:201], v14 offset:13312
    v_mfma_f32_16x16x32_bf16 v[112:115], v[156:159], v[144:147], v[112:115]
    v_mfma_f32_16x16x32_bf16 v[32:35], v[160:163], v[132:135], v[32:35]
    ds_read_b64_tr_b16 v[202:203], v14 offset:13824
    v_mfma_f32_16x16x32_bf16 v[60:63], v[160:163], v[136:139], v[60:63]
    ds_read_b64_tr_b16 v[204:205], v15 offset:13312
    v_mfma_f32_16x16x32_bf16 v[88:91], v[160:163], v[140:143], v[88:91]
    ds_read_b64_tr_b16 v[206:207], v15 offset:13824
    v_mfma_f32_16x16x32_bf16 v[116:119], v[160:163], v[144:147], v[116:119]
    v_mfma_f32_16x16x32_bf16 v[36:39], v[164:167], v[132:135], v[36:39]
    ds_read_b64_tr_b16 v[208:209], v14 offset:14336
    v_mfma_f32_16x16x32_bf16 v[64:67], v[164:167], v[136:139], v[64:67]
    ds_read_b64_tr_b16 v[210:211], v14 offset:14848
    v_mfma_f32_16x16x32_bf16 v[92:95], v[164:167], v[140:143], v[92:95]
    ds_read_b64_tr_b16 v[212:213], v15 offset:14336
    v_mfma_f32_16x16x32_bf16 v[120:123], v[164:167], v[144:147], v[120:123]
    v_mfma_f32_16x16x32_bf16 v[40:43], v[168:171], v[132:135], v[40:43]
    ds_read_b64_tr_b16 v[214:215], v15 offset:14848
    v_mfma_f32_16x16x32_bf16 v[68:71], v[168:171], v[136:139], v[68:71]
    ds_read_b64_tr_b16 v[216:217], v16 offset:2048
    v_mfma_f32_16x16x32_bf16 v[96:99], v[168:171], v[140:143], v[96:99]
    ds_read_b64_tr_b16 v[218:219], v16 offset:2304
    v_mfma_f32_16x16x32_bf16 v[124:127], v[168:171], v[144:147], v[124:127]
    v_mfma_f32_16x16x32_bf16 v[44:47], v[172:175], v[132:135], v[44:47]
    v_mfma_f32_16x16x32_bf16 v[72:75], v[172:175], v[136:139], v[72:75]
    v_mfma_f32_16x16x32_bf16 v[100:103], v[172:175], v[140:143], v[100:103]
    v_mfma_f32_16x16x32_bf16 v[128:131], v[172:175], v[144:147], v[128:131]
    s_waitcnt lgkmcnt(0)
    v_mfma_f32_16x16x32_bf16 v[20:23], v[192:195], v[176:179], v[20:23]
    v_mfma_f32_16x16x32_bf16 v[48:51], v[192:195], v[180:183], v[48:51]
    v_mfma_f32_16x16x32_bf16 v[76:79], v[192:195], v[184:187], v[76:79]
    v_mfma_f32_16x16x32_bf16 v[104:107], v[192:195], v[188:191], v[104:107]
    v_mfma_f32_16x16x32_bf16 v[24:27], v[196:199], v[176:179], v[24:27]
    v_mfma_f32_16x16x32_bf16 v[52:55], v[196:199], v[180:183], v[52:55]
    v_mfma_f32_16x16x32_bf16 v[80:83], v[196:199], v[184:187], v[80:83]
    v_mfma_f32_16x16x32_bf16 v[108:111], v[196:199], v[188:191], v[108:111]
    v_mfma_f32_16x16x32_bf16 v[28:31], v[200:203], v[176:179], v[28:31]
    v_mfma_f32_16x16x32_bf16 v[56:59], v[200:203], v[180:183], v[56:59]
    v_mfma_f32_16x16x32_bf16 v[84:87], v[200:203], v[184:187], v[84:87]
    v_mfma_f32_16x16x32_bf16 v[112:115], v[200:203], v[188:191], v[112:115]
    v_mfma_f32_16x16x32_bf16 v[32:35], v[204:207], v[176:179], v[32:35]
    v_mfma_f32_16x16x32_bf16 v[60:63], v[204:207], v[180:183], v[60:63]
    v_mfma_f32_16x16x32_bf16 v[88:91], v[204:207], v[184:187], v[88:91]
    v_mfma_f32_16x16x32_bf16 v[116:119], v[204:207], v[188:191], v[116:119]
    v_mfma_f32_16x16x32_bf16 v[36:39], v[208:211], v[176:179], v[36:39]
    v_mfma_f32_16x16x32_bf16 v[64:67], v[208:211], v[180:183], v[64:67]
    v_mfma_f32_16x16x32_bf16 v[92:95], v[208:211], v[184:187], v[92:95]
    v_mfma_f32_16x16x32_bf16 v[120:123], v[208:211], v[188:191], v[120:123]
    v_mfma_f32_16x16x32_bf16 v[40:43], v[212:215], v[176:179], v[40:43]
    v_mfma_f32_16x16x32_bf16 v[68:71], v[212:215], v[180:183], v[68:71]
    v_mfma_f32_16x16x32_bf16 v[96:99], v[212:215], v[184:187], v[96:99]
    v_mfma_f32_16x16x32_bf16 v[124:127], v[212:215], v[188:191], v[124:127]
    v_mfma_f32_16x16x32_bf16 v[44:47], v[216:219], v[176:179], v[44:47]
    v_mfma_f32_16x16x32_bf16 v[72:75], v[216:219], v[180:183], v[72:75]
    v_mfma_f32_16x16x32_bf16 v[100:103], v[216:219], v[184:187], v[100:103]
    v_mfma_f32_16x16x32_bf16 v[128:131], v[216:219], v[188:191], v[128:131]
L_w1_join:
    s_barrier
    s_lshl_b32 s43, s51, 9
    v_lshl_add_u32 v3, v1, 3, s43
    ds_read_b64 v[132:133], v3 offset:45056
    ds_read_b64 v[134:135], v3 offset:45184
    ds_read_b64 v[136:137], v3 offset:45312
    ds_read_b64 v[138:139], v3 offset:45440
    s_lshl_b32 s43, s52, 7
    v_lshl_add_u32 v3, v2, 4, s43
    ds_read_b128 v[140:143], v3 offset:46080
    ds_read_b128 v[168:171], v3 offset:47104
    ds_read_b128 v[144:147], v3 offset:46144
    ds_read_b128 v[172:175], v3 offset:47168
    ds_read_b128 v[148:151], v3 offset:46336
    ds_read_b128 v[176:179], v3 offset:47360
    ds_read_b128 v[152:155], v3 offset:46400
    ds_read_b128 v[180:183], v3 offset:47424
    ds_read_b128 v[156:159], v3 offset:46592
    ds_read_b128 v[184:187], v3 offset:47616
    ds_read_b128 v[160:163], v3 offset:46656
    ds_read_b128 v[188:191], v3 offset:47680
    s_lshl_b32 s43, s52, 6
    v_lshl_add_u32 v3, v2, 4, s43
    ds_read_b128 v[164:167], v3 offset:46848
    ds_read_b128 v[192:195], v3 offset:47872
    s_lshl_b32 s43, s41, 7
    s_lshl_b32 s44, s51, 6
    s_add_u32 s43, s43, s44
    v_add_u32 v5, s43, v1
    v_lshlrev_b32 v4, 6, v5
    v_and_b32 v204, 1, v2
    v_lshrrev_b32 v208, 1, v2
    v_lshl_add_u32 v4, v208, 4, v4
    v_lshl_add_u32 v6, v204, 10, v4
    s_add_u32 s43, s42, 96
    s_lshl_b32 s43, s43, 17
    s_lshl_b32 s44, s52, 5
    s_add_u32 s43, s43, s44
    v_add_u32 v6, s43, v6
    v_lshl_add_u32 v4, v204, 5, v4
    s_mul_i32 s43, s42, 6
    s_add_u32 s43, s43, s52
    s_lshl_b32 s43, s43, 17
    v_add_u32 v4, s43, v4
    s_mov_b32 s47, 0xc0135761
    s_mov_b32 s48, 0xbdd2d3e8
    v_mov_b32 v212, s48
    v_mov_b32 v213, s47
    v_mov_b32 v214, 1.0
    v_mov_b32 v215, 1.0
    s_waitcnt lgkmcnt(0)
    s_lshl_b32 s43, s51, 12
    s_lshl_b32 s44, s52, 5
    s_add_u32 s43, s43, s44
    v_lshl_add_u32 v3, v1, 6, s43
    v_and_b32 v5, 1, v2
    v_lshl_add_u32 v3, v5, 10, v3
    v_lshrrev_b32 v5, 1, v2
    v_lshl_add_u32 v3, v5, 4, v3
    v_pk_fma_f32 v[216:217], v[132:133], v[164:165], v[192:193] op_sel:[1,0,0] op_sel_hi:[1,1,1]
    v_pk_fma_f32 v[218:219], v[132:133], v[166:167], v[194:195] op_sel:[1,0,0] op_sel_hi:[1,1,1]
    v_pk_fma_f32 v[220:221], v[134:135], v[164:165], v[192:193] op_sel:[1,0,0] op_sel_hi:[1,1,1]
    v_pk_fma_f32 v[222:223], v[134:135], v[166:167], v[194:195] op_sel:[1,0,0] op_sel_hi:[1,1,1]
    v_pk_fma_f32 v[44:45], v[44:45], v[132:133], v[216:217] op_sel:[0,0,0] op_sel_hi:[1,0,1]
    v_pk_fma_f32 v[46:47], v[46:47], v[132:133], v[218:219] op_sel:[0,0,0] op_sel_hi:[1,0,1]
    v_pk_fma_f32 v[72:73], v[72:73], v[134:135], v[220:221] op_sel:[0,0,0] op_sel_hi:[1,0,1]
    v_pk_fma_f32 v[74:75], v[74:75], v[134:135], v[222:223] op_sel:[0,0,0] op_sel_hi:[1,0,1]
    v_pk_mul_f32 v[216:217], v[44:45], v[44:45]
    v_pk_mul_f32 v[218:219], v[46:47], v[46:47]
    v_pk_mul_f32 v[220:221], v[72:73], v[72:73]
    v_pk_mul_f32 v[222:223], v[74:75], v[74:75]
    v_pk_fma_f32 v[216:217], v[216:217], v[212:213], v[212:213] op_sel:[0,0,1] op_sel_hi:[1,0,1]
    v_pk_fma_f32 v[218:219], v[218:219], v[212:213], v[212:213] op_sel:[0,0,1] op_sel_hi:[1,0,1]
    v_pk_fma_f32 v[220:221], v[220:221], v[212:213], v[212:213] op_sel:[0,0,1] op_sel_hi:[1,0,1]
    v_pk_fma_f32 v[222:223], v[222:223], v[212:213], v[212:213] op_sel:[0,0,1] op_sel_hi:[1,0,1]
    v_pk_mul_f32 v[216:217], v[216:217], v[44:45]
    v_pk_mul_f32 v[218:219], v[218:219], v[46:47]
    v_pk_mul_f32 v[220:221], v[220:221], v[72:73]
    v_pk_mul_f32 v[222:223], v[222:223], v[74:75]
    v_exp_f32 v216, v216
    v_exp_f32 v217, v217
    v_exp_f32 v218, v218
    v_exp_f32 v219, v219
    v_exp_f32 v220, v220
    v_exp_f32 v221, v221
    v_exp_f32 v222, v222
    v_exp_f32 v223, v223
    v_pk_add_f32 v[216:217], v[216:217], v[214:215]
    v_pk_add_f32 v[218:219], v[218:219], v[214:215]
    v_pk_add_f32 v[220:221], v[220:221], v[214:215]
    v_pk_add_f32 v[222:223], v[222:223], v[214:215]
    v_rcp_f32 v216, v216
    v_rcp_f32 v217, v217
    v_rcp_f32 v218, v218
    v_rcp_f32 v219, v219
    v_rcp_f32 v220, v220
    v_rcp_f32 v221, v221
    v_rcp_f32 v222, v222
    v_rcp_f32 v223, v223
    v_pk_mul_f32 v[44:45], v[44:45], v[216:217]
    v_pk_mul_f32 v[46:47], v[46:47], v[218:219]
    v_pk_mul_f32 v[72:73], v[72:73], v[220:221]
    v_pk_mul_f32 v[74:75], v[74:75], v[222:223]
    v_cvt_pk_bf16_f32 v196, v44, v45
    v_cvt_pk_bf16_f32 v197, v46, v47
    v_cvt_pk_bf16_f32 v198, v72, v73
    v_cvt_pk_bf16_f32 v199, v74, v75
    s_nop 1
    v_permlane16_swap_b32 v196, v198
    v_permlane16_swap_b32 v197, v199
    ds_write_b128 v3, v[196:199] offset:53248
    v_pk_fma_f32 v[216:217], v[136:137], v[164:165], v[192:193] op_sel:[1,0,0] op_sel_hi:[1,1,1]
    v_pk_fma_f32 v[218:219], v[136:137], v[166:167], v[194:195] op_sel:[1,0,0] op_sel_hi:[1,1,1]
    v_pk_fma_f32 v[220:221], v[138:139], v[164:165], v[192:193] op_sel:[1,0,0] op_sel_hi:[1,1,1]
    v_pk_fma_f32 v[222:223], v[138:139], v[166:167], v[194:195] op_sel:[1,0,0] op_sel_hi:[1,1,1]
    v_pk_fma_f32 v[100:101], v[100:101], v[136:137], v[216:217] op_sel:[0,0,0] op_sel_hi:[1,0,1]
    v_pk_fma_f32 v[102:103], v[102:103], v[136:137], v[218:219] op_sel:[0,0,0] op_sel_hi:[1,0,1]
    v_pk_fma_f32 v[128:129], v[128:129], v[138:139], v[220:221] op_sel:[0,0,0] op_sel_hi:[1,0,1]
    v_pk_fma_f32 v[130:131], v[130:131], v[138:139], v[222:223] op_sel:[0,0,0] op_sel_hi:[1,0,1]
    v_pk_mul_f32 v[216:217], v[100:101], v[100:101]
    v_pk_mul_f32 v[218:219], v[102:103], v[102:103]
    v_pk_mul_f32 v[220:221], v[128:129], v[128:129]
    v_pk_mul_f32 v[222:223], v[130:131], v[130:131]
    v_pk_fma_f32 v[216:217], v[216:217], v[212:213], v[212:213] op_sel:[0,0,1] op_sel_hi:[1,0,1]
    v_pk_fma_f32 v[218:219], v[218:219], v[212:213], v[212:213] op_sel:[0,0,1] op_sel_hi:[1,0,1]
    v_pk_fma_f32 v[220:221], v[220:221], v[212:213], v[212:213] op_sel:[0,0,1] op_sel_hi:[1,0,1]
    v_pk_fma_f32 v[222:223], v[222:223], v[212:213], v[212:213] op_sel:[0,0,1] op_sel_hi:[1,0,1]
    v_pk_mul_f32 v[216:217], v[216:217], v[100:101]
    v_pk_mul_f32 v[218:219], v[218:219], v[102:103]
    v_pk_mul_f32 v[220:221], v[220:221], v[128:129]
    v_pk_mul_f32 v[222:223], v[222:223], v[130:131]
    v_exp_f32 v216, v216
    v_exp_f32 v217, v217
    v_exp_f32 v218, v218
    v_exp_f32 v219, v219
    v_exp_f32 v220, v220
    v_exp_f32 v221, v221
    v_exp_f32 v222, v222
    v_exp_f32 v223, v223
    v_pk_add_f32 v[216:217], v[216:217], v[214:215]
    v_pk_add_f32 v[218:219], v[218:219], v[214:215]
    v_pk_add_f32 v[220:221], v[220:221], v[214:215]
    v_pk_add_f32 v[222:223], v[222:223], v[214:215]
    v_rcp_f32 v216, v216
    v_rcp_f32 v217, v217
    v_rcp_f32 v218, v218
    v_rcp_f32 v219, v219
    v_rcp_f32 v220, v220
    v_rcp_f32 v221, v221
    v_rcp_f32 v222, v222
    v_rcp_f32 v223, v223
    v_pk_mul_f32 v[100:101], v[100:101], v[216:217]
    v_pk_mul_f32 v[102:103], v[102:103], v[218:219]
    v_pk_mul_f32 v[128:129], v[128:129], v[220:221]
    v_pk_mul_f32 v[130:131], v[130:131], v[222:223]
    v_cvt_pk_bf16_f32 v200, v100, v101
    v_cvt_pk_bf16_f32 v201, v102, v103
    v_cvt_pk_bf16_f32 v202, v128, v129
    v_cvt_pk_bf16_f32 v203, v130, v131
    s_nop 1
    v_permlane16_swap_b32 v200, v202
    v_permlane16_swap_b32 v201, v203
    ds_write_b128 v3, v[200:203] offset:55296
    s_mov_b32 s44, 0
    v_pk_fma_f32 v[216:217], v[132:133], v[140:141], v[168:169] op_sel:[1,0,0] op_sel_hi:[1,1,1]
    v_pk_fma_f32 v[218:219], v[132:133], v[142:143], v[170:171] op_sel:[1,0,0] op_sel_hi:[1,1,1]
    v_pk_fma_f32 v[220:221], v[132:133], v[144:145], v[172:173] op_sel:[1,0,0] op_sel_hi:[1,1,1]
    v_pk_fma_f32 v[222:223], v[132:133], v[146:147], v[174:175] op_sel:[1,0,0] op_sel_hi:[1,1,1]
    v_pk_fma_f32 v[20:21], v[20:21], v[132:133], v[216:217] op_sel:[0,0,0] op_sel_hi:[1,0,1]
    v_pk_fma_f32 v[22:23], v[22:23], v[132:133], v[218:219] op_sel:[0,0,0] op_sel_hi:[1,0,1]
    v_pk_fma_f32 v[24:25], v[24:25], v[132:133], v[220:221] op_sel:[0,0,0] op_sel_hi:[1,0,1]
    v_pk_fma_f32 v[26:27], v[26:27], v[132:133], v[222:223] op_sel:[0,0,0] op_sel_hi:[1,0,1]
    v_pk_mul_f32 v[216:217], v[20:21], v[20:21]
    v_pk_mul_f32 v[218:219], v[22:23], v[22:23]
    v_pk_mul_f32 v[220:221], v[24:25], v[24:25]
    v_pk_mul_f32 v[222:223], v[26:27], v[26:27]
    v_pk_fma_f32 v[216:217], v[216:217], v[212:213], v[212:213] op_sel:[0,0,1] op_sel_hi:[1,0,1]
    v_pk_fma_f32 v[218:219], v[218:219], v[212:213], v[212:213] op_sel:[0,0,1] op_sel_hi:[1,0,1]
    v_pk_fma_f32 v[220:221], v[220:221], v[212:213], v[212:213] op_sel:[0,0,1] op_sel_hi:[1,0,1]
    v_pk_fma_f32 v[222:223], v[222:223], v[212:213], v[212:213] op_sel:[0,0,1] op_sel_hi:[1,0,1]
    v_pk_mul_f32 v[216:217], v[216:217], v[20:21]
    v_pk_mul_f32 v[218:219], v[218:219], v[22:23]
    v_pk_mul_f32 v[220:221], v[220:221], v[24:25]
    v_pk_mul_f32 v[222:223], v[222:223], v[26:27]
    v_exp_f32 v216, v216
    v_exp_f32 v217, v217
    v_exp_f32 v218, v218
    v_exp_f32 v219, v219
    v_exp_f32 v220, v220
    v_exp_f32 v221, v221
    v_exp_f32 v222, v222
    v_exp_f32 v223, v223
    v_pk_add_f32 v[216:217], v[216:217], v[214:215]
    v_pk_add_f32 v[218:219], v[218:219], v[214:215]
    v_pk_add_f32 v[220:221], v[220:221], v[214:215]
    v_pk_add_f32 v[222:223], v[222:223], v[214:215]
    v_rcp_f32 v216, v216
    v_rcp_f32 v217, v217
    v_rcp_f32 v218, v218
    v_rcp_f32 v219, v219
    v_rcp_f32 v220, v220
    v_rcp_f32 v221, v221
    v_rcp_f32 v222, v222
    v_rcp_f32 v223, v223
    v_pk_mul_f32 v[20:21], v[20:21], v[216:217]
    v_pk_mul_f32 v[22:23], v[22:23], v[218:219]
    v_pk_mul_f32 v[24:25], v[24:25], v[220:221]
    v_pk_mul_f32 v[26:27], v[26:27], v[222:223]
    v_cvt_pk_bf16_f32 v196, v20, v21
    v_cvt_pk_bf16_f32 v197, v22, v23
    v_cvt_pk_bf16_f32 v198, v24, v25
    v_cvt_pk_bf16_f32 v199, v26, v27
    s_nop 1
    v_permlane16_swap_b32 v196, v198
    v_permlane16_swap_b32 v197, v199
    buffer_store_dwordx4 v[196:199], v4, s[16:19], s44 offen offset:0 sc1
    v_pk_fma_f32 v[216:217], v[134:135], v[140:141], v[168:169] op_sel:[1,0,0] op_sel_hi:[1,1,1]
    v_pk_fma_f32 v[218:219], v[134:135], v[142:143], v[170:171] op_sel:[1,0,0] op_sel_hi:[1,1,1]
    v_pk_fma_f32 v[220:221], v[134:135], v[144:145], v[172:173] op_sel:[1,0,0] op_sel_hi:[1,1,1]
    v_pk_fma_f32 v[222:223], v[134:135], v[146:147], v[174:175] op_sel:[1,0,0] op_sel_hi:[1,1,1]
    v_pk_fma_f32 v[48:49], v[48:49], v[134:135], v[216:217] op_sel:[0,0,0] op_sel_hi:[1,0,1]
    v_pk_fma_f32 v[50:51], v[50:51], v[134:135], v[218:219] op_sel:[0,0,0] op_sel_hi:[1,0,1]
    v_pk_fma_f32 v[52:53], v[52:53], v[134:135], v[220:221] op_sel:[0,0,0] op_sel_hi:[1,0,1]
    v_pk_fma_f32 v[54:55], v[54:55], v[134:135], v[222:223] op_sel:[0,0,0] op_sel_hi:[1,0,1]
    v_pk_mul_f32 v[216:217], v[48:49], v[48:49]
    v_pk_mul_f32 v[218:219], v[50:51], v[50:51]
    v_pk_mul_f32 v[220:221], v[52:53], v[52:53]
    v_pk_mul_f32 v[222:223], v[54:55], v[54:55]
    v_pk_fma_f32 v[216:217], v[216:217], v[212:213], v[212:213] op_sel:[0,0,1] op_sel_hi:[1,0,1]
    v_pk_fma_f32 v[218:219], v[218:219], v[212:213], v[212:213] op_sel:[0,0,1] op_sel_hi:[1,0,1]
    v_pk_fma_f32 v[220:221], v[220:221], v[212:213], v[212:213] op_sel:[0,0,1] op_sel_hi:[1,0,1]
    v_pk_fma_f32 v[222:223], v[222:223], v[212:213], v[212:213] op_sel:[0,0,1] op_sel_hi:[1,0,1]
    v_pk_mul_f32 v[216:217], v[216:217], v[48:49]
    v_pk_mul_f32 v[218:219], v[218:219], v[50:51]
    v_pk_mul_f32 v[220:221], v[220:221], v[52:53]
    v_pk_mul_f32 v[222:223], v[222:223], v[54:55]
    v_exp_f32 v216, v216
    v_exp_f32 v217, v217
    v_exp_f32 v218, v218
    v_exp_f32 v219, v219
    v_exp_f32 v220, v220
    v_exp_f32 v221, v221
    v_exp_f32 v222, v222
    v_exp_f32 v223, v223
    v_pk_add_f32 v[216:217], v[216:217], v[214:215]
    v_pk_add_f32 v[218:219], v[218:219], v[214:215]
    v_pk_add_f32 v[220:221], v[220:221], v[214:215]
    v_pk_add_f32 v[222:223], v[222:223], v[214:215]
    v_rcp_f32 v216, v216
    v_rcp_f32 v217, v217
    v_rcp_f32 v218, v218
    v_rcp_f32 v219, v219
    v_rcp_f32 v220, v220
    v_rcp_f32 v221, v221
    v_rcp_f32 v222, v222
    v_rcp_f32 v223, v223
    v_pk_mul_f32 v[48:49], v[48:49], v[216:217]
    v_pk_mul_f32 v[50:51], v[50:51], v[218:219]
    v_pk_mul_f32 v[52:53], v[52:53], v[220:221]
    v_pk_mul_f32 v[54:55], v[54:55], v[222:223]
    v_cvt_pk_bf16_f32 v200, v48, v49
    v_cvt_pk_bf16_f32 v201, v50, v51
    v_cvt_pk_bf16_f32 v202, v52, v53
    v_cvt_pk_bf16_f32 v203, v54, v55
    s_nop 1
    v_permlane16_swap_b32 v200, v202
    v_permlane16_swap_b32 v201, v203
    buffer_store_dwordx4 v[200:203], v4, s[16:19], s44 offen offset:1024 sc1
    v_pk_fma_f32 v[216:217], v[136:137], v[140:141], v[168:169] op_sel:[1,0,0] op_sel_hi:[1,1,1]
    v_pk_fma_f32 v[218:219], v[136:137], v[142:143], v[170:171] op_sel:[1,0,0] op_sel_hi:[1,1,1]
    v_pk_fma_f32 v[220:221], v[136:137], v[144:145], v[172:173] op_sel:[1,0,0] op_sel_hi:[1,1,1]
    v_pk_fma_f32 v[222:223], v[136:137], v[146:147], v[174:175] op_sel:[1,0,0] op_sel_hi:[1,1,1]
    v_pk_fma_f32 v[76:77], v[76:77], v[136:137], v[216:217] op_sel:[0,0,0] op_sel_hi:[1,0,1]
    v_pk_fma_f32 v[78:79], v[78:79], v[136:137], v[218:219] op_sel:[0,0,0] op_sel_hi:[1,0,1]
    v_pk_fma_f32 v[80:81], v[80:81], v[136:137], v[220:221] op_sel:[0,0,0] op_sel_hi:[1,0,1]
    v_pk_fma_f32 v[82:83], v[82:83], v[136:137], v[222:223] op_sel:[0,0,0] op_sel_hi:[1,0,1]
    v_pk_mul_f32 v[216:217], v[76:77], v[76:77]
    v_pk_mul_f32 v[218:219], v[78:79], v[78:79]
    v_pk_mul_f32 v[220:221], v[80:81], v[80:81]
    v_pk_mul_f32 v[222:223], v[82:83], v[82:83]
    v_pk_fma_f32 v[216:217], v[216:217], v[212:213], v[212:213] op_sel:[0,0,1] op_sel_hi:[1,0,1]
    v_pk_fma_f32 v[218:219], v[218:219], v[212:213], v[212:213] op_sel:[0,0,1] op_sel_hi:[1,0,1]
    v_pk_fma_f32 v[220:221], v[220:221], v[212:213], v[212:213] op_sel:[0,0,1] op_sel_hi:[1,0,1]
    v_pk_fma_f32 v[222:223], v[222:223], v[212:213], v[212:213] op_sel:[0,0,1] op_sel_hi:[1,0,1]
    v_pk_mul_f32 v[216:217], v[216:217], v[76:77]
    v_pk_mul_f32 v[218:219], v[218:219], v[78:79]
    v_pk_mul_f32 v[220:221], v[220:221], v[80:81]
    v_pk_mul_f32 v[222:223], v[222:223], v[82:83]
    v_exp_f32 v216, v216
    v_exp_f32 v217, v217
    v_exp_f32 v218, v218
    v_exp_f32 v219, v219
    v_exp_f32 v220, v220
    v_exp_f32 v221, v221
    v_exp_f32 v222, v222
    v_exp_f32 v223, v223
    v_pk_add_f32 v[216:217], v[216:217], v[214:215]
    v_pk_add_f32 v[218:219], v[218:219], v[214:215]
    v_pk_add_f32 v[220:221], v[220:221], v[214:215]
    v_pk_add_f32 v[222:223], v[222:223], v[214:215]
    v_rcp_f32 v216, v216
    v_rcp_f32 v217, v217
    v_rcp_f32 v218, v218
    v_rcp_f32 v219, v219
    v_rcp_f32 v220, v220
    v_rcp_f32 v221, v221
    v_rcp_f32 v222, v222
    v_rcp_f32 v223, v223
    v_pk_mul_f32 v[76:77], v[76:77], v[216:217]
    v_pk_mul_f32 v[78:79], v[78:79], v[218:219]
    v_pk_mul_f32 v[80:81], v[80:81], v[220:221]
    v_pk_mul_f32 v[82:83], v[82:83], v[222:223]
    v_cvt_pk_bf16_f32 v196, v76, v77
    v_cvt_pk_bf16_f32 v197, v78, v79
    v_cvt_pk_bf16_f32 v198, v80, v81
    v_cvt_pk_bf16_f32 v199, v82, v83
    s_nop 1
    v_permlane16_swap_b32 v196, v198
    v_permlane16_swap_b32 v197, v199
    buffer_store_dwordx4 v[196:199], v4, s[16:19], s44 offen offset:2048 sc1
    v_pk_fma_f32 v[216:217], v[138:139], v[140:141], v[168:169] op_sel:[1,0,0] op_sel_hi:[1,1,1]
    v_pk_fma_f32 v[218:219], v[138:139], v[142:143], v[170:171] op_sel:[1,0,0] op_sel_hi:[1,1,1]
    v_pk_fma_f32 v[220:221], v[138:139], v[144:145], v[172:173] op_sel:[1,0,0] op_sel_hi:[1,1,1]
    v_pk_fma_f32 v[222:223], v[138:139], v[146:147], v[174:175] op_sel:[1,0,0] op_sel_hi:[1,1,1]
    v_pk_fma_f32 v[104:105], v[104:105], v[138:139], v[216:217] op_sel:[0,0,0] op_sel_hi:[1,0,1]
    v_pk_fma_f32 v[106:107], v[106:107], v[138:139], v[218:219] op_sel:[0,0,0] op_sel_hi:[1,0,1]
    v_pk_fma_f32 v[108:109], v[108:109], v[138:139], v[220:221] op_sel:[0,0,0] op_sel_hi:[1,0,1]
    v_pk_fma_f32 v[110:111], v[110:111], v[138:139], v[222:223] op_sel:[0,0,0] op_sel_hi:[1,0,1]
    v_pk_mul_f32 v[216:217], v[104:105], v[104:105]
    v_pk_mul_f32 v[218:219], v[106:107], v[106:107]
    v_pk_mul_f32 v[220:221], v[108:109], v[108:109]
    v_pk_mul_f32 v[222:223], v[110:111], v[110:111]
    v_pk_fma_f32 v[216:217], v[216:217], v[212:213], v[212:213] op_sel:[0,0,1] op_sel_hi:[1,0,1]
    v_pk_fma_f32 v[218:219], v[218:219], v[212:213], v[212:213] op_sel:[0,0,1] op_sel_hi:[1,0,1]
    v_pk_fma_f32 v[220:221], v[220:221], v[212:213], v[212:213] op_sel:[0,0,1] op_sel_hi:[1,0,1]
    v_pk_fma_f32 v[222:223], v[222:223], v[212:213], v[212:213] op_sel:[0,0,1] op_sel_hi:[1,0,1]
    v_pk_mul_f32 v[216:217], v[216:217], v[104:105]
    v_pk_mul_f32 v[218:219], v[218:219], v[106:107]
    v_pk_mul_f32 v[220:221], v[220:221], v[108:109]
    v_pk_mul_f32 v[222:223], v[222:223], v[110:111]
    v_exp_f32 v216, v216
    v_exp_f32 v217, v217
    v_exp_f32 v218, v218
    v_exp_f32 v219, v219
    v_exp_f32 v220, v220
    v_exp_f32 v221, v221
    v_exp_f32 v222, v222
    v_exp_f32 v223, v223
    v_pk_add_f32 v[216:217], v[216:217], v[214:215]
    v_pk_add_f32 v[218:219], v[218:219], v[214:215]
    v_pk_add_f32 v[220:221], v[220:221], v[214:215]
    v_pk_add_f32 v[222:223], v[222:223], v[214:215]
    v_rcp_f32 v216, v216
    v_rcp_f32 v217, v217
    v_rcp_f32 v218, v218
    v_rcp_f32 v219, v219
    v_rcp_f32 v220, v220
    v_rcp_f32 v221, v221
    v_rcp_f32 v222, v222
    v_rcp_f32 v223, v223
    v_pk_mul_f32 v[104:105], v[104:105], v[216:217]
    v_pk_mul_f32 v[106:107], v[106:107], v[218:219]
    v_pk_mul_f32 v[108:109], v[108:109], v[220:221]
    v_pk_mul_f32 v[110:111], v[110:111], v[222:223]
    v_cvt_pk_bf16_f32 v200, v104, v105
    v_cvt_pk_bf16_f32 v201, v106, v107
    v_cvt_pk_bf16_f32 v202, v108, v109
    v_cvt_pk_bf16_f32 v203, v110, v111
    s_nop 1
    v_permlane16_swap_b32 v200, v202
    v_permlane16_swap_b32 v201, v203
    buffer_store_dwordx4 v[200:203], v4, s[16:19], s44 offen offset:3072 sc1
    s_waitcnt lgkmcnt(0)
    s_barrier
    s_lshl_b32 s43, s40, 11
    v_lshl_add_u32 v3, v0, 4, s43
    ds_read_b128 v[20:23], v3 offset:53248
    ds_read_b128 v[24:27], v3 offset:54272
    s_add_u32 s43, s42, 96
    s_lshl_b32 s43, s43, 17
    s_lshl_b32 s44, s41, 13
    s_add_u32 s43, s43, s44
    s_waitcnt lgkmcnt(0)
    buffer_store_dwordx4 v[20:23], v3, s[16:19], s43 offen offset:0 sc1
    buffer_store_dwordx4 v[24:27], v3, s[16:19], s43 offen offset:1024 sc1
    s_mov_b32 s44, 262144
    v_pk_fma_f32 v[216:217], v[132:133], v[148:149], v[176:177] op_sel:[1,0,0] op_sel_hi:[1,1,1]
    v_pk_fma_f32 v[218:219], v[132:133], v[150:151], v[178:179] op_sel:[1,0,0] op_sel_hi:[1,1,1]
    v_pk_fma_f32 v[220:221], v[132:133], v[152:153], v[180:181] op_sel:[1,0,0] op_sel_hi:[1,1,1]
    v_pk_fma_f32 v[222:223], v[132:133], v[154:155], v[182:183] op_sel:[1,0,0] op_sel_hi:[1,1,1]
    v_pk_fma_f32 v[28:29], v[28:29], v[132:133], v[216:217] op_sel:[0,0,0] op_sel_hi:[1,0,1]
    v_pk_fma_f32 v[30:31], v[30:31], v[132:133], v[218:219] op_sel:[0,0,0] op_sel_hi:[1,0,1]
    v_pk_fma_f32 v[32:33], v[32:33], v[132:133], v[220:221] op_sel:[0,0,0] op_sel_hi:[1,0,1]
    v_pk_fma_f32 v[34:35], v[34:35], v[132:133], v[222:223] op_sel:[0,0,0] op_sel_hi:[1,0,1]
    v_pk_mul_f32 v[216:217], v[28:29], v[28:29]
    v_pk_mul_f32 v[218:219], v[30:31], v[30:31]
    v_pk_mul_f32 v[220:221], v[32:33], v[32:33]
    v_pk_mul_f32 v[222:223], v[34:35], v[34:35]
    v_pk_fma_f32 v[216:217], v[216:217], v[212:213], v[212:213] op_sel:[0,0,1] op_sel_hi:[1,0,1]
    v_pk_fma_f32 v[218:219], v[218:219], v[212:213], v[212:213] op_sel:[0,0,1] op_sel_hi:[1,0,1]
    v_pk_fma_f32 v[220:221], v[220:221], v[212:213], v[212:213] op_sel:[0,0,1] op_sel_hi:[1,0,1]
    v_pk_fma_f32 v[222:223], v[222:223], v[212:213], v[212:213] op_sel:[0,0,1] op_sel_hi:[1,0,1]
    v_pk_mul_f32 v[216:217], v[216:217], v[28:29]
    v_pk_mul_f32 v[218:219], v[218:219], v[30:31]
    v_pk_mul_f32 v[220:221], v[220:221], v[32:33]
    v_pk_mul_f32 v[222:223], v[222:223], v[34:35]
    v_exp_f32 v216, v216
    v_exp_f32 v217, v217
    v_exp_f32 v218, v218
    v_exp_f32 v219, v219
    v_exp_f32 v220, v220
    v_exp_f32 v221, v221
    v_exp_f32 v222, v222
    v_exp_f32 v223, v223
    v_pk_add_f32 v[216:217], v[216:217], v[214:215]
    v_pk_add_f32 v[218:219], v[218:219], v[214:215]
    v_pk_add_f32 v[220:221], v[220:221], v[214:215]
    v_pk_add_f32 v[222:223], v[222:223], v[214:215]
    v_rcp_f32 v216, v216
    v_rcp_f32 v217, v217
    v_rcp_f32 v218, v218
    v_rcp_f32 v219, v219
    v_rcp_f32 v220, v220
    v_rcp_f32 v221, v221
    v_rcp_f32 v222, v222
    v_rcp_f32 v223, v223
    v_pk_mul_f32 v[28:29], v[28:29], v[216:217]
    v_pk_mul_f32 v[30:31], v[30:31], v[218:219]
    v_pk_mul_f32 v[32:33], v[32:33], v[220:221]
    v_pk_mul_f32 v[34:35], v[34:35], v[222:223]
    v_cvt_pk_bf16_f32 v196, v28, v29
    v_cvt_pk_bf16_f32 v197, v30, v31
    v_cvt_pk_bf16_f32 v198, v32, v33
    v_cvt_pk_bf16_f32 v199, v34, v35
    s_nop 1
    v_permlane16_swap_b32 v196, v198
    v_permlane16_swap_b32 v197, v199
    buffer_store_dwordx4 v[196:199], v4, s[16:19], s44 offen offset:0 sc1
    v_pk_fma_f32 v[216:217], v[134:135], v[148:149], v[176:177] op_sel:[1,0,0] op_sel_hi:[1,1,1]
    v_pk_fma_f32 v[218:219], v[134:135], v[150:151], v[178:179] op_sel:[1,0,0] op_sel_hi:[1,1,1]
    v_pk_fma_f32 v[220:221], v[134:135], v[152:153], v[180:181] op_sel:[1,0,0] op_sel_hi:[1,1,1]
    v_pk_fma_f32 v[222:223], v[134:135], v[154:155], v[182:183] op_sel:[1,0,0] op_sel_hi:[1,1,1]
    v_pk_fma_f32 v[56:57], v[56:57], v[134:135], v[216:217] op_sel:[0,0,0] op_sel_hi:[1,0,1]
    v_pk_fma_f32 v[58:59], v[58:59], v[134:135], v[218:219] op_sel:[0,0,0] op_sel_hi:[1,0,1]
    v_pk_fma_f32 v[60:61], v[60:61], v[134:135], v[220:221] op_sel:[0,0,0] op_sel_hi:[1,0,1]
    v_pk_fma_f32 v[62:63], v[62:63], v[134:135], v[222:223] op_sel:[0,0,0] op_sel_hi:[1,0,1]
    v_pk_mul_f32 v[216:217], v[56:57], v[56:57]
    v_pk_mul_f32 v[218:219], v[58:59], v[58:59]
    v_pk_mul_f32 v[220:221], v[60:61], v[60:61]
    v_pk_mul_f32 v[222:223], v[62:63], v[62:63]
    v_pk_fma_f32 v[216:217], v[216:217], v[212:213], v[212:213] op_sel:[0,0,1] op_sel_hi:[1,0,1]
    v_pk_fma_f32 v[218:219], v[218:219], v[212:213], v[212:213] op_sel:[0,0,1] op_sel_hi:[1,0,1]
    v_pk_fma_f32 v[220:221], v[220:221], v[212:213], v[212:213] op_sel:[0,0,1] op_sel_hi:[1,0,1]
    v_pk_fma_f32 v[222:223], v[222:223], v[212:213], v[212:213] op_sel:[0,0,1] op_sel_hi:[1,0,1]
    v_pk_mul_f32 v[216:217], v[216:217], v[56:57]
    v_pk_mul_f32 v[218:219], v[218:219], v[58:59]
    v_pk_mul_f32 v[220:221], v[220:221], v[60:61]
    v_pk_mul_f32 v[222:223], v[222:223], v[62:63]
    v_exp_f32 v216, v216
    v_exp_f32 v217, v217
    v_exp_f32 v218, v218
    v_exp_f32 v219, v219
    v_exp_f32 v220, v220
    v_exp_f32 v221, v221
    v_exp_f32 v222, v222
    v_exp_f32 v223, v223
    v_pk_add_f32 v[216:217], v[216:217], v[214:215]
    v_pk_add_f32 v[218:219], v[218:219], v[214:215]
    v_pk_add_f32 v[220:221], v[220:221], v[214:215]
    v_pk_add_f32 v[222:223], v[222:223], v[214:215]
    v_rcp_f32 v216, v216
    v_rcp_f32 v217, v217
    v_rcp_f32 v218, v218
    v_rcp_f32 v219, v219
    v_rcp_f32 v220, v220
    v_rcp_f32 v221, v221
    v_rcp_f32 v222, v222
    v_rcp_f32 v223, v223
    v_pk_mul_f32 v[56:57], v[56:57], v[216:217]
    v_pk_mul_f32 v[58:59], v[58:59], v[218:219]
    v_pk_mul_f32 v[60:61], v[60:61], v[220:221]
    v_pk_mul_f32 v[62:63], v[62:63], v[222:223]
    v_cvt_pk_bf16_f32 v200, v56, v57
    v_cvt_pk_bf16_f32 v201, v58, v59
    v_cvt_pk_bf16_f32 v202, v60, v61
    v_cvt_pk_bf16_f32 v203, v62, v63
    s_nop 1
    v_permlane16_swap_b32 v200, v202
    v_permlane16_swap_b32 v201, v203
    buffer_store_dwordx4 v[200:203], v4, s[16:19], s44 offen offset:1024 sc1
    v_pk_fma_f32 v[216:217], v[136:137], v[148:149], v[176:177] op_sel:[1,0,0] op_sel_hi:[1,1,1]
    v_pk_fma_f32 v[218:219], v[136:137], v[150:151], v[178:179] op_sel:[1,0,0] op_sel_hi:[1,1,1]
    v_pk_fma_f32 v[220:221], v[136:137], v[152:153], v[180:181] op_sel:[1,0,0] op_sel_hi:[1,1,1]
    v_pk_fma_f32 v[222:223], v[136:137], v[154:155], v[182:183] op_sel:[1,0,0] op_sel_hi:[1,1,1]
    v_pk_fma_f32 v[84:85], v[84:85], v[136:137], v[216:217] op_sel:[0,0,0] op_sel_hi:[1,0,1]
    v_pk_fma_f32 v[86:87], v[86:87], v[136:137], v[218:219] op_sel:[0,0,0] op_sel_hi:[1,0,1]
    v_pk_fma_f32 v[88:89], v[88:89], v[136:137], v[220:221] op_sel:[0,0,0] op_sel_hi:[1,0,1]
    v_pk_fma_f32 v[90:91], v[90:91], v[136:137], v[222:223] op_sel:[0,0,0] op_sel_hi:[1,0,1]
    v_pk_mul_f32 v[216:217], v[84:85], v[84:85]
    v_pk_mul_f32 v[218:219], v[86:87], v[86:87]
    v_pk_mul_f32 v[220:221], v[88:89], v[88:89]
    v_pk_mul_f32 v[222:223], v[90:91], v[90:91]
    v_pk_fma_f32 v[216:217], v[216:217], v[212:213], v[212:213] op_sel:[0,0,1] op_sel_hi:[1,0,1]
    v_pk_fma_f32 v[218:219], v[218:219], v[212:213], v[212:213] op_sel:[0,0,1] op_sel_hi:[1,0,1]
    v_pk_fma_f32 v[220:221], v[220:221], v[212:213], v[212:213] op_sel:[0,0,1] op_sel_hi:[1,0,1]
    v_pk_fma_f32 v[222:223], v[222:223], v[212:213], v[212:213] op_sel:[0,0,1] op_sel_hi:[1,0,1]
    v_pk_mul_f32 v[216:217], v[216:217], v[84:85]
    v_pk_mul_f32 v[218:219], v[218:219], v[86:87]
    v_pk_mul_f32 v[220:221], v[220:221], v[88:89]
    v_pk_mul_f32 v[222:223], v[222:223], v[90:91]
    v_exp_f32 v216, v216
    v_exp_f32 v217, v217
    v_exp_f32 v218, v218
    v_exp_f32 v219, v219
    v_exp_f32 v220, v220
    v_exp_f32 v221, v221
    v_exp_f32 v222, v222
    v_exp_f32 v223, v223
    v_pk_add_f32 v[216:217], v[216:217], v[214:215]
    v_pk_add_f32 v[218:219], v[218:219], v[214:215]
    v_pk_add_f32 v[220:221], v[220:221], v[214:215]
    v_pk_add_f32 v[222:223], v[222:223], v[214:215]
    v_rcp_f32 v216, v216
    v_rcp_f32 v217, v217
    v_rcp_f32 v218, v218
    v_rcp_f32 v219, v219
    v_rcp_f32 v220, v220
    v_rcp_f32 v221, v221
    v_rcp_f32 v222, v222
    v_rcp_f32 v223, v223
    v_pk_mul_f32 v[84:85], v[84:85], v[216:217]
    v_pk_mul_f32 v[86:87], v[86:87], v[218:219]
    v_pk_mul_f32 v[88:89], v[88:89], v[220:221]
    v_pk_mul_f32 v[90:91], v[90:91], v[222:223]
    v_cvt_pk_bf16_f32 v196, v84, v85
    v_cvt_pk_bf16_f32 v197, v86, v87
    v_cvt_pk_bf16_f32 v198, v88, v89
    v_cvt_pk_bf16_f32 v199, v90, v91
    s_nop 1
    v_permlane16_swap_b32 v196, v198
    v_permlane16_swap_b32 v197, v199
    buffer_store_dwordx4 v[196:199], v4, s[16:19], s44 offen offset:2048 sc1
    v_pk_fma_f32 v[216:217], v[138:139], v[148:149], v[176:177] op_sel:[1,0,0] op_sel_hi:[1,1,1]
    v_pk_fma_f32 v[218:219], v[138:139], v[150:151], v[178:179] op_sel:[1,0,0] op_sel_hi:[1,1,1]
    v_pk_fma_f32 v[220:221], v[138:139], v[152:153], v[180:181] op_sel:[1,0,0] op_sel_hi:[1,1,1]
    v_pk_fma_f32 v[222:223], v[138:139], v[154:155], v[182:183] op_sel:[1,0,0] op_sel_hi:[1,1,1]
    v_pk_fma_f32 v[112:113], v[112:113], v[138:139], v[216:217] op_sel:[0,0,0] op_sel_hi:[1,0,1]
    v_pk_fma_f32 v[114:115], v[114:115], v[138:139], v[218:219] op_sel:[0,0,0] op_sel_hi:[1,0,1]
    v_pk_fma_f32 v[116:117], v[116:117], v[138:139], v[220:221] op_sel:[0,0,0] op_sel_hi:[1,0,1]
    v_pk_fma_f32 v[118:119], v[118:119], v[138:139], v[222:223] op_sel:[0,0,0] op_sel_hi:[1,0,1]
    v_pk_mul_f32 v[216:217], v[112:113], v[112:113]
    v_pk_mul_f32 v[218:219], v[114:115], v[114:115]
    v_pk_mul_f32 v[220:221], v[116:117], v[116:117]
    v_pk_mul_f32 v[222:223], v[118:119], v[118:119]
    v_pk_fma_f32 v[216:217], v[216:217], v[212:213], v[212:213] op_sel:[0,0,1] op_sel_hi:[1,0,1]
    v_pk_fma_f32 v[218:219], v[218:219], v[212:213], v[212:213] op_sel:[0,0,1] op_sel_hi:[1,0,1]
    v_pk_fma_f32 v[220:221], v[220:221], v[212:213], v[212:213] op_sel:[0,0,1] op_sel_hi:[1,0,1]
    v_pk_fma_f32 v[222:223], v[222:223], v[212:213], v[212:213] op_sel:[0,0,1] op_sel_hi:[1,0,1]
    v_pk_mul_f32 v[216:217], v[216:217], v[112:113]
    v_pk_mul_f32 v[218:219], v[218:219], v[114:115]
    v_pk_mul_f32 v[220:221], v[220:221], v[116:117]
    v_pk_mul_f32 v[222:223], v[222:223], v[118:119]
    v_exp_f32 v216, v216
    v_exp_f32 v217, v217
    v_exp_f32 v218, v218
    v_exp_f32 v219, v219
    v_exp_f32 v220, v220
    v_exp_f32 v221, v221
    v_exp_f32 v222, v222
    v_exp_f32 v223, v223
    v_pk_add_f32 v[216:217], v[216:217], v[214:215]
    v_pk_add_f32 v[218:219], v[218:219], v[214:215]
    v_pk_add_f32 v[220:221], v[220:221], v[214:215]
    v_pk_add_f32 v[222:223], v[222:223], v[214:215]
    v_rcp_f32 v216, v216
    v_rcp_f32 v217, v217
    v_rcp_f32 v218, v218
    v_rcp_f32 v219, v219
    v_rcp_f32 v220, v220
    v_rcp_f32 v221, v221
    v_rcp_f32 v222, v222
    v_rcp_f32 v223, v223
    v_pk_mul_f32 v[112:113], v[112:113], v[216:217]
    v_pk_mul_f32 v[114:115], v[114:115], v[218:219]
    v_pk_mul_f32 v[116:117], v[116:117], v[220:221]
    v_pk_mul_f32 v[118:119], v[118:119], v[222:223]
    v_cvt_pk_bf16_f32 v200, v112, v113
    v_cvt_pk_bf16_f32 v201, v114, v115
    v_cvt_pk_bf16_f32 v202, v116, v117
    v_cvt_pk_bf16_f32 v203, v118, v119
    s_nop 1
    v_permlane16_swap_b32 v200, v202
    v_permlane16_swap_b32 v201, v203
    buffer_store_dwordx4 v[200:203], v4, s[16:19], s44 offen offset:3072 sc1
    s_mov_b32 s44, 524288
    v_pk_fma_f32 v[216:217], v[132:133], v[156:157], v[184:185] op_sel:[1,0,0] op_sel_hi:[1,1,1]
    v_pk_fma_f32 v[218:219], v[132:133], v[158:159], v[186:187] op_sel:[1,0,0] op_sel_hi:[1,1,1]
    v_pk_fma_f32 v[220:221], v[132:133], v[160:161], v[188:189] op_sel:[1,0,0] op_sel_hi:[1,1,1]
    v_pk_fma_f32 v[222:223], v[132:133], v[162:163], v[190:191] op_sel:[1,0,0] op_sel_hi:[1,1,1]
    v_pk_fma_f32 v[36:37], v[36:37], v[132:133], v[216:217] op_sel:[0,0,0] op_sel_hi:[1,0,1]
    v_pk_fma_f32 v[38:39], v[38:39], v[132:133], v[218:219] op_sel:[0,0,0] op_sel_hi:[1,0,1]
    v_pk_fma_f32 v[40:41], v[40:41], v[132:133], v[220:221] op_sel:[0,0,0] op_sel_hi:[1,0,1]
    v_pk_fma_f32 v[42:43], v[42:43], v[132:133], v[222:223] op_sel:[0,0,0] op_sel_hi:[1,0,1]
    v_pk_mul_f32 v[216:217], v[36:37], v[36:37]
    v_pk_mul_f32 v[218:219], v[38:39], v[38:39]
    v_pk_mul_f32 v[220:221], v[40:41], v[40:41]
    v_pk_mul_f32 v[222:223], v[42:43], v[42:43]
    v_pk_fma_f32 v[216:217], v[216:217], v[212:213], v[212:213] op_sel:[0,0,1] op_sel_hi:[1,0,1]
    v_pk_fma_f32 v[218:219], v[218:219], v[212:213], v[212:213] op_sel:[0,0,1] op_sel_hi:[1,0,1]
    v_pk_fma_f32 v[220:221], v[220:221], v[212:213], v[212:213] op_sel:[0,0,1] op_sel_hi:[1,0,1]
    v_pk_fma_f32 v[222:223], v[222:223], v[212:213], v[212:213] op_sel:[0,0,1] op_sel_hi:[1,0,1]
    v_pk_mul_f32 v[216:217], v[216:217], v[36:37]
    v_pk_mul_f32 v[218:219], v[218:219], v[38:39]
    v_pk_mul_f32 v[220:221], v[220:221], v[40:41]
    v_pk_mul_f32 v[222:223], v[222:223], v[42:43]
    v_exp_f32 v216, v216
    v_exp_f32 v217, v217
    v_exp_f32 v218, v218
    v_exp_f32 v219, v219
    v_exp_f32 v220, v220
    v_exp_f32 v221, v221
    v_exp_f32 v222, v222
    v_exp_f32 v223, v223
    v_pk_add_f32 v[216:217], v[216:217], v[214:215]
    v_pk_add_f32 v[218:219], v[218:219], v[214:215]
    v_pk_add_f32 v[220:221], v[220:221], v[214:215]
    v_pk_add_f32 v[222:223], v[222:223], v[214:215]
    v_rcp_f32 v216, v216
    v_rcp_f32 v217, v217
    v_rcp_f32 v218, v218
    v_rcp_f32 v219, v219
    v_rcp_f32 v220, v220
    v_rcp_f32 v221, v221
    v_rcp_f32 v222, v222
    v_rcp_f32 v223, v223
    v_pk_mul_f32 v[36:37], v[36:37], v[216:217]
    v_pk_mul_f32 v[38:39], v[38:39], v[218:219]
    v_pk_mul_f32 v[40:41], v[40:41], v[220:221]
    v_pk_mul_f32 v[42:43], v[42:43], v[222:223]
    v_cvt_pk_bf16_f32 v196, v36, v37
    v_cvt_pk_bf16_f32 v197, v38, v39
    v_cvt_pk_bf16_f32 v198, v40, v41
    v_cvt_pk_bf16_f32 v199, v42, v43
    s_nop 1
    v_permlane16_swap_b32 v196, v198
    v_permlane16_swap_b32 v197, v199
    buffer_store_dwordx4 v[196:199], v4, s[16:19], s44 offen offset:0 sc1
    v_pk_fma_f32 v[216:217], v[134:135], v[156:157], v[184:185] op_sel:[1,0,0] op_sel_hi:[1,1,1]
    v_pk_fma_f32 v[218:219], v[134:135], v[158:159], v[186:187] op_sel:[1,0,0] op_sel_hi:[1,1,1]
    v_pk_fma_f32 v[220:221], v[134:135], v[160:161], v[188:189] op_sel:[1,0,0] op_sel_hi:[1,1,1]
    v_pk_fma_f32 v[222:223], v[134:135], v[162:163], v[190:191] op_sel:[1,0,0] op_sel_hi:[1,1,1]
    v_pk_fma_f32 v[64:65], v[64:65], v[134:135], v[216:217] op_sel:[0,0,0] op_sel_hi:[1,0,1]
    v_pk_fma_f32 v[66:67], v[66:67], v[134:135], v[218:219] op_sel:[0,0,0] op_sel_hi:[1,0,1]
    v_pk_fma_f32 v[68:69], v[68:69], v[134:135], v[220:221] op_sel:[0,0,0] op_sel_hi:[1,0,1]
    v_pk_fma_f32 v[70:71], v[70:71], v[134:135], v[222:223] op_sel:[0,0,0] op_sel_hi:[1,0,1]
    v_pk_mul_f32 v[216:217], v[64:65], v[64:65]
    v_pk_mul_f32 v[218:219], v[66:67], v[66:67]
    v_pk_mul_f32 v[220:221], v[68:69], v[68:69]
    v_pk_mul_f32 v[222:223], v[70:71], v[70:71]
    v_pk_fma_f32 v[216:217], v[216:217], v[212:213], v[212:213] op_sel:[0,0,1] op_sel_hi:[1,0,1]
    v_pk_fma_f32 v[218:219], v[218:219], v[212:213], v[212:213] op_sel:[0,0,1] op_sel_hi:[1,0,1]
    v_pk_fma_f32 v[220:221], v[220:221], v[212:213], v[212:213] op_sel:[0,0,1] op_sel_hi:[1,0,1]
    v_pk_fma_f32 v[222:223], v[222:223], v[212:213], v[212:213] op_sel:[0,0,1] op_sel_hi:[1,0,1]
    v_pk_mul_f32 v[216:217], v[216:217], v[64:65]
    v_pk_mul_f32 v[218:219], v[218:219], v[66:67]
    v_pk_mul_f32 v[220:221], v[220:221], v[68:69]
    v_pk_mul_f32 v[222:223], v[222:223], v[70:71]
    v_exp_f32 v216, v216
    v_exp_f32 v217, v217
    v_exp_f32 v218, v218
    v_exp_f32 v219, v219
    v_exp_f32 v220, v220
    v_exp_f32 v221, v221
    v_exp_f32 v222, v222
    v_exp_f32 v223, v223
    v_pk_add_f32 v[216:217], v[216:217], v[214:215]
    v_pk_add_f32 v[218:219], v[218:219], v[214:215]
    v_pk_add_f32 v[220:221], v[220:221], v[214:215]
    v_pk_add_f32 v[222:223], v[222:223], v[214:215]
    v_rcp_f32 v216, v216
    v_rcp_f32 v217, v217
    v_rcp_f32 v218, v218
    v_rcp_f32 v219, v219
    v_rcp_f32 v220, v220
    v_rcp_f32 v221, v221
    v_rcp_f32 v222, v222
    v_rcp_f32 v223, v223
    v_pk_mul_f32 v[64:65], v[64:65], v[216:217]
    v_pk_mul_f32 v[66:67], v[66:67], v[218:219]
    v_pk_mul_f32 v[68:69], v[68:69], v[220:221]
    v_pk_mul_f32 v[70:71], v[70:71], v[222:223]
    v_cvt_pk_bf16_f32 v200, v64, v65
    v_cvt_pk_bf16_f32 v201, v66, v67
    v_cvt_pk_bf16_f32 v202, v68, v69
    v_cvt_pk_bf16_f32 v203, v70, v71
    s_nop 1
    v_permlane16_swap_b32 v200, v202
    v_permlane16_swap_b32 v201, v203
    buffer_store_dwordx4 v[200:203], v4, s[16:19], s44 offen offset:1024 sc1
    v_pk_fma_f32 v[216:217], v[136:137], v[156:157], v[184:185] op_sel:[1,0,0] op_sel_hi:[1,1,1]
    v_pk_fma_f32 v[218:219], v[136:137], v[158:159], v[186:187] op_sel:[1,0,0] op_sel_hi:[1,1,1]
    v_pk_fma_f32 v[220:221], v[136:137], v[160:161], v[188:189] op_sel:[1,0,0] op_sel_hi:[1,1,1]
    v_pk_fma_f32 v[222:223], v[136:137], v[162:163], v[190:191] op_sel:[1,0,0] op_sel_hi:[1,1,1]
    v_pk_fma_f32 v[92:93], v[92:93], v[136:137], v[216:217] op_sel:[0,0,0] op_sel_hi:[1,0,1]
    v_pk_fma_f32 v[94:95], v[94:95], v[136:137], v[218:219] op_sel:[0,0,0] op_sel_hi:[1,0,1]
    v_pk_fma_f32 v[96:97], v[96:97], v[136:137], v[220:221] op_sel:[0,0,0] op_sel_hi:[1,0,1]
    v_pk_fma_f32 v[98:99], v[98:99], v[136:137], v[222:223] op_sel:[0,0,0] op_sel_hi:[1,0,1]
    v_pk_mul_f32 v[216:217], v[92:93], v[92:93]
    v_pk_mul_f32 v[218:219], v[94:95], v[94:95]
    v_pk_mul_f32 v[220:221], v[96:97], v[96:97]
    v_pk_mul_f32 v[222:223], v[98:99], v[98:99]
    v_pk_fma_f32 v[216:217], v[216:217], v[212:213], v[212:213] op_sel:[0,0,1] op_sel_hi:[1,0,1]
    v_pk_fma_f32 v[218:219], v[218:219], v[212:213], v[212:213] op_sel:[0,0,1] op_sel_hi:[1,0,1]
    v_pk_fma_f32 v[220:221], v[220:221], v[212:213], v[212:213] op_sel:[0,0,1] op_sel_hi:[1,0,1]
    v_pk_fma_f32 v[222:223], v[222:223], v[212:213], v[212:213] op_sel:[0,0,1] op_sel_hi:[1,0,1]
    v_pk_mul_f32 v[216:217], v[216:217], v[92:93]
    v_pk_mul_f32 v[218:219], v[218:219], v[94:95]
    v_pk_mul_f32 v[220:221], v[220:221], v[96:97]
    v_pk_mul_f32 v[222:223], v[222:223], v[98:99]
    v_exp_f32 v216, v216
    v_exp_f32 v217, v217
    v_exp_f32 v218, v218
    v_exp_f32 v219, v219
    v_exp_f32 v220, v220
    v_exp_f32 v221, v221
    v_exp_f32 v222, v222
    v_exp_f32 v223, v223
    v_pk_add_f32 v[216:217], v[216:217], v[214:215]
    v_pk_add_f32 v[218:219], v[218:219], v[214:215]
    v_pk_add_f32 v[220:221], v[220:221], v[214:215]
    v_pk_add_f32 v[222:223], v[222:223], v[214:215]
    v_rcp_f32 v216, v216
    v_rcp_f32 v217, v217
    v_rcp_f32 v218, v218
    v_rcp_f32 v219, v219
    v_rcp_f32 v220, v220
    v_rcp_f32 v221, v221
    v_rcp_f32 v222, v222
    v_rcp_f32 v223, v223
    v_pk_mul_f32 v[92:93], v[92:93], v[216:217]
    v_pk_mul_f32 v[94:95], v[94:95], v[218:219]
    v_pk_mul_f32 v[96:97], v[96:97], v[220:221]
    v_pk_mul_f32 v[98:99], v[98:99], v[222:223]
    v_cvt_pk_bf16_f32 v196, v92, v93
    v_cvt_pk_bf16_f32 v197, v94, v95
    v_cvt_pk_bf16_f32 v198, v96, v97
    v_cvt_pk_bf16_f32 v199, v98, v99
    s_nop 1
    v_permlane16_swap_b32 v196, v198
    v_permlane16_swap_b32 v197, v199
    buffer_store_dwordx4 v[196:199], v4, s[16:19], s44 offen offset:2048 sc1
    v_pk_fma_f32 v[216:217], v[138:139], v[156:157], v[184:185] op_sel:[1,0,0] op_sel_hi:[1,1,1]
    v_pk_fma_f32 v[218:219], v[138:139], v[158:159], v[186:187] op_sel:[1,0,0] op_sel_hi:[1,1,1]
    v_pk_fma_f32 v[220:221], v[138:139], v[160:161], v[188:189] op_sel:[1,0,0] op_sel_hi:[1,1,1]
    v_pk_fma_f32 v[222:223], v[138:139], v[162:163], v[190:191] op_sel:[1,0,0] op_sel_hi:[1,1,1]
    v_pk_fma_f32 v[120:121], v[120:121], v[138:139], v[216:217] op_sel:[0,0,0] op_sel_hi:[1,0,1]
    v_pk_fma_f32 v[122:123], v[122:123], v[138:139], v[218:219] op_sel:[0,0,0] op_sel_hi:[1,0,1]
    v_pk_fma_f32 v[124:125], v[124:125], v[138:139], v[220:221] op_sel:[0,0,0] op_sel_hi:[1,0,1]
    v_pk_fma_f32 v[126:127], v[126:127], v[138:139], v[222:223] op_sel:[0,0,0] op_sel_hi:[1,0,1]
    v_pk_mul_f32 v[216:217], v[120:121], v[120:121]
    v_pk_mul_f32 v[218:219], v[122:123], v[122:123]
    v_pk_mul_f32 v[220:221], v[124:125], v[124:125]
    v_pk_mul_f32 v[222:223], v[126:127], v[126:127]
    v_pk_fma_f32 v[216:217], v[216:217], v[212:213], v[212:213] op_sel:[0,0,1] op_sel_hi:[1,0,1]
    v_pk_fma_f32 v[218:219], v[218:219], v[212:213], v[212:213] op_sel:[0,0,1] op_sel_hi:[1,0,1]
    v_pk_fma_f32 v[220:221], v[220:221], v[212:213], v[212:213] op_sel:[0,0,1] op_sel_hi:[1,0,1]
    v_pk_fma_f32 v[222:223], v[222:223], v[212:213], v[212:213] op_sel:[0,0,1] op_sel_hi:[1,0,1]
    v_pk_mul_f32 v[216:217], v[216:217], v[120:121]
    v_pk_mul_f32 v[218:219], v[218:219], v[122:123]
    v_pk_mul_f32 v[220:221], v[220:221], v[124:125]
    v_pk_mul_f32 v[222:223], v[222:223], v[126:127]
    v_exp_f32 v216, v216
    v_exp_f32 v217, v217
    v_exp_f32 v218, v218
    v_exp_f32 v219, v219
    v_exp_f32 v220, v220
    v_exp_f32 v221, v221
    v_exp_f32 v222, v222
    v_exp_f32 v223, v223
    v_pk_add_f32 v[216:217], v[216:217], v[214:215]
    v_pk_add_f32 v[218:219], v[218:219], v[214:215]
    v_pk_add_f32 v[220:221], v[220:221], v[214:215]
    v_pk_add_f32 v[222:223], v[222:223], v[214:215]
    v_rcp_f32 v216, v216
    v_rcp_f32 v217, v217
    v_rcp_f32 v218, v218
    v_rcp_f32 v219, v219
    v_rcp_f32 v220, v220
    v_rcp_f32 v221, v221
    v_rcp_f32 v222, v222
    v_rcp_f32 v223, v223
    v_pk_mul_f32 v[120:121], v[120:121], v[216:217]
    v_pk_mul_f32 v[122:123], v[122:123], v[218:219]
    v_pk_mul_f32 v[124:125], v[124:125], v[220:221]
    v_pk_mul_f32 v[126:127], v[126:127], v[222:223]
    v_cvt_pk_bf16_f32 v200, v120, v121
    v_cvt_pk_bf16_f32 v201, v122, v123
    v_cvt_pk_bf16_f32 v202, v124, v125
    v_cvt_pk_bf16_f32 v203, v126, v127
    s_nop 1
    v_permlane16_swap_b32 v200, v202
    v_permlane16_swap_b32 v201, v203
    buffer_store_dwordx4 v[200:203], v4, s[16:19], s44 offen offset:3072 sc1
    s_branch L_sync_w1
L_w1_selfloops:
    s_xor_b32 s43, s51, s52
    s_cmp_lg_u32 s43, 0
    s_cbranch_scc1 L_w1_slb5
L_w1_cloopa:
    s_waitcnt lgkmcnt(0)
    v_mfma_f32_16x16x32_bf16 v[20:23], v[148:151], v[132:135], v[20:23]
    ds_read_b128 v[176:179], v13 offset:0
    v_mfma_f32_16x16x32_bf16 v[48:51], v[148:151], v[136:139], v[48:51]
    ds_read_b64_tr_b16 v[192:193], v14 offset:12288
    v_mfma_f32_16x16x32_bf16 v[76:79], v[148:151], v[140:143], v[76:79]
    v_mfma_f32_16x16x32_bf16 v[104:107], v[148:151], v[144:147], v[104:107]
    ds_read_b64_tr_b16 v[194:195], v14 offset:12800
    v_mfma_f32_16x16x32_bf16 v[24:27], v[152:155], v[132:135], v[24:27]
    v_mfma_f32_16x16x32_bf16 v[52:55], v[152:155], v[136:139], v[52:55]
    ds_read_b64_tr_b16 v[196:197], v15 offset:12288
    v_mfma_f32_16x16x32_bf16 v[80:83], v[152:155], v[140:143], v[80:83]
    ds_read_b64_tr_b16 v[198:199], v15 offset:12800
    v_mfma_f32_16x16x32_bf16 v[108:111], v[152:155], v[144:147], v[108:111]
    v_mfma_f32_16x16x32_bf16 v[28:31], v[156:159], v[132:135], v[28:31]
    ds_read_b128 v[180:183], v13 offset:2048
    v_mfma_f32_16x16x32_bf16 v[56:59], v[156:159], v[136:139], v[56:59]
    v_mfma_f32_16x16x32_bf16 v[84:87], v[156:159], v[140:143], v[84:87]
    ds_read_b128 v[184:187], v13 offset:4096
    v_mfma_f32_16x16x32_bf16 v[112:115], v[156:159], v[144:147], v[112:115]
    v_mfma_f32_16x16x32_bf16 v[32:35], v[160:163], v[132:135], v[32:35]
    ds_read_b128 v[188:191], v13 offset:6144
    v_mfma_f32_16x16x32_bf16 v[60:63], v[160:163], v[136:139], v[60:63]
    ds_read_b64_tr_b16 v[200:201], v14 offset:13312
    v_mfma_f32_16x16x32_bf16 v[88:91], v[160:163], v[140:143], v[88:91]
    v_mfma_f32_16x16x32_bf16 v[116:119], v[160:163], v[144:147], v[116:119]
    ds_read_b64_tr_b16 v[202:203], v14 offset:13824
    v_mfma_f32_16x16x32_bf16 v[36:39], v[164:167], v[132:135], v[36:39]
    v_mfma_f32_16x16x32_bf16 v[64:67], v[164:167], v[136:139], v[64:67]
    ds_read_b64_tr_b16 v[204:205], v15 offset:13312
    v_mfma_f32_16x16x32_bf16 v[92:95], v[164:167], v[140:143], v[92:95]
    ds_read_b64_tr_b16 v[206:207], v15 offset:13824
    v_mfma_f32_16x16x32_bf16 v[120:123], v[164:167], v[144:147], v[120:123]
    v_mfma_f32_16x16x32_bf16 v[40:43], v[168:171], v[132:135], v[40:43]
    ds_read_b64_tr_b16 v[208:209], v14 offset:14336
    v_mfma_f32_16x16x32_bf16 v[68:71], v[168:171], v[136:139], v[68:71]
    v_mfma_f32_16x16x32_bf16 v[96:99], v[168:171], v[140:143], v[96:99]
    ds_read_b64_tr_b16 v[210:211], v14 offset:14848
    v_mfma_f32_16x16x32_bf16 v[124:127], v[168:171], v[144:147], v[124:127]
    v_mfma_f32_16x16x32_bf16 v[44:47], v[172:175], v[132:135], v[44:47]
    ds_read_b64_tr_b16 v[212:213], v15 offset:14336
    v_mfma_f32_16x16x32_bf16 v[72:75], v[172:175], v[136:139], v[72:75]
    ds_read_b64_tr_b16 v[214:215], v15 offset:14848
    v_mfma_f32_16x16x32_bf16 v[100:103], v[172:175], v[140:143], v[100:103]
    v_mfma_f32_16x16x32_bf16 v[128:131], v[172:175], v[144:147], v[128:131]
    ds_read_b64_tr_b16 v[216:217], v16 offset:2048
    v_mfma_f32_16x16x32_bf16 v[220:223], v[148:151], v[248:251], v[220:223]
    v_mfma_f32_16x16x32_bf16 v[224:227], v[152:155], v[248:251], v[224:227]
    ds_read_b64_tr_b16 v[218:219], v16 offset:2304
    v_mfma_f32_16x16x32_bf16 v[228:231], v[156:159], v[248:251], v[228:231]
    s_add_u32 s45, s45, 45056
    s_cmp_eq_u32 s45, 135168
    s_cselect_b32 s45, 0, s45
    v_add_u32 v12, s45, v7
    v_add_u32 v13, s45, v8
    v_add_u32 v14, s45, v9
    v_add_u32 v15, s45, v10
    v_add_u32 v16, s45, v11
    v_mfma_f32_16x16x32_bf16 v[232:235], v[160:163], v[248:251], v[232:235]
    v_mfma_f32_16x16x32_bf16 v[236:239], v[164:167], v[248:251], v[236:239]
    v_mfma_f32_16x16x32_bf16 v[240:243], v[168:171], v[248:251], v[240:243]
    v_mfma_f32_16x16x32_bf16 v[244:247], v[172:175], v[248:251], v[244:247]
    s_waitcnt lgkmcnt(0)
    s_barrier
    v_mfma_f32_16x16x32_bf16 v[20:23], v[192:195], v[176:179], v[20:23]
    ds_read_b128 v[132:135], v12 offset:0
    v_mfma_f32_16x16x32_bf16 v[48:51], v[192:195], v[180:183], v[48:51]
    ds_read_b64_tr_b16 v[148:149], v14 offset:0
    v_mfma_f32_16x16x32_bf16 v[76:79], v[192:195], v[184:187], v[76:79]
    ds_read_b64_tr_b16 v[150:151], v14 offset:512
    v_mfma_f32_16x16x32_bf16 v[104:107], v[192:195], v[188:191], v[104:107]
    v_mfma_f32_16x16x32_bf16 v[24:27], v[196:199], v[176:179], v[24:27]
    ds_read_b64_tr_b16 v[152:153], v15 offset:0
    v_mfma_f32_16x16x32_bf16 v[52:55], v[196:199], v[180:183], v[52:55]
    ds_read_b64_tr_b16 v[154:155], v15 offset:512
    v_mfma_f32_16x16x32_bf16 v[80:83], v[196:199], v[184:187], v[80:83]
    ds_read_b128 v[136:139], v12 offset:2048
    v_mfma_f32_16x16x32_bf16 v[108:111], v[196:199], v[188:191], v[108:111]
    v_mfma_f32_16x16x32_bf16 v[28:31], v[200:203], v[176:179], v[28:31]
    ds_read_b128 v[140:143], v12 offset:4096
    v_mfma_f32_16x16x32_bf16 v[56:59], v[200:203], v[180:183], v[56:59]
    ds_read_b128 v[144:147], v12 offset:6144
    v_mfma_f32_16x16x32_bf16 v[84:87], v[200:203], v[184:187], v[84:87]
    ds_read_b64_tr_b16 v[156:157], v14 offset:1024
    v_mfma_f32_16x16x32_bf16 v[112:115], v[200:203], v[188:191], v[112:115]
    v_mfma_f32_16x16x32_bf16 v[32:35], v[204:207], v[176:179], v[32:35]
    ds_read_b64_tr_b16 v[158:159], v14 offset:1536
    v_mfma_f32_16x16x32_bf16 v[60:63], v[204:207], v[180:183], v[60:63]
    ds_read_b64_tr_b16 v[160:161], v15 offset:1024
    v_mfma_f32_16x16x32_bf16 v[88:91], v[204:207], v[184:187], v[88:91]
    ds_read_b64_tr_b16 v[162:163], v15 offset:1536
    v_mfma_f32_16x16x32_bf16 v[116:119], v[204:207], v[188:191], v[116:119]
    v_mfma_f32_16x16x32_bf16 v[36:39], v[208:211], v[176:179], v[36:39]
    ds_read_b64_tr_b16 v[164:165], v14 offset:2048
    v_mfma_f32_16x16x32_bf16 v[64:67], v[208:211], v[180:183], v[64:67]
    ds_read_b64_tr_b16 v[166:167], v14 offset:2560
    v_mfma_f32_16x16x32_bf16 v[92:95], v[208:211], v[184:187], v[92:95]
    ds_read_b64_tr_b16 v[168:169], v15 offset:2048
    v_mfma_f32_16x16x32_bf16 v[120:123], v[208:211], v[188:191], v[120:123]
    v_mfma_f32_16x16x32_bf16 v[40:43], v[212:215], v[176:179], v[40:43]
    ds_read_b64_tr_b16 v[170:171], v15 offset:2560
    v_mfma_f32_16x16x32_bf16 v[68:71], v[212:215], v[180:183], v[68:71]
    ds_read_b64_tr_b16 v[172:173], v16 offset:0
    v_mfma_f32_16x16x32_bf16 v[96:99], v[212:215], v[184:187], v[96:99]
    ds_read_b64_tr_b16 v[174:175], v16 offset:256
    v_mfma_f32_16x16x32_bf16 v[124:127], v[212:215], v[188:191], v[124:127]
    s_sub_u32 s46, s46, 1
    s_cmp_lg_u32 s46, 0
    v_mfma_f32_16x16x32_bf16 v[44:47], v[216:219], v[176:179], v[44:47]
    v_mfma_f32_16x16x32_bf16 v[72:75], v[216:219], v[180:183], v[72:75]
    v_mfma_f32_16x16x32_bf16 v[100:103], v[216:219], v[184:187], v[100:103]
    v_mfma_f32_16x16x32_bf16 v[128:131], v[216:219], v[188:191], v[128:131]
    s_cbranch_scc1 L_w1_cloopa
    s_waitcnt lgkmcnt(0)
    v_mfma_f32_16x16x32_bf16 v[20:23], v[148:151], v[132:135], v[20:23]
    ds_read_b128 v[176:179], v13 offset:0
    v_mfma_f32_16x16x32_bf16 v[48:51], v[148:151], v[136:139], v[48:51]
    ds_read_b64_tr_b16 v[192:193], v14 offset:12288
    v_mfma_f32_16x16x32_bf16 v[76:79], v[148:151], v[140:143], v[76:79]
    v_mfma_f32_16x16x32_bf16 v[104:107], v[148:151], v[144:147], v[104:107]
    ds_read_b64_tr_b16 v[194:195], v14 offset:12800
    v_mfma_f32_16x16x32_bf16 v[24:27], v[152:155], v[132:135], v[24:27]
    v_mfma_f32_16x16x32_bf16 v[52:55], v[152:155], v[136:139], v[52:55]
    ds_read_b64_tr_b16 v[196:197], v15 offset:12288
    v_mfma_f32_16x16x32_bf16 v[80:83], v[152:155], v[140:143], v[80:83]
    ds_read_b64_tr_b16 v[198:199], v15 offset:12800
    v_mfma_f32_16x16x32_bf16 v[108:111], v[152:155], v[144:147], v[108:111]
    v_mfma_f32_16x16x32_bf16 v[28:31], v[156:159], v[132:135], v[28:31]
    ds_read_b128 v[180:183], v13 offset:2048
    v_mfma_f32_16x16x32_bf16 v[56:59], v[156:159], v[136:139], v[56:59]
    v_mfma_f32_16x16x32_bf16 v[84:87], v[156:159], v[140:143], v[84:87]
    ds_read_b128 v[184:187], v13 offset:4096
    v_mfma_f32_16x16x32_bf16 v[112:115], v[156:159], v[144:147], v[112:115]
    v_mfma_f32_16x16x32_bf16 v[32:35], v[160:163], v[132:135], v[32:35]
    ds_read_b128 v[188:191], v13 offset:6144
    v_mfma_f32_16x16x32_bf16 v[60:63], v[160:163], v[136:139], v[60:63]
    ds_read_b64_tr_b16 v[200:201], v14 offset:13312
    v_mfma_f32_16x16x32_bf16 v[88:91], v[160:163], v[140:143], v[88:91]
    v_mfma_f32_16x16x32_bf16 v[116:119], v[160:163], v[144:147], v[116:119]
    ds_read_b64_tr_b16 v[202:203], v14 offset:13824
    v_mfma_f32_16x16x32_bf16 v[36:39], v[164:167], v[132:135], v[36:39]
    v_mfma_f32_16x16x32_bf16 v[64:67], v[164:167], v[136:139], v[64:67]
    ds_read_b64_tr_b16 v[204:205], v15 offset:13312
    v_mfma_f32_16x16x32_bf16 v[92:95], v[164:167], v[140:143], v[92:95]
    ds_read_b64_tr_b16 v[206:207], v15 offset:13824
    v_mfma_f32_16x16x32_bf16 v[120:123], v[164:167], v[144:147], v[120:123]
    v_mfma_f32_16x16x32_bf16 v[40:43], v[168:171], v[132:135], v[40:43]
    ds_read_b64_tr_b16 v[208:209], v14 offset:14336
    v_mfma_f32_16x16x32_bf16 v[68:71], v[168:171], v[136:139], v[68:71]
    v_mfma_f32_16x16x32_bf16 v[96:99], v[168:171], v[140:143], v[96:99]
    ds_read_b64_tr_b16 v[210:211], v14 offset:14848
    v_mfma_f32_16x16x32_bf16 v[124:127], v[168:171], v[144:147], v[124:127]
    v_mfma_f32_16x16x32_bf16 v[44:47], v[172:175], v[132:135], v[44:47]
    ds_read_b64_tr_b16 v[212:213], v15 offset:14336
    v_mfma_f32_16x16x32_bf16 v[72:75], v[172:175], v[136:139], v[72:75]
    ds_read_b64_tr_b16 v[214:215], v15 offset:14848
    v_mfma_f32_16x16x32_bf16 v[100:103], v[172:175], v[140:143], v[100:103]
    v_mfma_f32_16x16x32_bf16 v[128:131], v[172:175], v[144:147], v[128:131]
    ds_read_b64_tr_b16 v[216:217], v16 offset:2048
    v_mfma_f32_16x16x32_bf16 v[220:223], v[148:151], v[248:251], v[220:223]
    v_mfma_f32_16x16x32_bf16 v[224:227], v[152:155], v[248:251], v[224:227]
    ds_read_b64_tr_b16 v[218:219], v16 offset:2304
    v_mfma_f32_16x16x32_bf16 v[228:231], v[156:159], v[248:251], v[228:231]
    v_mfma_f32_16x16x32_bf16 v[232:235], v[160:163], v[248:251], v[232:235]
    v_mfma_f32_16x16x32_bf16 v[236:239], v[164:167], v[248:251], v[236:239]
    v_mfma_f32_16x16x32_bf16 v[240:243], v[168:171], v[248:251], v[240:243]
    v_mfma_f32_16x16x32_bf16 v[244:247], v[172:175], v[248:251], v[244:247]
    s_waitcnt lgkmcnt(0)
    v_mfma_f32_16x16x32_bf16 v[20:23], v[192:195], v[176:179], v[20:23]
    v_mfma_f32_16x16x32_bf16 v[48:51], v[192:195], v[180:183], v[48:51]
    v_mfma_f32_16x16x32_bf16 v[76:79], v[192:195], v[184:187], v[76:79]
    v_mfma_f32_16x16x32_bf16 v[104:107], v[192:195], v[188:191], v[104:107]
    v_mfma_f32_16x16x32_bf16 v[24:27], v[196:199], v[176:179], v[24:27]
    v_mfma_f32_16x16x32_bf16 v[52:55], v[196:199], v[180:183], v[52:55]
    v_mfma_f32_16x16x32_bf16 v[80:83], v[196:199], v[184:187], v[80:83]
    v_mfma_f32_16x16x32_bf16 v[108:111], v[196:199], v[188:191], v[108:111]
    v_mfma_f32_16x16x32_bf16 v[28:31], v[200:203], v[176:179], v[28:31]
    v_mfma_f32_16x16x32_bf16 v[56:59], v[200:203], v[180:183], v[56:59]
    v_mfma_f32_16x16x32_bf16 v[84:87], v[200:203], v[184:187], v[84:87]
    v_mfma_f32_16x16x32_bf16 v[112:115], v[200:203], v[188:191], v[112:115]
    v_mfma_f32_16x16x32_bf16 v[32:35], v[204:207], v[176:179], v[32:35]
    v_mfma_f32_16x16x32_bf16 v[60:63], v[204:207], v[180:183], v[60:63]
    v_mfma_f32_16x16x32_bf16 v[88:91], v[204:207], v[184:187], v[88:91]
    v_mfma_f32_16x16x32_bf16 v[116:119], v[204:207], v[188:191], v[116:119]
    v_mfma_f32_16x16x32_bf16 v[36:39], v[208:211], v[176:179], v[36:39]
    v_mfma_f32_16x16x32_bf16 v[64:67], v[208:211], v[180:183], v[64:67]
    v_mfma_f32_16x16x32_bf16 v[92:95], v[208:211], v[184:187], v[92:95]
    v_mfma_f32_16x16x32_bf16 v[120:123], v[208:211], v[188:191], v[120:123]
    v_mfma_f32_16x16x32_bf16 v[40:43], v[212:215], v[176:179], v[40:43]
    v_mfma_f32_16x16x32_bf16 v[68:71], v[212:215], v[180:183], v[68:71]
    v_mfma_f32_16x16x32_bf16 v[96:99], v[212:215], v[184:187], v[96:99]
    v_mfma_f32_16x16x32_bf16 v[124:127], v[212:215], v[188:191], v[124:127]
    v_mfma_f32_16x16x32_bf16 v[44:47], v[216:219], v[176:179], v[44:47]
    v_mfma_f32_16x16x32_bf16 v[72:75], v[216:219], v[180:183], v[72:75]
    v_mfma_f32_16x16x32_bf16 v[100:103], v[216:219], v[184:187], v[100:103]
    v_mfma_f32_16x16x32_bf16 v[128:131], v[216:219], v[188:191], v[128:131]
    s_branch L_w1_sle6
L_w1_slb5:
L_w1_cloopb:
    s_waitcnt lgkmcnt(0)
    v_mfma_f32_16x16x32_bf16 v[20:23], v[148:151], v[132:135], v[20:23]
    ds_read_b128 v[176:179], v13 offset:0
    v_mfma_f32_16x16x32_bf16 v[48:51], v[148:151], v[136:139], v[48:51]
    ds_read_b64_tr_b16 v[192:193], v14 offset:12288
    v_mfma_f32_16x16x32_bf16 v[76:79], v[148:151], v[140:143], v[76:79]
    ds_read_b64_tr_b16 v[194:195], v14 offset:12800
    v_mfma_f32_16x16x32_bf16 v[104:107], v[148:151], v[144:147], v[104:107]
    v_mfma_f32_16x16x32_bf16 v[24:27], v[152:155], v[132:135], v[24:27]
    ds_read_b64_tr_b16 v[196:197], v15 offset:12288
    v_mfma_f32_16x16x32_bf16 v[52:55], v[152:155], v[136:139], v[52:55]
    ds_read_b64_tr_b16 v[198:199], v15 offset:12800
    v_mfma_f32_16x16x32_bf16 v[80:83], v[152:155], v[140:143], v[80:83]
    ds_read_b128 v[180:183], v13 offset:2048
    v_mfma_f32_16x16x32_bf16 v[108:111], v[152:155], v[144:147], v[108:111]
    v_mfma_f32_16x16x32_bf16 v[28:31], v[156:159], v[132:135], v[28:31]
    ds_read_b128 v[184:187], v13 offset:4096
    v_mfma_f32_16x16x32_bf16 v[56:59], v[156:159], v[136:139], v[56:59]
    ds_read_b128 v[188:191], v13 offset:6144
    v_mfma_f32_16x16x32_bf16 v[84:87], v[156:159], v[140:143], v[84:87]
    ds_read_b64_tr_b16 v[200:201], v14 offset:13312
    v_mfma_f32_16x16x32_bf16 v[112:115], v[156:159], v[144:147], v[112:115]
    v_mfma_f32_16x16x32_bf16 v[32:35], v[160:163], v[132:135], v[32:35]
    ds_read_b64_tr_b16 v[202:203], v14 offset:13824
    v_mfma_f32_16x16x32_bf16 v[60:63], v[160:163], v[136:139], v[60:63]
    ds_read_b64_tr_b16 v[204:205], v15 offset:13312
    v_mfma_f32_16x16x32_bf16 v[88:91], v[160:163], v[140:143], v[88:91]
    ds_read_b64_tr_b16 v[206:207], v15 offset:13824
    v_mfma_f32_16x16x32_bf16 v[116:119], v[160:163], v[144:147], v[116:119]
    v_mfma_f32_16x16x32_bf16 v[36:39], v[164:167], v[132:135], v[36:39]
    ds_read_b64_tr_b16 v[208:209], v14 offset:14336
    v_mfma_f32_16x16x32_bf16 v[64:67], v[164:167], v[136:139], v[64:67]
    ds_read_b64_tr_b16 v[210:211], v14 offset:14848
    v_mfma_f32_16x16x32_bf16 v[92:95], v[164:167], v[140:143], v[92:95]
    ds_read_b64_tr_b16 v[212:213], v15 offset:14336
    v_mfma_f32_16x16x32_bf16 v[120:123], v[164:167], v[144:147], v[120:123]
    v_mfma_f32_16x16x32_bf16 v[40:43], v[168:171], v[132:135], v[40:43]
    ds_read_b64_tr_b16 v[214:215], v15 offset:14848
    v_mfma_f32_16x16x32_bf16 v[68:71], v[168:171], v[136:139], v[68:71]
    ds_read_b64_tr_b16 v[216:217], v16 offset:2048
    v_mfma_f32_16x16x32_bf16 v[96:99], v[168:171], v[140:143], v[96:99]
    ds_read_b64_tr_b16 v[218:219], v16 offset:2304
    v_mfma_f32_16x16x32_bf16 v[124:127], v[168:171], v[144:147], v[124:127]
    s_add_u32 s45, s45, 45056
    s_cmp_eq_u32 s45, 135168
    s_cselect_b32 s45, 0, s45
    v_add_u32 v12, s45, v7
    v_add_u32 v13, s45, v8
    v_add_u32 v14, s45, v9
    v_add_u32 v15, s45, v10
    v_add_u32 v16, s45, v11
    v_mfma_f32_16x16x32_bf16 v[44:47], v[172:175], v[132:135], v[44:47]
    v_mfma_f32_16x16x32_bf16 v[72:75], v[172:175], v[136:139], v[72:75]
    v_mfma_f32_16x16x32_bf16 v[100:103], v[172:175], v[140:143], v[100:103]
    v_mfma_f32_16x16x32_bf16 v[128:131], v[172:175], v[144:147], v[128:131]
    s_waitcnt lgkmcnt(0)
    s_barrier
    v_mfma_f32_16x16x32_bf16 v[20:23], v[192:195], v[176:179], v[20:23]
    ds_read_b128 v[132:135], v12 offset:0
    v_mfma_f32_16x16x32_bf16 v[48:51], v[192:195], v[180:183], v[48:51]
    ds_read_b64_tr_b16 v[148:149], v14 offset:0
    v_mfma_f32_16x16x32_bf16 v[76:79], v[192:195], v[184:187], v[76:79]
    v_mfma_f32_16x16x32_bf16 v[104:107], v[192:195], v[188:191], v[104:107]
    ds_read_b64_tr_b16 v[150:151], v14 offset:512
    v_mfma_f32_16x16x32_bf16 v[24:27], v[196:199], v[176:179], v[24:27]
    v_mfma_f32_16x16x32_bf16 v[52:55], v[196:199], v[180:183], v[52:55]
    ds_read_b64_tr_b16 v[152:153], v15 offset:0
    v_mfma_f32_16x16x32_bf16 v[80:83], v[196:199], v[184:187], v[80:83]
    ds_read_b64_tr_b16 v[154:155], v15 offset:512
    v_mfma_f32_16x16x32_bf16 v[108:111], v[196:199], v[188:191], v[108:111]
    v_mfma_f32_16x16x32_bf16 v[28:31], v[200:203], v[176:179], v[28:31]
    ds_read_b128 v[136:139], v12 offset:2048
    v_mfma_f32_16x16x32_bf16 v[56:59], v[200:203], v[180:183], v[56:59]
    v_mfma_f32_16x16x32_bf16 v[84:87], v[200:203], v[184:187], v[84:87]
    ds_read_b128 v[140:143], v12 offset:4096
    v_mfma_f32_16x16x32_bf16 v[112:115], v[200:203], v[188:191], v[112:115]
    v_mfma_f32_16x16x32_bf16 v[32:35], v[204:207], v[176:179], v[32:35]
    ds_read_b128 v[144:147], v12 offset:6144
    v_mfma_f32_16x16x32_bf16 v[60:63], v[204:207], v[180:183], v[60:63]
    ds_read_b64_tr_b16 v[156:157], v14 offset:1024
    v_mfma_f32_16x16x32_bf16 v[88:91], v[204:207], v[184:187], v[88:91]
    v_mfma_f32_16x16x32_bf16 v[116:119], v[204:207], v[188:191], v[116:119]
    ds_read_b64_tr_b16 v[158:159], v14 offset:1536
    v_mfma_f32_16x16x32_bf16 v[36:39], v[208:211], v[176:179], v[36:39]
    v_mfma_f32_16x16x32_bf16 v[64:67], v[208:211], v[180:183], v[64:67]
    ds_read_b64_tr_b16 v[160:161], v15 offset:1024
    v_mfma_f32_16x16x32_bf16 v[92:95], v[208:211], v[184:187], v[92:95]
    ds_read_b64_tr_b16 v[162:163], v15 offset:1536
    v_mfma_f32_16x16x32_bf16 v[120:123], v[208:211], v[188:191], v[120:123]
    v_mfma_f32_16x16x32_bf16 v[40:43], v[212:215], v[176:179], v[40:43]
    ds_read_b64_tr_b16 v[164:165], v14 offset:2048
    v_mfma_f32_16x16x32_bf16 v[68:71], v[212:215], v[180:183], v[68:71]
    v_mfma_f32_16x16x32_bf16 v[96:99], v[212:215], v[184:187], v[96:99]
    ds_read_b64_tr_b16 v[166:167], v14 offset:2560
    v_mfma_f32_16x16x32_bf16 v[124:127], v[212:215], v[188:191], v[124:127]
    v_mfma_f32_16x16x32_bf16 v[44:47], v[216:219], v[176:179], v[44:47]
    ds_read_b64_tr_b16 v[168:169], v15 offset:2048
    v_mfma_f32_16x16x32_bf16 v[72:75], v[216:219], v[180:183], v[72:75]
    ds_read_b64_tr_b16 v[170:171], v15 offset:2560
    v_mfma_f32_16x16x32_bf16 v[100:103], v[216:219], v[184:187], v[100:103]
    v_mfma_f32_16x16x32_bf16 v[128:131], v[216:219], v[188:191], v[128:131]
    ds_read_b64_tr_b16 v[172:173], v16 offset:0
    v_mfma_f32_16x16x32_bf16 v[220:223], v[192:195], v[248:251], v[220:223]
    v_mfma_f32_16x16x32_bf16 v[224:227], v[196:199], v[248:251], v[224:227]
    ds_read_b64_tr_b16 v[174:175], v16 offset:256
    v_mfma_f32_16x16x32_bf16 v[228:231], v[200:203], v[248:251], v[228:231]
    s_sub_u32 s46, s46, 1
    s_cmp_lg_u32 s46, 0
    v_mfma_f32_16x16x32_bf16 v[232:235], v[204:207], v[248:251], v[232:235]
    v_mfma_f32_16x16x32_bf16 v[236:239], v[208:211], v[248:251], v[236:239]
    v_mfma_f32_16x16x32_bf16 v[240:243], v[212:215], v[248:251], v[240:243]
    v_mfma_f32_16x16x32_bf16 v[244:247], v[216:219], v[248:251], v[244:247]
    s_cbranch_scc1 L_w1_cloopb
    s_waitcnt lgkmcnt(0)
    v_mfma_f32_16x16x32_bf16 v[20:23], v[148:151], v[132:135], v[20:23]
    ds_read_b128 v[176:179], v13 offset:0
    v_mfma_f32_16x16x32_bf16 v[48:51], v[148:151], v[136:139], v[48:51]
    ds_read_b64_tr_b16 v[192:193], v14 offset:12288
    v_mfma_f32_16x16x32_bf16 v[76:79], v[148:151], v[140:143], v[76:79]
    ds_read_b64_tr_b16 v[194:195], v14 offset:12800
    v_mfma_f32_16x16x32_bf16 v[104:107], v[148:151], v[144:147], v[104:107]
    v_mfma_f32_16x16x32_bf16 v[24:27], v[152:155], v[132:135], v[24:27]
    ds_read_b64_tr_b16 v[196:197], v15 offset:12288
    v_mfma_f32_16x16x32_bf16 v[52:55], v[152:155], v[136:139], v[52:55]
    ds_read_b64_tr_b16 v[198:199], v15 offset:12800
    v_mfma_f32_16x16x32_bf16 v[80:83], v[152:155], v[140:143], v[80:83]
    ds_read_b128 v[180:183], v13 offset:2048
    v_mfma_f32_16x16x32_bf16 v[108:111], v[152:155], v[144:147], v[108:111]
    v_mfma_f32_16x16x32_bf16 v[28:31], v[156:159], v[132:135], v[28:31]
    ds_read_b128 v[184:187], v13 offset:4096
    v_mfma_f32_16x16x32_bf16 v[56:59], v[156:159], v[136:139], v[56:59]
    ds_read_b128 v[188:191], v13 offset:6144
    v_mfma_f32_16x16x32_bf16 v[84:87], v[156:159], v[140:143], v[84:87]
    ds_read_b64_tr_b16 v[200:201], v14 offset:13312
    v_mfma_f32_16x16x32_bf16 v[112:115], v[156:159], v[144:147], v[112:115]
    v_mfma_f32_16x16x32_bf16 v[32:35], v[160:163], v[132:135], v[32:35]
    ds_read_b64_tr_b16 v[202:203], v14 offset:13824
    v_mfma_f32_16x16x32_bf16 v[60:63], v[160:163], v[136:139], v[60:63]
    ds_read_b64_tr_b16 v[204:205], v15 offset:13312
    v_mfma_f32_16x16x32_bf16 v[88:91], v[160:163], v[140:143], v[88:91]
    ds_read_b64_tr_b16 v[206:207], v15 offset:13824
    v_mfma_f32_16x16x32_bf16 v[116:119], v[160:163], v[144:147], v[116:119]
    v_mfma_f32_16x16x32_bf16 v[36:39], v[164:167], v[132:135], v[36:39]
    ds_read_b64_tr_b16 v[208:209], v14 offset:14336
    v_mfma_f32_16x16x32_bf16 v[64:67], v[164:167], v[136:139], v[64:67]
    ds_read_b64_tr_b16 v[210:211], v14 offset:14848
    v_mfma_f32_16x16x32_bf16 v[92:95], v[164:167], v[140:143], v[92:95]
    ds_read_b64_tr_b16 v[212:213], v15 offset:14336
    v_mfma_f32_16x16x32_bf16 v[120:123], v[164:167], v[144:147], v[120:123]
    v_mfma_f32_16x16x32_bf16 v[40:43], v[168:171], v[132:135], v[40:43]
    ds_read_b64_tr_b16 v[214:215], v15 offset:14848
    v_mfma_f32_16x16x32_bf16 v[68:71], v[168:171], v[136:139], v[68:71]
    ds_read_b64_tr_b16 v[216:217], v16 offset:2048
    v_mfma_f32_16x16x32_bf16 v[96:99], v[168:171], v[140:143], v[96:99]
    ds_read_b64_tr_b16 v[218:219], v16 offset:2304
    v_mfma_f32_16x16x32_bf16 v[124:127], v[168:171], v[144:147], v[124:127]
    v_mfma_f32_16x16x32_bf16 v[44:47], v[172:175], v[132:135], v[44:47]
    v_mfma_f32_16x16x32_bf16 v[72:75], v[172:175], v[136:139], v[72:75]
    v_mfma_f32_16x16x32_bf16 v[100:103], v[172:175], v[140:143], v[100:103]
    v_mfma_f32_16x16x32_bf16 v[128:131], v[172:175], v[144:147], v[128:131]
    s_waitcnt lgkmcnt(0)
    v_mfma_f32_16x16x32_bf16 v[220:223], v[192:195], v[248:251], v[220:223]
    v_mfma_f32_16x16x32_bf16 v[224:227], v[196:199], v[248:251], v[224:227]
    v_mfma_f32_16x16x32_bf16 v[228:231], v[200:203], v[248:251], v[228:231]
    v_mfma_f32_16x16x32_bf16 v[232:235], v[204:207], v[248:251], v[232:235]
    v_mfma_f32_16x16x32_bf16 v[236:239], v[208:211], v[248:251], v[236:239]
    v_mfma_f32_16x16x32_bf16 v[240:243], v[212:215], v[248:251], v[240:243]
    v_mfma_f32_16x16x32_bf16 v[244:247], v[216:219], v[248:251], v[244:247]
    v_mfma_f32_16x16x32_bf16 v[20:23], v[192:195], v[176:179], v[20:23]
    v_mfma_f32_16x16x32_bf16 v[48:51], v[192:195], v[180:183], v[48:51]
    v_mfma_f32_16x16x32_bf16 v[76:79], v[192:195], v[184:187], v[76:79]
    v_mfma_f32_16x16x32_bf16 v[104:107], v[192:195], v[188:191], v[104:107]
    v_mfma_f32_16x16x32_bf16 v[24:27], v[196:199], v[176:179], v[24:27]
    v_mfma_f32_16x16x32_bf16 v[52:55], v[196:199], v[180:183], v[52:55]
    v_mfma_f32_16x16x32_bf16 v[80:83], v[196:199], v[184:187], v[80:83]
    v_mfma_f32_16x16x32_bf16 v[108:111], v[196:199], v[188:191], v[108:111]
    v_mfma_f32_16x16x32_bf16 v[28:31], v[200:203], v[176:179], v[28:31]
    v_mfma_f32_16x16x32_bf16 v[56:59], v[200:203], v[180:183], v[56:59]
    v_mfma_f32_16x16x32_bf16 v[84:87], v[200:203], v[184:187], v[84:87]
    v_mfma_f32_16x16x32_bf16 v[112:115], v[200:203], v[188:191], v[112:115]
    v_mfma_f32_16x16x32_bf16 v[32:35], v[204:207], v[176:179], v[32:35]
    v_mfma_f32_16x16x32_bf16 v[60:63], v[204:207], v[180:183], v[60:63]
    v_mfma_f32_16x16x32_bf16 v[88:91], v[204:207], v[184:187], v[88:91]
    v_mfma_f32_16x16x32_bf16 v[116:119], v[204:207], v[188:191], v[116:119]
    v_mfma_f32_16x16x32_bf16 v[36:39], v[208:211], v[176:179], v[36:39]
    v_mfma_f32_16x16x32_bf16 v[64:67], v[208:211], v[180:183], v[64:67]
    v_mfma_f32_16x16x32_bf16 v[92:95], v[208:211], v[184:187], v[92:95]
    v_mfma_f32_16x16x32_bf16 v[120:123], v[208:211], v[188:191], v[120:123]
    v_mfma_f32_16x16x32_bf16 v[40:43], v[212:215], v[176:179], v[40:43]
    v_mfma_f32_16x16x32_bf16 v[68:71], v[212:215], v[180:183], v[68:71]
    v_mfma_f32_16x16x32_bf16 v[96:99], v[212:215], v[184:187], v[96:99]
    v_mfma_f32_16x16x32_bf16 v[124:127], v[212:215], v[188:191], v[124:127]
    v_mfma_f32_16x16x32_bf16 v[44:47], v[216:219], v[176:179], v[44:47]
    v_mfma_f32_16x16x32_bf16 v[72:75], v[216:219], v[180:183], v[72:75]
    v_mfma_f32_16x16x32_bf16 v[100:103], v[216:219], v[184:187], v[100:103]
    v_mfma_f32_16x16x32_bf16 v[128:131], v[216:219], v[188:191], v[128:131]
L_w1_sle6:
    s_nop 7
    s_lshl_b32 s43, s51, 10
    s_lshl_b32 s44, s52, 7
    s_add_u32 s44, s44, s43
    v_lshl_add_u32 v3, v2, 4, s44
    s_lshl_b32 s44, s52, 6
    s_add_u32 s44, s44, s43
    v_lshl_add_u32 v4, v2, 4, s44
    v_cmp_eq_u32 vcc, 0, v1
    s_and_saveexec_b64 s[62:63], vcc
    ds_write_b128 v3, v[220:223] offset:49152
    ds_write_b128 v3, v[224:227] offset:49216
    ds_write_b128 v3, v[228:231] offset:49408
    ds_write_b128 v3, v[232:235] offset:49472
    ds_write_b128 v3, v[236:239] offset:49664
    ds_write_b128 v3, v[240:243] offset:49728
    ds_write_b128 v4, v[244:247] offset:49920
    s_mov_b64 exec, -1
    s_waitcnt lgkmcnt(0)
    s_barrier
    s_branch L_w1_join
L_w1_ool12:
    s_barrier
    s_lshl_b32 s43, s51, 8
    v_lshl_add_u32 v1, v0, 2, s43
    ds_read_b32 v74, v1 offset:49152
    ds_read_b32 v75, v1 offset:50176
    s_cmp_eq_u32 s41, 0
    s_mov_b32 s44, 2146435072
    s_cselect_b32 s44, 1310720, s44
    s_waitcnt vmcnt(0) lgkmcnt(0)
    v_add_f32 v56, v74, v75
    s_cmp_eq_u32 s51, 3
    s_cselect_b32 s43, 32, 64
    v_cmp_gt_u32 vcc, s43, v0
    v_mov_b32 v1, 2146435072
    s_nop 0
    v_cndmask_b32 v47, v1, v47, vcc
    buffer_store_dword v56, v47, s[24:27], s44 offen sc1
    s_branch L_w1_back13
L_sync_w1:
    s_load_dwordx2 s[4:5], s[0:1], 80
    s_waitcnt vmcnt(0) lgkmcnt(0)
    s_barrier
    s_add_u32 s8, s4, 65011712
    s_addc_u32 s9, s5, 0
    s_and_b32 s9, s9, 0xffff
    s_mov_b32 s10, 1048576
    s_mov_b32 s11, 131072
    v_mbcnt_lo_u32_b32 v0, -1, 0
    v_mbcnt_hi_u32_b32 v0, -1, v0
    s_xor_b32 s12, s3, 1
    s_mul_i32 s12, s12, 5
    s_add_u32 s12, s12, 3
    s_lshl_b32 s12, s12, 15
    s_cmp_lg_u32 s97, 0
    s_cbranch_scc1 L_syncw1_go1
    s_lshl_b32 s13, s96, 7
    s_add_u32 s13, s12, s13
    v_mov_b32 v1, 0
    v_mov_b32 v2, s95
    s_mov_b64 exec, 1
    buffer_store_dword v2, v1, s[8:11], s13 offen sc1
    s_mov_b64 exec, -1
L_syncw1_go1:
    s_and_b32 s14, s2, 7
    s_lshr_b32 s15, s2, 3
    s_bfe_u32 s13, s2, 0x10001
    s_lshl_b32 s13, s13, 3
    s_and_b32 s15, s15, 7
    s_add_u32 s13, s13, s15
    s_lshl_b32 s13, s13, 11
    s_add_u32 s99, s12, s13
    s_lshl_b32 s13, s97, 6
    v_or_b32 v0, s13, v0
    s_add_u32 s98, s98, 1
    s_branch w2_run
ce_w1:
.p2align 8
cs_w2:
.globl w2_b_kernel
.p2align 8
.type w2_b_kernel,@function
w2_b_kernel:
    s_mov_b32 s3, 0
    s_branch w2_body
.globl w2_a_kernel
.p2align 8
.type w2_a_kernel,@function
w2_a_kernel:
    s_mov_b32 s3, 1
    s_mov_b32 s98, 0
    s_mov_b32 s99, -1
w2_body:
    s_cmp_ge_u32 s2, 256
    s_cbranch_scc1 L_w2_end
w2_run:
    s_load_dwordx2 s[6:7], s[0:1], 48
    s_load_dwordx2 s[30:31], s[0:1], 80
    s_load_dwordx2 s[32:33], s[0:1], 64
    s_load_dwordx2 s[34:35], s[0:1], 56
    s_xor_b32 s29, s3, 1
    s_mul_i32 s29, s29, 134217728
    v_lshrrev_b32 v1, 6, v0
    v_and_b32 v0, 63, v0
    v_readfirstlane_b32 s40, v1
    s_and_b32 s43, s2, 7
    s_lshr_b32 s44, s2, 3
    s_and_b32 s58, s2, 1
    s_bfe_u32 s41, s2, 0x10001
    s_lshl_b32 s41, s41, 3
    s_and_b32 s42, s44, 7
    s_add_u32 s41, s41, s42
    s_lshr_b32 s42, s43, 2
    s_lshl_b32 s42, s42, 2
    s_lshr_b32 s44, s44, 3
    s_add_u32 s42, s42, s44
    s_lshl_b32 s42, s42, 1
    s_add_u32 s42, s42, s58
    s_mov_b32 s97, s40
    s_lshl_b32 s96, s41, 4
    s_add_u32 s96, s96, s42
    s_load_dwordx2 s[56:57], s[0:1], 8
    s_cmp_ge_u32 s40, 4
    s_cbranch_scc0 L_w2_compute
L_w2_loader:
    s_sub_u32 s51, s40, 4
    v_lshrrev_b32 v1, 3, v0
    v_lshrrev_b32 v2, 1, v1
    s_and_b32 s43, s51, 1
    s_lshl_b32 s44, s43, 2
    v_add_u32 v2, s44, v2
    v_and_b32 v3, 7, v0
    v_xor_b32 v2, v2, v3
    v_lshlrev_b32 v2, 4, v2
    s_lshl_b32 s44, s51, 3
    v_add_u32 v1, s44, v1
    s_lshl_b32 s46, s41, 7
    v_add_u32 v1, s46, v1
    v_lshrrev_b32 v3, 6, v2
    v_and_b32 v4, 48, v2
    v_lshl_add_u32 v4, v3, 17, v4
    v_lshl_add_u32 v8, v1, 6, v4
    v_add_u32 v9, 2048, v8
    v_add_u32 v10, 4096, v8
    v_add_u32 v11, 6144, v8
    v_lshrrev_b32 v3, 6, v2
    v_and_b32 v4, 48, v2
    v_lshl_add_u32 v4, v3, 17, v4
    v_lshl_add_u32 v40, v1, 6, v4
    v_add_u32 v41, 2048, v40
    v_add_u32 v42, 4096, v40
    v_add_u32 v43, 6144, v40
    s_cmp_lg_u32 s3, 0
    s_mov_b32 s61, 262144
    s_cselect_b32 s61, 128, s61
    v_lshrrev_b32 v1, 5, v0
    v_bfe_u32 v2, v0, 2, 2
    v_lshl_add_u32 v1, v1, 2, v2
    v_add_u32 v1, s44, v1
    v_mul_u32_u24 v1, 2048, v1
    v_and_b32 v2, 3, v0
    s_lshl_b32 s43, s43, 1
    v_xor_b32 v2, s43, v2
    v_bfe_u32 v3, v0, 4, 1
    v_lshl_add_u32 v2, v3, 2, v2
    v_lshl_add_u32 v1, v2, 4, v1
    s_lshl_b32 s43, s42, 7
    s_xor_b32 s44, s43, 128
    v_add_u32 v2, s44, v1
    v_add_u32 v1, s43, v1
    v_add_u32 v12, 0, v1
    v_add_u32 v13, 0, v2
    v_add_u32 v14, 65536, v1
    v_add_u32 v15, 65536, v2
    s_lshl_b32 s53, s51, 10
    s_mul_i32 s54, s51, 2048
    s_add_u32 s54, s54, 16384
    s_mov_b32 s45, 0
    s_mul_i32 s62, s58, 55
    s_mov_b32 s63, s62
    s_cmp_eq_u32 s58, 0
    s_cselect_b32 s55, 3, -1
    s_mov_b32 s59, 1000
    s_cselect_b32 s59, 24, s59
    s_lshl_b32 s47, s62, 18
    s_mul_i32 s48, s63, 131072
    s_waitcnt lgkmcnt(0)
    s_add_u32 s8, s30, s29
    s_addc_u32 s9, s31, 0
    s_add_u32 s8, s8, 20971520
    s_addc_u32 s9, s9, 0
    s_and_b32 s9, s9, 0xffff
    s_mov_b32 s10, 14680064
    s_mov_b32 s11, 131072
    s_mov_b32 s12, s6
    s_and_b32 s13, s7, 0xffff
    s_mov_b32 s14, 7340032
    s_mov_b32 s15, 131072
    s_add_u32 s20, s30, s29
    s_addc_u32 s21, s31, 0
    s_add_u32 s20, s20, 16777216
    s_addc_u32 s21, s21, 0
    s_and_b32 s21, s21, 0xffff
    s_mov_b32 s22, 4194304
    s_mov_b32 s23, 131072
    s_mov_b32 s46, 2
L_w2_wp9:
    s_add_u32 s49, s45, s53
    s_add_u32 s50, s45, s54
    s_add_u32 m0, s50, 0
    s_nop 0
    buffer_load_dwordx4 v12, s[12:15], s48 offen lds
    s_add_u32 m0, s50, 1024
    s_nop 0
    buffer_load_dwordx4 v13, s[12:15], s48 offen lds
    s_add_u32 m0, s50, 8192
    s_nop 0
    buffer_load_dwordx4 v14, s[12:15], s48 offen lds
    s_add_u32 m0, s50, 9216
    s_nop 0
    buffer_load_dwordx4 v15, s[12:15], s48 offen lds
    s_add_u32 s63, s63, s55
    s_cmp_ge_u32 s63, s59
    s_cselect_b32 s43, 23, 0
    s_sub_u32 s63, s63, s43
    s_mul_i32 s48, s63, 131072
    s_add_u32 s45, s45, 32768
    s_cmp_eq_u32 s45, 163840
    s_cselect_b32 s45, 0, s45
    s_sub_u32 s46, s46, 1
    s_cmp_lg_u32 s46, 0
    s_cbranch_scc1 L_w2_wp9
    s_cmp_eq_u32 s99, -1
    s_cbranch_scc1 L_w2_dwe10
    s_cmp_lg_u32 s97, 4
    s_cbranch_scc1 L_w2_dwb11
    s_add_u32 s64, s30, 65011712
    s_addc_u32 s65, s31, 0
    s_and_b32 s65, s65, 0xffff
    s_mov_b32 s66, 1048576
    s_mov_b32 s67, 131072
    v_lshlrev_b32 v76, 7, v0
    s_mov_b32 s46, 0x400000
    s_mov_b64 exec, 0xffff
L_w2_dwp12:
    buffer_load_dword v77, v76, s[64:67], s99 offen sc1
    s_waitcnt vmcnt(0)
    v_cmp_ne_u32 vcc, s95, v77
    s_sub_u32 s46, s46, 1
    s_cbranch_scc1 L_w2_dwg13
    s_nop 1
    s_cbranch_vccz L_w2_dwg13
    s_sleep 1
    s_branch L_w2_dwp12
L_w2_dwg13:
    s_mov_b64 exec, -1
L_w2_dwb11:
    s_barrier
L_w2_dwe10:
    s_mov_b32 s45, 0
    s_add_u32 s49, s45, s53
    s_add_u32 s50, s45, s54
    s_add_u32 m0, s49, 0
    s_nop 0
    buffer_load_dwordx4 v8, s[8:11], s47 offen lds
    s_add_u32 m0, s49, 4096
    s_nop 0
    buffer_load_dwordx4 v9, s[8:11], s47 offen lds
    s_add_u32 m0, s49, 8192
    s_nop 0
    buffer_load_dwordx4 v10, s[8:11], s47 offen lds
    s_add_u32 m0, s49, 12288
    s_nop 0
    buffer_load_dwordx4 v11, s[8:11], s47 offen lds
    s_add_u32 s62, s62, s55
    s_cmp_ge_u32 s62, s59
    s_cselect_b32 s43, 23, 0
    s_sub_u32 s62, s62, s43
    s_lshl_b32 s47, s62, 18
    s_add_u32 s45, s45, 32768
    s_cmp_eq_u32 s45, 163840
    s_cselect_b32 s45, 0, s45
    s_add_u32 s49, s45, s53
    s_add_u32 s50, s45, s54
    s_add_u32 m0, s49, 0
    s_nop 0
    buffer_load_dwordx4 v8, s[8:11], s47 offen lds
    s_add_u32 m0, s49, 4096
    s_nop 0
    buffer_load_dwordx4 v9, s[8:11], s47 offen lds
    s_add_u32 m0, s49, 8192
    s_nop 0
    buffer_load_dwordx4 v10, s[8:11], s47 offen lds
    s_add_u32 m0, s49, 12288
    s_nop 0
    buffer_load_dwordx4 v11, s[8:11], s47 offen lds
    s_add_u32 s62, s62, s55
    s_cmp_ge_u32 s62, s59
    s_cselect_b32 s43, 23, 0
    s_sub_u32 s62, s62, s43
    s_lshl_b32 s47, s62, 18
    s_add_u32 s45, s45, 32768
    s_cmp_eq_u32 s45, 163840
    s_cselect_b32 s45, 0, s45
    s_waitcnt vmcnt(4)
    s_barrier
    s_add_u32 s49, s45, s53
    s_add_u32 s50, s45, s54
    s_add_u32 m0, s49, 0
    s_nop 0
    buffer_load_dwordx4 v8, s[8:11], s47 offen lds
    s_add_u32 m0, s49, 4096
    s_nop 0
    buffer_load_dwordx4 v9, s[8:11], s47 offen lds
    s_add_u32 m0, s50, 0
    s_nop 0
    buffer_load_dwordx4 v12, s[12:15], s48 offen lds
    s_add_u32 m0, s50, 1024
    s_nop 0
    buffer_load_dwordx4 v13, s[12:15], s48 offen lds
    s_add_u32 m0, s49, 8192
    s_nop 0
    buffer_load_dwordx4 v10, s[8:11], s47 offen lds
    s_add_u32 m0, s49, 12288
    s_nop 0
    buffer_load_dwordx4 v11, s[8:11], s47 offen lds
    s_add_u32 m0, s50, 8192
    s_nop 0
    buffer_load_dwordx4 v14, s[12:15], s48 offen lds
    s_add_u32 m0, s50, 9216
    s_nop 0
    buffer_load_dwordx4 v15, s[12:15], s48 offen lds
    s_add_u32 s62, s62, s55
    s_cmp_ge_u32 s62, s59
    s_cselect_b32 s43, 23, 0
    s_sub_u32 s62, s62, s43
    s_lshl_b32 s47, s62, 18
    s_add_u32 s63, s63, s55
    s_cmp_ge_u32 s63, s59
    s_cselect_b32 s43, 23, 0
    s_sub_u32 s63, s63, s43
    s_mul_i32 s48, s63, 131072
    s_add_u32 s45, s45, 32768
    s_cmp_eq_u32 s45, 163840
    s_cselect_b32 s45, 0, s45
    s_add_u32 s49, s45, s53
    s_add_u32 s50, s45, s54
    s_add_u32 m0, s49, 0
    s_nop 0
    buffer_load_dwordx4 v8, s[8:11], s47 offen lds
    s_add_u32 m0, s49, 4096
    s_nop 0
    buffer_load_dwordx4 v9, s[8:11], s47 offen lds
    s_add_u32 m0, s50, 0
    s_nop 0
    buffer_load_dwordx4 v12, s[12:15], s48 offen lds
    s_add_u32 m0, s50, 1024
    s_nop 0
    buffer_load_dwordx4 v13, s[12:15], s48 offen lds
    s_add_u32 m0, s49, 8192
    s_nop 0
    buffer_load_dwordx4 v10, s[8:11], s47 offen lds
    s_add_u32 m0, s49, 12288
    s_nop 0
    buffer_load_dwordx4 v11, s[8:11], s47 offen lds
    s_add_u32 m0, s50, 8192
    s_nop 0
    buffer_load_dwordx4 v14, s[12:15], s48 offen lds
    s_add_u32 m0, s50, 9216
    s_nop 0
    buffer_load_dwordx4 v15, s[12:15], s48 offen lds
    s_add_u32 s62, s62, s55
    s_cmp_ge_u32 s62, s59
    s_cselect_b32 s43, 23, 0
    s_sub_u32 s62, s62, s43
    s_lshl_b32 s47, s62, 18
    s_add_u32 s63, s63, s55
    s_cmp_ge_u32 s63, s59
    s_cselect_b32 s43, 23, 0
    s_sub_u32 s63, s63, s43
    s_mul_i32 s48, s63, 131072
    s_add_u32 s45, s45, 32768
    s_cmp_eq_u32 s45, 163840
    s_cselect_b32 s45, 0, s45
    s_mov_b32 s46, 20
L_w2_lloop:
    s_waitcnt vmcnt(16)
    s_barrier
    s_add_u32 s49, s45, s53
    s_add_u32 s50, s45, s54
    s_add_u32 m0, s49, 0
    s_nop 0
    buffer_load_dwordx4 v8, s[8:11], s47 offen lds
    s_add_u32 m0, s49, 4096
    s_nop 0
    buffer_load_dwordx4 v9, s[8:11], s47 offen lds
    s_add_u32 m0, s50, 0
    s_nop 0
    buffer_load_dwordx4 v12, s[12:15], s48 offen lds
    s_add_u32 m0, s50, 1024
    s_nop 0
    buffer_load_dwordx4 v13, s[12:15], s48 offen lds
    s_add_u32 m0, s49, 8192
    s_nop 0
    buffer_load_dwordx4 v10, s[8:11], s47 offen lds
    s_add_u32 m0, s49, 12288
    s_nop 0
    buffer_load_dwordx4 v11, s[8:11], s47 offen lds
    s_add_u32 m0, s50, 8192
    s_nop 0
    buffer_load_dwordx4 v14, s[12:15], s48 offen lds
    s_add_u32 m0, s50, 9216
    s_nop 0
    buffer_load_dwordx4 v15, s[12:15], s48 offen lds
    s_add_u32 s62, s62, s55
    s_cmp_ge_u32 s62, s59
    s_cselect_b32 s43, 23, 0
    s_sub_u32 s62, s62, s43
    s_lshl_b32 s47, s62, 18
    s_add_u32 s63, s63, s55
    s_cmp_ge_u32 s63, s59
    s_cselect_b32 s43, 23, 0
    s_sub_u32 s63, s63, s43
    s_mul_i32 s48, s63, 131072
    s_add_u32 s45, s45, 32768
    s_cmp_eq_u32 s45, 163840
    s_cselect_b32 s45, 0, s45
    s_sub_u32 s46, s46, 1
    s_cmp_lg_u32 s46, 0
    s_cbranch_scc1 L_w2_lloop
    s_waitcnt vmcnt(16)
    s_barrier
    s_add_u32 s49, s45, s53
    s_cmp_eq_u32 s58, 0
    s_cselect_b32 s62, 24, 31
    s_cselect_b32 s55, 1, -1
    s_mov_b32 s63, s62
    s_mov_b32 s59, 1000
    s_lshl_b32 s47, s62, 18
    s_mul_i32 s48, s63, 131072
    s_add_u32 s50, s45, s54
    s_add_u32 m0, s49, 0
    s_nop 0
    buffer_load_dwordx4 v8, s[8:11], s47 offen lds
    s_add_u32 m0, s49, 4096
    s_nop 0
    buffer_load_dwordx4 v9, s[8:11], s47 offen lds
    s_add_u32 m0, s50, 0
    s_nop 0
    buffer_load_dwordx4 v12, s[12:15], s48 offen lds
    s_add_u32 m0, s49, 8192
    s_nop 0
    buffer_load_dwordx4 v10, s[8:11], s47 offen lds
    s_add_u32 m0, s49, 12288
    s_nop 0
    buffer_load_dwordx4 v11, s[8:11], s47 offen lds
    s_add_u32 m0, s50, 8192
    s_nop 0
    buffer_load_dwordx4 v14, s[12:15], s48 offen lds
    s_add_u32 s62, s62, s55
    s_cmp_ge_u32 s62, s59
    s_cselect_b32 s43, 23, 0
    s_sub_u32 s62, s62, s43
    s_lshl_b32 s47, s62, 18
    s_add_u32 s63, s63, s55
    s_cmp_ge_u32 s63, s59
    s_cselect_b32 s43, 23, 0
    s_sub_u32 s63, s63, s43
    s_mul_i32 s48, s63, 131072
    s_add_u32 s45, s45, 32768
    s_cmp_eq_u32 s45, 163840
    s_cselect_b32 s45, 0, s45
    s_waitcnt vmcnt(14)
    s_barrier
    s_add_u32 s49, s45, s53
    s_add_u32 s50, s45, s54
    s_add_u32 m0, s49, 0
    s_nop 0
    buffer_load_dwordx4 v8, s[8:11], s47 offen lds
    s_add_u32 m0, s49, 4096
    s_nop 0
    buffer_load_dwordx4 v9, s[8:11], s47 offen lds
    s_add_u32 m0, s50, 0
    s_nop 0
    buffer_load_dwordx4 v12, s[12:15], s48 offen lds
    s_add_u32 m0, s49, 8192
    s_nop 0
    buffer_load_dwordx4 v10, s[8:11], s47 offen lds
    s_add_u32 m0, s49, 12288
    s_nop 0
    buffer_load_dwordx4 v11, s[8:11], s47 offen lds
    s_add_u32 m0, s50, 8192
    s_nop 0
    buffer_load_dwordx4 v14, s[12:15], s48 offen lds
    s_add_u32 s62, s62, s55
    s_cmp_ge_u32 s62, s59
    s_cselect_b32 s43, 23, 0
    s_sub_u32 s62, s62, s43
    s_lshl_b32 s47, s62, 18
    s_add_u32 s63, s63, s55
    s_cmp_ge_u32 s63, s59
    s_cselect_b32 s43, 23, 0
    s_sub_u32 s63, s63, s43
    s_mul_i32 s48, s63, 131072
    s_add_u32 s45, s45, 32768
    s_cmp_eq_u32 s45, 163840
    s_cselect_b32 s45, 0, s45
    s_waitcnt vmcnt(12)
    s_barrier
    s_add_u32 s49, s45, s53
    s_add_u32 s50, s45, s54
    s_add_u32 m0, s49, 0
    s_nop 0
    buffer_load_dwordx4 v8, s[8:11], s47 offen lds
    s_add_u32 m0, s49, 4096
    s_nop 0
    buffer_load_dwordx4 v9, s[8:11], s47 offen lds
    s_add_u32 m0, s50, 0
    s_nop 0
    buffer_load_dwordx4 v12, s[12:15], s48 offen lds
    s_add_u32 m0, s49, 8192
    s_nop 0
    buffer_load_dwordx4 v10, s[8:11], s47 offen lds
    s_add_u32 m0, s49, 12288
    s_nop 0
    buffer_load_dwordx4 v11, s[8:11], s47 offen lds
    s_add_u32 m0, s50, 8192
    s_nop 0
    buffer_load_dwordx4 v14, s[12:15], s48 offen lds
    s_add_u32 s62, s62, s55
    s_cmp_ge_u32 s62, s59
    s_cselect_b32 s43, 23, 0
    s_sub_u32 s62, s62, s43
    s_lshl_b32 s47, s62, 18
    s_add_u32 s63, s63, s55
    s_cmp_ge_u32 s63, s59
    s_cselect_b32 s43, 23, 0
    s_sub_u32 s63, s63, s43
    s_mul_i32 s48, s63, 131072
    s_add_u32 s45, s45, 32768
    s_cmp_eq_u32 s45, 163840
    s_cselect_b32 s45, 0, s45
    s_waitcnt vmcnt(12)
    s_barrier
    s_add_u32 s49, s45, s53
    s_add_u32 s50, s45, s54
    s_add_u32 m0, s49, 0
    s_nop 0
    buffer_load_dwordx4 v8, s[8:11], s47 offen lds
    s_add_u32 m0, s49, 4096
    s_nop 0
    buffer_load_dwordx4 v9, s[8:11], s47 offen lds
    s_add_u32 m0, s50, 0
    s_nop 0
    buffer_load_dwordx4 v12, s[12:15], s48 offen lds
    s_add_u32 m0, s49, 8192
    s_nop 0
    buffer_load_dwordx4 v10, s[8:11], s47 offen lds
    s_add_u32 m0, s49, 12288
    s_nop 0
    buffer_load_dwordx4 v11, s[8:11], s47 offen lds
    s_add_u32 m0, s50, 8192
    s_nop 0
    buffer_load_dwordx4 v14, s[12:15], s48 offen lds
    s_add_u32 s62, s62, s55
    s_cmp_ge_u32 s62, s59
    s_cselect_b32 s43, 23, 0
    s_sub_u32 s62, s62, s43
    s_lshl_b32 s47, s62, 18
    s_add_u32 s63, s63, s55
    s_cmp_ge_u32 s63, s59
    s_cselect_b32 s43, 23, 0
    s_sub_u32 s63, s63, s43
    s_mul_i32 s48, s63, 131072
    s_add_u32 s45, s45, 32768
    s_cmp_eq_u32 s45, 163840
    s_cselect_b32 s45, 0, s45
    s_waitcnt vmcnt(12)
    s_barrier
    s_add_u32 s49, s45, s53
    s_add_u32 s50, s45, s54
    s_add_u32 m0, s49, 0
    s_nop 0
    buffer_load_dwordx4 v8, s[8:11], s47 offen lds
    s_add_u32 m0, s49, 4096
    s_nop 0
    buffer_load_dwordx4 v9, s[8:11], s47 offen lds
    s_add_u32 m0, s50, 0
    s_nop 0
    buffer_load_dwordx4 v12, s[12:15], s48 offen lds
    s_add_u32 m0, s49, 8192
    s_nop 0
    buffer_load_dwordx4 v10, s[8:11], s47 offen lds
    s_add_u32 m0, s49, 12288
    s_nop 0
    buffer_load_dwordx4 v11, s[8:11], s47 offen lds
    s_add_u32 m0, s50, 8192
    s_nop 0
    buffer_load_dwordx4 v14, s[12:15], s48 offen lds
    s_add_u32 s62, s62, s55
    s_cmp_ge_u32 s62, s59
    s_cselect_b32 s43, 23, 0
    s_sub_u32 s62, s62, s43
    s_lshl_b32 s47, s62, 18
    s_add_u32 s63, s63, s55
    s_cmp_ge_u32 s63, s59
    s_cselect_b32 s43, 23, 0
    s_sub_u32 s63, s63, s43
    s_mul_i32 s48, s63, 131072
    s_add_u32 s45, s45, 32768
    s_cmp_eq_u32 s45, 163840
    s_cselect_b32 s45, 0, s45
    s_waitcnt vmcnt(12)
    s_barrier
    s_add_u32 s49, s45, s53
    s_add_u32 s50, s45, s54
    s_add_u32 m0, s49, 0
    s_nop 0
    buffer_load_dwordx4 v8, s[8:11], s47 offen lds
    s_add_u32 m0, s49, 4096
    s_nop 0
    buffer_load_dwordx4 v9, s[8:11], s47 offen lds
    s_add_u32 m0, s50, 0
    s_nop 0
    buffer_load_dwordx4 v12, s[12:15], s48 offen lds
    s_add_u32 m0, s49, 8192
    s_nop 0
    buffer_load_dwordx4 v10, s[8:11], s47 offen lds
    s_add_u32 m0, s49, 12288
    s_nop 0
    buffer_load_dwordx4 v11, s[8:11], s47 offen lds
    s_add_u32 m0, s50, 8192
    s_nop 0
    buffer_load_dwordx4 v14, s[12:15], s48 offen lds
    s_add_u32 s62, s62, s55
    s_cmp_ge_u32 s62, s59
    s_cselect_b32 s43, 23, 0
    s_sub_u32 s62, s62, s43
    s_lshl_b32 s47, s62, 18
    s_add_u32 s63, s63, s55
    s_cmp_ge_u32 s63, s59
    s_cselect_b32 s43, 23, 0
    s_sub_u32 s63, s63, s43
    s_mul_i32 s48, s63, 131072
    s_add_u32 s45, s45, 32768
    s_cmp_eq_u32 s45, 163840
    s_cselect_b32 s45, 0, s45
    s_waitcnt vmcnt(12)
    s_barrier
    s_add_u32 s49, s45, s53
    s_add_u32 s50, s45, s54
    s_add_u32 m0, s49, 0
    s_nop 0
    buffer_load_dwordx4 v8, s[8:11], s47 offen lds
    s_add_u32 m0, s49, 4096
    s_nop 0
    buffer_load_dwordx4 v9, s[8:11], s47 offen lds
    s_add_u32 m0, s50, 0
    s_nop 0
    buffer_load_dwordx4 v12, s[12:15], s48 offen lds
    s_add_u32 m0, s49, 8192
    s_nop 0
    buffer_load_dwordx4 v10, s[8:11], s47 offen lds
    s_add_u32 m0, s49, 12288
    s_nop 0
    buffer_load_dwordx4 v11, s[8:11], s47 offen lds
    s_add_u32 m0, s50, 8192
    s_nop 0
    buffer_load_dwordx4 v14, s[12:15], s48 offen lds
    s_add_u32 s62, s62, s55
    s_cmp_ge_u32 s62, s59
    s_cselect_b32 s43, 23, 0
    s_sub_u32 s62, s62, s43
    s_lshl_b32 s47, s62, 18
    s_add_u32 s63, s63, s55
    s_cmp_ge_u32 s63, s59
    s_cselect_b32 s43, 23, 0
    s_sub_u32 s63, s63, s43
    s_mul_i32 s48, s63, 131072
    s_add_u32 s45, s45, 32768
    s_cmp_eq_u32 s45, 163840
    s_cselect_b32 s45, 0, s45
    s_waitcnt vmcnt(12)
    s_barrier
    s_add_u32 s49, s45, s53
    s_add_u32 s50, s45, s54
    s_add_u32 m0, s49, 0
    s_nop 0
    buffer_load_dwordx4 v8, s[8:11], s47 offen lds
    s_add_u32 m0, s49, 4096
    s_nop 0
    buffer_load_dwordx4 v9, s[8:11], s47 offen lds
    s_add_u32 m0, s50, 0
    s_nop 0
    buffer_load_dwordx4 v12, s[12:15], s48 offen lds
    s_add_u32 m0, s49, 8192
    s_nop 0
    buffer_load_dwordx4 v10, s[8:11], s47 offen lds
    s_add_u32 m0, s49, 12288
    s_nop 0
    buffer_load_dwordx4 v11, s[8:11], s47 offen lds
    s_add_u32 m0, s50, 8192
    s_nop 0
    buffer_load_dwordx4 v14, s[12:15], s48 offen lds
    s_add_u32 s62, s62, s55
    s_cmp_ge_u32 s62, s59
    s_cselect_b32 s43, 23, 0
    s_sub_u32 s62, s62, s43
    s_lshl_b32 s47, s62, 18
    s_add_u32 s63, s63, s55
    s_cmp_ge_u32 s63, s59
    s_cselect_b32 s43, 23, 0
    s_sub_u32 s63, s63, s43
    s_mul_i32 s48, s63, 131072
    s_add_u32 s45, s45, 32768
    s_cmp_eq_u32 s45, 163840
    s_cselect_b32 s45, 0, s45
    s_waitcnt vmcnt(12)
    s_barrier
    s_add_u32 s49, s45, s53
    s_lshl_b32 s47, s42, 18
    s_add_u32 m0, s49, 0
    s_nop 0
    buffer_load_dwordx4 v40, s[20:23], s47 offen lds
    s_add_u32 m0, s49, 4096
    s_nop 0
    buffer_load_dwordx4 v41, s[20:23], s47 offen lds
    s_add_u32 m0, s49, 8192
    s_nop 0
    buffer_load_dwordx4 v42, s[20:23], s47 offen lds
    s_add_u32 m0, s49, 12288
    s_nop 0
    buffer_load_dwordx4 v43, s[20:23], s47 offen lds
    s_waitcnt vmcnt(10)
    s_barrier
    s_waitcnt vmcnt(4)
    s_barrier
    s_waitcnt vmcnt(0)
    s_barrier
    s_cmp_eq_u32 s3, 0
    s_cbranch_scc1 L_w2_end
    s_mov_b32 s60, s56
    s_and_b32 s61, s57, 0xffff
    s_mov_b32 s62, 6291456
    s_mov_b32 s63, 131072
    s_lshr_b32 s43, s2, 3
    s_and_b32 s43, s43, 31
    s_and_b32 s44, s2, 7
    s_lshl_b32 s43, s43, 5
    v_add_u32 v1, s43, v0
    v_mul_u32_u24 v5, 6144, v1
    s_lshr_b32 s44, s44, 1
    s_lshl_b32 s43, s44, 9
    s_add_u32 s43, s43, 384
    v_add_u32 v5, s43, v5
    s_lshl_b32 s43, s51, 11
    v_add_u32 v5, s43, v5
    s_and_b32 s44, s44, 1
    s_cmp_eq_u32 s51, 3
    s_cselect_b32 s44, 1, s44
    s_cmp_eq_u32 s44, 0
    s_cselect_b32 s44, 32, 0
    v_cmp_gt_u32 vcc, s44, v0
    v_mov_b32 v1, 2146435072
    s_nop 0
    v_cndmask_b32 v5, v1, v5, vcc
    buffer_load_dword v6, v5, s[60:63], 0 offen
    s_lshr_b32 s43, s2, 3
    s_lshl_b32 s43, s43, 2
    s_add_u32 s43, s43, s51
    s_cmp_ge_u32 s43, 2
    s_cbranch_scc1 L_w2_nct15
    s_getpc_b64 s[64:65]
L_w2_pc14:
    s_sub_u32 s64, s64, L_w2_pc14-code_start
    s_subb_u32 s65, s65, 0
    v_lshl_add_u32 v2, s43, 6, v0
    v_lshlrev_b32 v2, 7, v2
    v_add_u32 v2, cs_qkv-code_start, v2
    v_min_u32 v2, ce_qkv-code_start-4, v2
    v_mov_b32 v3, s65
    v_add_co_u32 v2, vcc, s64, v2
    s_nop 1
    v_addc_co_u32 v3, vcc, 0, v3, vcc
    global_load_dword v7, v[2:3], off
L_w2_nct15:
    s_barrier
    s_cmp_eq_u32 s3, 0
    s_cbranch_scc1 L_w2_end
    s_branch L_sync_w2
L_w2_end:
    s_endpgm
L_w2_compute:
    s_lshr_b32 s51, s40, 1
    s_and_b32 s52, s40, 1
    v_and_b32 v1, 15, v0
    v_lshrrev_b32 v2, 4, v0
    v_lshrrev_b32 v3, 1, v1
    v_xor_b32 v3, v3, v2
    v_lshlrev_b32 v3, 4, v3
    v_lshl_add_u32 v7, v1, 7, v3
    s_lshl_b32 s43, s51, 13
    v_add_u32 v7, s43, v7
    v_xor_b32 v8, 64, v7
    v_lshrrev_b32 v3, 2, v1
    v_and_b32 v4, 3, v1
    v_lshlrev_b32 v3, 6, v3
    v_lshl_add_u32 v3, v4, 3, v3
    v_and_b32 v4, 1, v2
    v_lshl_add_u32 v5, v4, 5, v3
    v_mul_u32_u24 v6, 2048, v2
    v_add_u32 v9, v5, v6
    s_lshl_b32 s43, s52, 8
    s_add_u32 s43, s43, 16384
    v_add_u32 v9, s43, v9
    v_xor_b32 v10, 32, v9
    s_waitcnt lgkmcnt(0)
    s_mov_b32 s16, s32
    s_and_b32 s17, s33, 0xffff
    s_mov_b32 s18, 4194304
    s_mov_b32 s19, 131072
    s_add_u32 s24, s30, 37748736
    s_addc_u32 s25, s31, 0
    s_and_b32 s25, s25, 0xffff
    s_mov_b32 s26, 2097152
    s_mov_b32 s27, 131072
    s_mov_b32 s36, s34
    s_and_b32 s37, s35, 0xffff
    s_mov_b32 s38, 2048
    s_mov_b32 s39, 131072
    v_lshrrev_b32 v3, 3, v1
    v_sub_u32 v3, v2, v3
    v_and_b32 v4, 1, v1
    v_lshlrev_b32 v4, 4, v4
    v_mov_b32 v5, 0x3f80
    v_lshlrev_b32 v4, v4, v5
    v_bfe_u32 v5, v1, 1, 2
    v_lshl_add_u32 v3, v3, 1, v5
    v_lshrrev_b32 v5, 3, v1
    v_xor_b32 v5, v5, v2
    v_and_b32 v5, 1, v5
    v_lshl_add_u32 v3, v5, 8, v3
    v_cmp_eq_u32 vcc, 0, v3
    s_nop 1
    v_cndmask_b32 v148, 0, v4, vcc
    v_cmp_eq_u32 vcc, 1, v3
    s_nop 1
    v_cndmask_b32 v149, 0, v4, vcc
    v_cmp_eq_u32 vcc, 2, v3
    s_nop 1
    v_cndmask_b32 v150, 0, v4, vcc
    v_cmp_eq_u32 vcc, 3, v3
    s_nop 1
    v_cndmask_b32 v151, 0, v4, vcc
    v_cmp_eq_u32 vcc, 4, v3
    s_nop 1
    v_cndmask_b32 v152, 0, v4, vcc
    v_cmp_eq_u32 vcc, 5, v3
    s_nop 1
    v_cndmask_b32 v153, 0, v4, vcc
    v_cmp_eq_u32 vcc, 6, v3
    s_nop 1
    v_cndmask_b32 v154, 0, v4, vcc
    v_cmp_eq_u32 vcc, 7, v3
    s_nop 1
    v_cndmask_b32 v155, 0, v4, vcc
    s_lshl_b32 s43, s52, 6
    v_xor_b32 v157, s43, v7
    v_mov_b32 v20, 0
    v_mov_b32 v21, 0
    v_mov_b32 v22, 0
    v_mov_b32 v23, 0
    v_mov_b32 v24, 0
    v_mov_b32 v25, 0
    v_mov_b32 v26, 0
    v_mov_b32 v27, 0
    v_mov_b32 v28, 0
    v_mov_b32 v29, 0
    v_mov_b32 v30, 0
    v_mov_b32 v31, 0
    v_mov_b32 v32, 0
    v_mov_b32 v33, 0
    v_mov_b32 v34, 0
    v_mov_b32 v35, 0
    v_mov_b32 v36, 0
    v_mov_b32 v37, 0
    v_mov_b32 v38, 0
    v_mov_b32 v39, 0
    v_mov_b32 v40, 0
    v_mov_b32 v41, 0
    v_mov_b32 v42, 0
    v_mov_b32 v43, 0
    v_mov_b32 v44, 0
    v_mov_b32 v45, 0
    v_mov_b32 v46, 0
    v_mov_b32 v47, 0
    v_mov_b32 v48, 0
    v_mov_b32 v49, 0
    v_mov_b32 v50, 0
    v_mov_b32 v51, 0
    v_mov_b32 v52, 0
    v_mov_b32 v53, 0
    v_mov_b32 v54, 0
    v_mov_b32 v55, 0
    v_mov_b32 v56, 0
    v_mov_b32 v57, 0
    v_mov_b32 v58, 0
    v_mov_b32 v59, 0
    v_mov_b32 v60, 0
    v_mov_b32 v61, 0
    v_mov_b32 v62, 0
    v_mov_b32 v63, 0
    v_mov_b32 v64, 0
    v_mov_b32 v65, 0
    v_mov_b32 v66, 0
    v_mov_b32 v67, 0
    v_mov_b32 v68, 0
    v_mov_b32 v69, 0
    v_mov_b32 v70, 0
    v_mov_b32 v71, 0
    v_mov_b32 v72, 0
    v_mov_b32 v73, 0
    v_mov_b32 v74, 0
    v_mov_b32 v75, 0
    v_mov_b32 v76, 0
    v_mov_b32 v77, 0
    v_mov_b32 v78, 0
    v_mov_b32 v79, 0
    v_mov_b32 v80, 0
    v_mov_b32 v81, 0
    v_mov_b32 v82, 0
    v_mov_b32 v83, 0
    s_lshl_b32 s43, s42, 7
    s_lshl_b32 s44, s52, 6
    s_add_u32 s43, s43, s44
    v_lshl_add_u32 v5, v2, 3, s43
    buffer_load_dwordx2 v[158:159], v5, s[36:39], 0 offen offset:0
    buffer_load_dwordx2 v[160:161], v5, s[36:39], 0 offen offset:32
    s_mov_b32 s45, 0
    s_cmp_eq_u32 s99, -1
    s_cbranch_scc1 L_w2_dwe1
    s_barrier
L_w2_dwe1:
    s_add_u32 s68, s30, s29
    s_addc_u32 s69, s31, 0
    s_add_u32 s68, s68, 41943040
    s_addc_u32 s69, s69, 0
    s_and_b32 s69, s69, 0xffff
    s_mov_b32 s70, 8388608
    s_mov_b32 s71, 131072
    v_lshlrev_b32 v202, 4, v0
    s_lshl_b32 s43, s3, 17
    v_mov_b32 v203, s43
    v_mov_b32 v204, s95
    s_mov_b32 s46, 23
    v_add_u32 v12, s45, v7
    v_add_u32 v13, s45, v8
    v_add_u32 v14, s45, v9
    v_add_u32 v15, s45, v10
    s_barrier
    ds_read_b128 v[84:87], v12 offset:0
    ds_read_b64_tr_b16 v[100:101], v14 offset:0
    ds_read_b64_tr_b16 v[102:103], v14 offset:512
    ds_read_b64_tr_b16 v[104:105], v15 offset:0
    ds_read_b64_tr_b16 v[106:107], v15 offset:512
    ds_read_b128 v[88:91], v12 offset:2048
    ds_read_b128 v[92:95], v12 offset:4096
    ds_read_b128 v[96:99], v12 offset:6144
    ds_read_b64_tr_b16 v[108:109], v14 offset:1024
    ds_read_b64_tr_b16 v[110:111], v14 offset:1536
    ds_read_b64_tr_b16 v[112:113], v15 offset:1024
    ds_read_b64_tr_b16 v[114:115], v15 offset:1536
L_w2_cloop:
    s_waitcnt lgkmcnt(0)
    v_mfma_f32_16x16x32_bf16 v[20:23], v[100:103], v[84:87], v[20:23]
    ds_read_b128 v[116:119], v13 offset:0
    v_mfma_f32_16x16x32_bf16 v[36:39], v[100:103], v[88:91], v[36:39]
    ds_read_b64_tr_b16 v[132:133], v14 offset:8192
    v_mfma_f32_16x16x32_bf16 v[52:55], v[100:103], v[92:95], v[52:55]
    ds_read_b64_tr_b16 v[134:135], v14 offset:8704
    v_mfma_f32_16x16x32_bf16 v[68:71], v[100:103], v[96:99], v[68:71]
    ds_read_b64_tr_b16 v[136:137], v15 offset:8192
    v_mfma_f32_16x16x32_bf16 v[24:27], v[104:107], v[84:87], v[24:27]
    ds_read_b64_tr_b16 v[138:139], v15 offset:8704
    v_mfma_f32_16x16x32_bf16 v[40:43], v[104:107], v[88:91], v[40:43]
    ds_read_b128 v[120:123], v13 offset:2048
    v_mfma_f32_16x16x32_bf16 v[56:59], v[104:107], v[92:95], v[56:59]
    ds_read_b128 v[124:127], v13 offset:4096
    v_mfma_f32_16x16x32_bf16 v[72:75], v[104:107], v[96:99], v[72:75]
    ds_read_b128 v[128:131], v13 offset:6144
    v_mfma_f32_16x16x32_bf16 v[28:31], v[108:111], v[84:87], v[28:31]
    ds_read_b64_tr_b16 v[140:141], v14 offset:9216
    v_mfma_f32_16x16x32_bf16 v[44:47], v[108:111], v[88:91], v[44:47]
    ds_read_b64_tr_b16 v[142:143], v14 offset:9728
    v_mfma_f32_16x16x32_bf16 v[60:63], v[108:111], v[92:95], v[60:63]
    ds_read_b64_tr_b16 v[144:145], v15 offset:9216
    v_mfma_f32_16x16x32_bf16 v[76:79], v[108:111], v[96:99], v[76:79]
    ds_read_b64_tr_b16 v[146:147], v15 offset:9728
    v_mfma_f32_16x16x32_bf16 v[32:35], v[112:115], v[84:87], v[32:35]
    v_mfma_f32_16x16x32_bf16 v[48:51], v[112:115], v[88:91], v[48:51]
    v_mfma_f32_16x16x32_bf16 v[64:67], v[112:115], v[92:95], v[64:67]
    v_mfma_f32_16x16x32_bf16 v[80:83], v[112:115], v[96:99], v[80:83]
    s_add_u32 s45, s45, 32768
    s_cmp_eq_u32 s45, 163840
    s_cselect_b32 s45, 0, s45
    s_waitcnt lgkmcnt(0)
    s_barrier
    v_add_u32 v12, s45, v7
    v_add_u32 v13, s45, v8
    v_add_u32 v14, s45, v9
    v_add_u32 v15, s45, v10
    v_mfma_f32_16x16x32_bf16 v[20:23], v[132:135], v[116:119], v[20:23]
    ds_read_b128 v[84:87], v12 offset:0
    v_mfma_f32_16x16x32_bf16 v[36:39], v[132:135], v[120:123], v[36:39]
    ds_read_b64_tr_b16 v[100:101], v14 offset:0
    v_mfma_f32_16x16x32_bf16 v[52:55], v[132:135], v[124:127], v[52:55]
    ds_read_b64_tr_b16 v[102:103], v14 offset:512
    v_mfma_f32_16x16x32_bf16 v[68:71], v[132:135], v[128:131], v[68:71]
    ds_read_b64_tr_b16 v[104:105], v15 offset:0
    v_mfma_f32_16x16x32_bf16 v[24:27], v[136:139], v[116:119], v[24:27]
    ds_read_b64_tr_b16 v[106:107], v15 offset:512
    v_mfma_f32_16x16x32_bf16 v[40:43], v[136:139], v[120:123], v[40:43]
    ds_read_b128 v[88:91], v12 offset:2048
    v_mfma_f32_16x16x32_bf16 v[56:59], v[136:139], v[124:127], v[56:59]
    ds_read_b128 v[92:95], v12 offset:4096
    v_mfma_f32_16x16x32_bf16 v[72:75], v[136:139], v[128:131], v[72:75]
    ds_read_b128 v[96:99], v12 offset:6144
    v_mfma_f32_16x16x32_bf16 v[28:31], v[140:143], v[116:119], v[28:31]
    ds_read_b64_tr_b16 v[108:109], v14 offset:1024
    v_mfma_f32_16x16x32_bf16 v[44:47], v[140:143], v[120:123], v[44:47]
    ds_read_b64_tr_b16 v[110:111], v14 offset:1536
    v_mfma_f32_16x16x32_bf16 v[60:63], v[140:143], v[124:127], v[60:63]
    ds_read_b64_tr_b16 v[112:113], v15 offset:1024
    v_mfma_f32_16x16x32_bf16 v[76:79], v[140:143], v[128:131], v[76:79]
    ds_read_b64_tr_b16 v[114:115], v15 offset:1536
    v_mfma_f32_16x16x32_bf16 v[32:35], v[144:147], v[116:119], v[32:35]
    v_mfma_f32_16x16x32_bf16 v[48:51], v[144:147], v[120:123], v[48:51]
    v_mfma_f32_16x16x32_bf16 v[64:67], v[144:147], v[124:127], v[64:67]
    v_mfma_f32_16x16x32_bf16 v[80:83], v[144:147], v[128:131], v[80:83]
    s_sub_u32 s46, s46, 1
    s_cmp_lg_u32 s46, 0
    s_cbranch_scc1 L_w2_cloop
    s_waitcnt lgkmcnt(0)
    v_mfma_f32_16x16x32_bf16 v[20:23], v[100:103], v[84:87], v[20:23]
    ds_read_b128 v[116:119], v13 offset:0
    v_mfma_f32_16x16x32_bf16 v[36:39], v[100:103], v[88:91], v[36:39]
    ds_read_b64_tr_b16 v[132:133], v14 offset:8192
    v_mfma_f32_16x16x32_bf16 v[52:55], v[100:103], v[92:95], v[52:55]
    ds_read_b64_tr_b16 v[134:135], v14 offset:8704
    v_mfma_f32_16x16x32_bf16 v[68:71], v[100:103], v[96:99], v[68:71]
    ds_read_b64_tr_b16 v[136:137], v15 offset:8192
    v_mfma_f32_16x16x32_bf16 v[24:27], v[104:107], v[84:87], v[24:27]
    ds_read_b64_tr_b16 v[138:139], v15 offset:8704
    v_mfma_f32_16x16x32_bf16 v[40:43], v[104:107], v[88:91], v[40:43]
    ds_read_b128 v[120:123], v13 offset:2048
    v_mfma_f32_16x16x32_bf16 v[56:59], v[104:107], v[92:95], v[56:59]
    ds_read_b128 v[124:127], v13 offset:4096
    v_mfma_f32_16x16x32_bf16 v[72:75], v[104:107], v[96:99], v[72:75]
    ds_read_b128 v[128:131], v13 offset:6144
    v_mfma_f32_16x16x32_bf16 v[28:31], v[108:111], v[84:87], v[28:31]
    ds_read_b64_tr_b16 v[140:141], v14 offset:9216
    v_mfma_f32_16x16x32_bf16 v[44:47], v[108:111], v[88:91], v[44:47]
    ds_read_b64_tr_b16 v[142:143], v14 offset:9728
    v_mfma_f32_16x16x32_bf16 v[60:63], v[108:111], v[92:95], v[60:63]
    ds_read_b64_tr_b16 v[144:145], v15 offset:9216
    v_mfma_f32_16x16x32_bf16 v[76:79], v[108:111], v[96:99], v[76:79]
    ds_read_b64_tr_b16 v[146:147], v15 offset:9728
    v_mfma_f32_16x16x32_bf16 v[32:35], v[112:115], v[84:87], v[32:35]
    v_mfma_f32_16x16x32_bf16 v[48:51], v[112:115], v[88:91], v[48:51]
    v_mfma_f32_16x16x32_bf16 v[64:67], v[112:115], v[92:95], v[64:67]
    v_mfma_f32_16x16x32_bf16 v[80:83], v[112:115], v[96:99], v[80:83]
    s_add_u32 s45, s45, 32768
    s_cmp_eq_u32 s45, 163840
    s_cselect_b32 s45, 0, s45
    s_waitcnt lgkmcnt(0)
    s_barrier
    v_add_u32 v12, s45, v7
    v_add_u32 v13, s45, v8
    v_add_u32 v14, s45, v9
    v_add_u32 v15, s45, v10
    v_mfma_f32_16x16x32_bf16 v[28:31], v[140:143], v[116:119], v[28:31]
    ds_read_b128 v[84:87], v12 offset:0
    v_mfma_f32_16x16x32_bf16 v[44:47], v[140:143], v[120:123], v[44:47]
    ds_read_b64_tr_b16 v[100:101], v14 offset:0
    v_mfma_f32_16x16x32_bf16 v[60:63], v[140:143], v[124:127], v[60:63]
    v_mfma_f32_16x16x32_bf16 v[76:79], v[140:143], v[128:131], v[76:79]
    ds_read_b64_tr_b16 v[102:103], v14 offset:512
    v_mfma_f32_16x16x32_bf16 v[32:35], v[144:147], v[116:119], v[32:35]
    ds_read_b64_tr_b16 v[104:105], v15 offset:0
    v_mfma_f32_16x16x32_bf16 v[48:51], v[144:147], v[120:123], v[48:51]
    v_mfma_f32_16x16x32_bf16 v[64:67], v[144:147], v[124:127], v[64:67]
    ds_read_b64_tr_b16 v[106:107], v15 offset:512
    v_mfma_f32_16x16x32_bf16 v[80:83], v[144:147], v[128:131], v[80:83]
    ds_read_b128 v[88:91], v12 offset:2048
    v_mfma_f32_16x16x32_bf16 v[20:23], v[132:135], v[116:119], v[20:23]
    v_mfma_f32_16x16x32_bf16 v[36:39], v[132:135], v[120:123], v[36:39]
    ds_read_b128 v[92:95], v12 offset:4096
    v_mfma_f32_16x16x32_bf16 v[52:55], v[132:135], v[124:127], v[52:55]
    ds_read_b128 v[96:99], v12 offset:6144
    v_mfma_f32_16x16x32_bf16 v[68:71], v[132:135], v[128:131], v[68:71]
    v_mfma_f32_16x16x32_bf16 v[24:27], v[136:139], v[116:119], v[24:27]
    v_mfma_f32_16x16x32_bf16 v[40:43], v[136:139], v[120:123], v[40:43]
    v_mfma_f32_16x16x32_bf16 v[56:59], v[136:139], v[124:127], v[56:59]
    v_mfma_f32_16x16x32_bf16 v[72:75], v[136:139], v[128:131], v[72:75]
    s_xor_b32 s59, s2, 1
    s_lshl_b32 s59, s59, 2
    s_add_u32 s59, s59, s40
    s_lshl_b32 s55, s59, 13
    buffer_store_dwordx4 v[28:31], v202, s[68:71], s55 offen offset:0 sc1
    buffer_store_dwordx4 v[32:35], v202, s[68:71], s55 offen offset:1024 sc1
    buffer_store_dwordx4 v[44:47], v202, s[68:71], s55 offen offset:2048 sc1
    buffer_store_dwordx4 v[48:51], v202, s[68:71], s55 offen offset:3072 sc1
    s_add_u32 s55, s55, 4096
    buffer_store_dwordx4 v[60:63], v202, s[68:71], s55 offen offset:0 sc1
    buffer_store_dwordx4 v[64:67], v202, s[68:71], s55 offen offset:1024 sc1
    buffer_store_dwordx4 v[76:79], v202, s[68:71], s55 offen offset:2048 sc1
    buffer_store_dwordx4 v[80:83], v202, s[68:71], s55 offen offset:3072 sc1
    s_lshl_b32 s59, s59, 7
    s_add_u32 s59, s59, 1572864
    s_mov_b32 s53, 0
L_w2_cloop2:
    s_waitcnt lgkmcnt(0)
    v_mfma_f32_16x16x32_bf16 v[20:23], v[100:103], v[84:87], v[20:23]
    ds_read_b128 v[116:119], v13 offset:0
    v_mfma_f32_16x16x32_bf16 v[36:39], v[100:103], v[88:91], v[36:39]
    ds_read_b64_tr_b16 v[132:133], v14 offset:8192
    v_mfma_f32_16x16x32_bf16 v[52:55], v[100:103], v[92:95], v[52:55]
    ds_read_b64_tr_b16 v[134:135], v14 offset:8704
    v_mfma_f32_16x16x32_bf16 v[68:71], v[100:103], v[96:99], v[68:71]
    ds_read_b64_tr_b16 v[136:137], v15 offset:8192
    v_mfma_f32_16x16x32_bf16 v[24:27], v[104:107], v[84:87], v[24:27]
    ds_read_b64_tr_b16 v[138:139], v15 offset:8704
    v_mfma_f32_16x16x32_bf16 v[40:43], v[104:107], v[88:91], v[40:43]
    ds_read_b128 v[120:123], v13 offset:2048
    v_mfma_f32_16x16x32_bf16 v[56:59], v[104:107], v[92:95], v[56:59]
    ds_read_b128 v[124:127], v13 offset:4096
    v_mfma_f32_16x16x32_bf16 v[72:75], v[104:107], v[96:99], v[72:75]
    ds_read_b128 v[128:131], v13 offset:6144
    s_bitcmp1_b32 80, s53
    s_cbranch_scc1 L_w2_ool5
L_w2_back6:
    s_add_u32 s45, s45, 32768
    s_cmp_eq_u32 s45, 163840
    s_cselect_b32 s45, 0, s45
    s_waitcnt lgkmcnt(0)
    s_barrier
    v_add_u32 v12, s45, v7
    v_add_u32 v13, s45, v8
    v_add_u32 v14, s45, v9
    v_add_u32 v15, s45, v10
    v_mfma_f32_16x16x32_bf16 v[20:23], v[132:135], v[116:119], v[20:23]
    ds_read_b128 v[84:87], v12 offset:0
    v_mfma_f32_16x16x32_bf16 v[36:39], v[132:135], v[120:123], v[36:39]
    ds_read_b64_tr_b16 v[100:101], v14 offset:0
    v_mfma_f32_16x16x32_bf16 v[52:55], v[132:135], v[124:127], v[52:55]
    ds_read_b64_tr_b16 v[102:103], v14 offset:512
    v_mfma_f32_16x16x32_bf16 v[68:71], v[132:135], v[128:131], v[68:71]
    ds_read_b64_tr_b16 v[104:105], v15 offset:0
    v_mfma_f32_16x16x32_bf16 v[24:27], v[136:139], v[116:119], v[24:27]
    ds_read_b64_tr_b16 v[106:107], v15 offset:512
    v_mfma_f32_16x16x32_bf16 v[40:43], v[136:139], v[120:123], v[40:43]
    ds_read_b128 v[88:91], v12 offset:2048
    v_mfma_f32_16x16x32_bf16 v[56:59], v[136:139], v[124:127], v[56:59]
    ds_read_b128 v[92:95], v12 offset:4096
    v_mfma_f32_16x16x32_bf16 v[72:75], v[136:139], v[128:131], v[72:75]
    ds_read_b128 v[96:99], v12 offset:6144
    s_add_u32 s53, s53, 1
    s_cmp_lg_u32 s53, 7
    s_cbranch_scc1 L_w2_cloop2
    s_waitcnt lgkmcnt(0)
    v_mfma_f32_16x16x32_bf16 v[20:23], v[100:103], v[84:87], v[20:23]
    ds_read_b128 v[116:119], v13 offset:0
    v_mfma_f32_16x16x32_bf16 v[36:39], v[100:103], v[88:91], v[36:39]
    ds_read_b64_tr_b16 v[132:133], v14 offset:8192
    v_mfma_f32_16x16x32_bf16 v[52:55], v[100:103], v[92:95], v[52:55]
    ds_read_b64_tr_b16 v[134:135], v14 offset:8704
    v_mfma_f32_16x16x32_bf16 v[68:71], v[100:103], v[96:99], v[68:71]
    ds_read_b64_tr_b16 v[136:137], v15 offset:8192
    v_mfma_f32_16x16x32_bf16 v[24:27], v[104:107], v[84:87], v[24:27]
    ds_read_b64_tr_b16 v[138:139], v15 offset:8704
    v_mfma_f32_16x16x32_bf16 v[40:43], v[104:107], v[88:91], v[40:43]
    ds_read_b128 v[120:123], v13 offset:2048
    v_mfma_f32_16x16x32_bf16 v[56:59], v[104:107], v[92:95], v[56:59]
    ds_read_b128 v[124:127], v13 offset:4096
    v_mfma_f32_16x16x32_bf16 v[72:75], v[104:107], v[96:99], v[72:75]
    ds_read_b128 v[128:131], v13 offset:6144
    s_mov_b32 s46, 0x400000
L_w2_poll:
    s_waitcnt vmcnt(0)
    v_readfirstlane_b32 s43, v204
    s_sub_u32 s46, s46, 1
    s_cbranch_scc1 L_w2_got
    s_cmp_eq_u32 s43, s95
    s_cbranch_scc1 L_w2_got
    s_sleep 1
    s_mov_b64 exec, 1
    buffer_load_dword v204, v203, s[24:27], s59 offen sc1
    s_mov_b64 exec, -1
    s_branch L_w2_poll
L_w2_got:
    buffer_load_dwordx4 v[170:173], v202, s[68:71], s55 offen offset:0 sc1
    buffer_load_dwordx4 v[174:177], v202, s[68:71], s55 offen offset:1024 sc1
    buffer_load_dwordx4 v[178:181], v202, s[68:71], s55 offen offset:2048 sc1
    buffer_load_dwordx4 v[182:185], v202, s[68:71], s55 offen offset:3072 sc1
    s_add_u32 s55, s55, 4096
    buffer_load_dwordx4 v[186:189], v202, s[68:71], s55 offen offset:0 sc1
    buffer_load_dwordx4 v[190:193], v202, s[68:71], s55 offen offset:1024 sc1
    buffer_load_dwordx4 v[194:197], v202, s[68:71], s55 offen offset:2048 sc1
    buffer_load_dwordx4 v[198:201], v202, s[68:71], s55 offen offset:3072 sc1
    s_add_u32 s45, s45, 32768
    s_cmp_eq_u32 s45, 163840
    s_cselect_b32 s45, 0, s45
    s_waitcnt lgkmcnt(0)
    s_barrier
    v_add_u32 v156, s45, v157
    v_mfma_f32_16x16x32_bf16 v[20:23], v[132:135], v[116:119], v[20:23]
    ds_read_b128 v[84:87], v156 offset:0
    v_mfma_f32_16x16x32_bf16 v[36:39], v[132:135], v[120:123], v[36:39]
    ds_read_b128 v[88:91], v156 offset:2048
    v_mfma_f32_16x16x32_bf16 v[52:55], v[132:135], v[124:127], v[52:55]
    ds_read_b128 v[92:95], v156 offset:4096
    v_mfma_f32_16x16x32_bf16 v[68:71], v[132:135], v[128:131], v[68:71]
    ds_read_b128 v[96:99], v156 offset:6144
    v_mfma_f32_16x16x32_bf16 v[24:27], v[136:139], v[116:119], v[24:27]
    v_mfma_f32_16x16x32_bf16 v[40:43], v[136:139], v[120:123], v[40:43]
    v_mfma_f32_16x16x32_bf16 v[56:59], v[136:139], v[124:127], v[56:59]
    v_mfma_f32_16x16x32_bf16 v[72:75], v[136:139], v[128:131], v[72:75]
    s_waitcnt lgkmcnt(0)
    v_mfma_f32_16x16x32_bf16 v[20:23], v[148:151], v[84:87], v[20:23]
    v_mfma_f32_16x16x32_bf16 v[36:39], v[148:151], v[88:91], v[36:39]
    v_mfma_f32_16x16x32_bf16 v[52:55], v[148:151], v[92:95], v[52:55]
    v_mfma_f32_16x16x32_bf16 v[68:71], v[148:151], v[96:99], v[68:71]
    v_mfma_f32_16x16x32_bf16 v[24:27], v[152:155], v[84:87], v[24:27]
    v_mfma_f32_16x16x32_bf16 v[40:43], v[152:155], v[88:91], v[40:43]
    v_mfma_f32_16x16x32_bf16 v[56:59], v[152:155], v[92:95], v[56:59]
    v_mfma_f32_16x16x32_bf16 v[72:75], v[152:155], v[96:99], v[72:75]
    s_nop 7
    s_lshl_b32 s43, s41, 7
    s_lshl_b32 s44, s51, 6
    s_add_u32 s43, s43, s44
    v_add_u32 v4, s43, v1
    v_and_b32 v5, 1, v2
    v_lshlrev_b32 v5, 5, v5
    v_lshrrev_b32 v6, 1, v2
    v_lshl_add_u32 v5, v6, 4, v5
    v_lshl_add_u32 v3, v4, 6, v5
    v_lshl_add_u32 v4, v4, 11, v5
    s_lshl_b32 s43, s42, 1
    s_add_u32 s43, s43, s52
    s_lshl_b32 s44, s43, 17
    s_lshl_b32 s43, s43, 6
    s_cmp_lg_u32 s3, 0
    s_cselect_b32 s43, 2146435072, s43
    s_cselect_b32 s44, s44, 2146435072
    s_add_u32 s20, s30, 50331648
    s_addc_u32 s21, s31, 0
    s_and_b32 s21, s21, 0xffff
    s_mov_b32 s22, 4194304
    s_mov_b32 s23, 131072
    v_add_u32 v4, s43, v4
    v_add_u32 v3, s44, v3
    s_waitcnt vmcnt(7)
    v_pk_add_f32 v[20:21], v[20:21], v[162:163]
    v_pk_add_f32 v[22:23], v[22:23], v[164:165]
    v_pk_add_f32 v[20:21], v[20:21], v[170:171]
    v_pk_add_f32 v[22:23], v[22:23], v[172:173]
    v_cvt_pk_bf16_f32 v84, v20, v21
    v_cvt_pk_bf16_f32 v85, v22, v23
    s_waitcnt vmcnt(6)
    v_pk_add_f32 v[24:25], v[24:25], v[166:167]
    v_pk_add_f32 v[26:27], v[26:27], v[168:169]
    v_pk_add_f32 v[24:25], v[24:25], v[174:175]
    v_pk_add_f32 v[26:27], v[26:27], v[176:177]
    v_cvt_pk_bf16_f32 v86, v24, v25
    v_cvt_pk_bf16_f32 v87, v26, v27
    s_nop 1
    v_permlane16_swap_b32 v84, v86
    v_permlane16_swap_b32 v85, v87
    s_mov_b32 s44, 0
    buffer_store_dwordx4 v[84:87], v4, s[16:19], s44 offen
    buffer_store_dwordx4 v[84:87], v3, s[20:23], 0 offen offset:0 sc1
    s_waitcnt vmcnt(7)
    v_pk_add_f32 v[36:37], v[36:37], v[162:163]
    v_pk_add_f32 v[38:39], v[38:39], v[164:165]
    v_pk_add_f32 v[36:37], v[36:37], v[178:179]
    v_pk_add_f32 v[38:39], v[38:39], v[180:181]
    v_cvt_pk_bf16_f32 v88, v36, v37
    v_cvt_pk_bf16_f32 v89, v38, v39
    s_waitcnt vmcnt(6)
    v_pk_add_f32 v[40:41], v[40:41], v[166:167]
    v_pk_add_f32 v[42:43], v[42:43], v[168:169]
    v_pk_add_f32 v[40:41], v[40:41], v[182:183]
    v_pk_add_f32 v[42:43], v[42:43], v[184:185]
    v_cvt_pk_bf16_f32 v90, v40, v41
    v_cvt_pk_bf16_f32 v91, v42, v43
    s_nop 1
    v_permlane16_swap_b32 v88, v90
    v_permlane16_swap_b32 v89, v91
    s_mov_b32 s44, 32768
    buffer_store_dwordx4 v[88:91], v4, s[16:19], s44 offen
    buffer_store_dwordx4 v[88:91], v3, s[20:23], 0 offen offset:1024 sc1
    s_waitcnt vmcnt(7)
    v_pk_add_f32 v[52:53], v[52:53], v[162:163]
    v_pk_add_f32 v[54:55], v[54:55], v[164:165]
    v_pk_add_f32 v[52:53], v[52:53], v[186:187]
    v_pk_add_f32 v[54:55], v[54:55], v[188:189]
    v_cvt_pk_bf16_f32 v92, v52, v53
    v_cvt_pk_bf16_f32 v93, v54, v55
    s_waitcnt vmcnt(6)
    v_pk_add_f32 v[56:57], v[56:57], v[166:167]
    v_pk_add_f32 v[58:59], v[58:59], v[168:169]
    v_pk_add_f32 v[56:57], v[56:57], v[190:191]
    v_pk_add_f32 v[58:59], v[58:59], v[192:193]
    v_cvt_pk_bf16_f32 v94, v56, v57
    v_cvt_pk_bf16_f32 v95, v58, v59
    s_nop 1
    v_permlane16_swap_b32 v92, v94
    v_permlane16_swap_b32 v93, v95
    s_mov_b32 s44, 65536
    buffer_store_dwordx4 v[92:95], v4, s[16:19], s44 offen
    buffer_store_dwordx4 v[92:95], v3, s[20:23], 0 offen offset:2048 sc1
    s_waitcnt vmcnt(7)
    v_pk_add_f32 v[68:69], v[68:69], v[162:163]
    v_pk_add_f32 v[70:71], v[70:71], v[164:165]
    v_pk_add_f32 v[68:69], v[68:69], v[194:195]
    v_pk_add_f32 v[70:71], v[70:71], v[196:197]
    v_cvt_pk_bf16_f32 v96, v68, v69
    v_cvt_pk_bf16_f32 v97, v70, v71
    s_waitcnt vmcnt(6)
    v_pk_add_f32 v[72:73], v[72:73], v[166:167]
    v_pk_add_f32 v[74:75], v[74:75], v[168:169]
    v_pk_add_f32 v[72:73], v[72:73], v[198:199]
    v_pk_add_f32 v[74:75], v[74:75], v[200:201]
    v_cvt_pk_bf16_f32 v98, v72, v73
    v_cvt_pk_bf16_f32 v99, v74, v75
    s_nop 1
    v_permlane16_swap_b32 v96, v98
    v_permlane16_swap_b32 v97, v99
    s_mov_b32 s44, 98304
    buffer_store_dwordx4 v[96:99], v4, s[16:19], s44 offen
    buffer_store_dwordx4 v[96:99], v3, s[20:23], 0 offen offset:3072 sc1
    s_cmp_eq_u32 s3, 0
    s_cbranch_scc1 L_w2_end
    v_lshlrev_b32 v108, 16, v84
    v_and_b32 v109, 0xffff0000, v84
    v_lshlrev_b32 v110, 16, v85
    v_and_b32 v111, 0xffff0000, v85
    v_lshlrev_b32 v112, 16, v86
    v_and_b32 v113, 0xffff0000, v86
    v_lshlrev_b32 v114, 16, v87
    v_and_b32 v115, 0xffff0000, v87
    v_pk_add_f32 v[116:117], v[108:109], v[110:111]
    v_pk_add_f32 v[118:119], v[112:113], v[114:115]
    v_pk_add_f32 v[116:117], v[116:117], v[118:119]
    v_add_f32 v116, v116, v117
    v_mul_f32 v100, 0.125, v116
    v_mul_f32 v116, 0xbe000000, v116
    v_pk_add_f32 v[108:109], v[108:109], v[116:117] op_sel_hi:[1,0]
    v_pk_add_f32 v[110:111], v[110:111], v[116:117] op_sel_hi:[1,0]
    v_pk_add_f32 v[112:113], v[112:113], v[116:117] op_sel_hi:[1,0]
    v_pk_add_f32 v[114:115], v[114:115], v[116:117] op_sel_hi:[1,0]
    v_pk_mul_f32 v[118:119], v[108:109], v[108:109]
    v_pk_fma_f32 v[118:119], v[110:111], v[110:111], v[118:119]
    v_pk_fma_f32 v[118:119], v[112:113], v[112:113], v[118:119]
    v_pk_fma_f32 v[118:119], v[114:115], v[114:115], v[118:119]
    v_add_f32 v104, v118, v119
    v_lshlrev_b32 v108, 16, v88
    v_and_b32 v109, 0xffff0000, v88
    v_lshlrev_b32 v110, 16, v89
    v_and_b32 v111, 0xffff0000, v89
    v_lshlrev_b32 v112, 16, v90
    v_and_b32 v113, 0xffff0000, v90
    v_lshlrev_b32 v114, 16, v91
    v_and_b32 v115, 0xffff0000, v91
    v_pk_add_f32 v[116:117], v[108:109], v[110:111]
    v_pk_add_f32 v[118:119], v[112:113], v[114:115]
    v_pk_add_f32 v[116:117], v[116:117], v[118:119]
    v_add_f32 v116, v116, v117
    v_mul_f32 v101, 0.125, v116
    v_mul_f32 v116, 0xbe000000, v116
    v_pk_add_f32 v[108:109], v[108:109], v[116:117] op_sel_hi:[1,0]
    v_pk_add_f32 v[110:111], v[110:111], v[116:117] op_sel_hi:[1,0]
    v_pk_add_f32 v[112:113], v[112:113], v[116:117] op_sel_hi:[1,0]
    v_pk_add_f32 v[114:115], v[114:115], v[116:117] op_sel_hi:[1,0]
    v_pk_mul_f32 v[118:119], v[108:109], v[108:109]
    v_pk_fma_f32 v[118:119], v[110:111], v[110:111], v[118:119]
    v_pk_fma_f32 v[118:119], v[112:113], v[112:113], v[118:119]
    v_pk_fma_f32 v[118:119], v[114:115], v[114:115], v[118:119]
    v_add_f32 v105, v118, v119
    v_lshlrev_b32 v108, 16, v92
    v_and_b32 v109, 0xffff0000, v92
    v_lshlrev_b32 v110, 16, v93
    v_and_b32 v111, 0xffff0000, v93
    v_lshlrev_b32 v112, 16, v94
    v_and_b32 v113, 0xffff0000, v94
    v_lshlrev_b32 v114, 16, v95
    v_and_b32 v115, 0xffff0000, v95
    v_pk_add_f32 v[116:117], v[108:109], v[110:111]
    v_pk_add_f32 v[118:119], v[112:113], v[114:115]
    v_pk_add_f32 v[116:117], v[116:117], v[118:119]
    v_add_f32 v116, v116, v117
    v_mul_f32 v102, 0.125, v116
    v_mul_f32 v116, 0xbe000000, v116
    v_pk_add_f32 v[108:109], v[108:109], v[116:117] op_sel_hi:[1,0]
    v_pk_add_f32 v[110:111], v[110:111], v[116:117] op_sel_hi:[1,0]
    v_pk_add_f32 v[112:113], v[112:113], v[116:117] op_sel_hi:[1,0]
    v_pk_add_f32 v[114:115], v[114:115], v[116:117] op_sel_hi:[1,0]
    v_pk_mul_f32 v[118:119], v[108:109], v[108:109]
    v_pk_fma_f32 v[118:119], v[110:111], v[110:111], v[118:119]
    v_pk_fma_f32 v[118:119], v[112:113], v[112:113], v[118:119]
    v_pk_fma_f32 v[118:119], v[114:115], v[114:115], v[118:119]
    v_add_f32 v106, v118, v119
    v_lshlrev_b32 v108, 16, v96
    v_and_b32 v109, 0xffff0000, v96
    v_lshlrev_b32 v110, 16, v97
    v_and_b32 v111, 0xffff0000, v97
    v_lshlrev_b32 v112, 16, v98
    v_and_b32 v113, 0xffff0000, v98
    v_lshlrev_b32 v114, 16, v99
    v_and_b32 v115, 0xffff0000, v99
    v_pk_add_f32 v[116:117], v[108:109], v[110:111]
    v_pk_add_f32 v[118:119], v[112:113], v[114:115]
    v_pk_add_f32 v[116:117], v[116:117], v[118:119]
    v_add_f32 v116, v116, v117
    v_mul_f32 v103, 0.125, v116
    v_mul_f32 v116, 0xbe000000, v116
    v_pk_add_f32 v[108:109], v[108:109], v[116:117] op_sel_hi:[1,0]
    v_pk_add_f32 v[110:111], v[110:111], v[116:117] op_sel_hi:[1,0]
    v_pk_add_f32 v[112:113], v[112:113], v[116:117] op_sel_hi:[1,0]
    v_pk_add_f32 v[114:115], v[114:115], v[116:117] op_sel_hi:[1,0]
    v_pk_mul_f32 v[118:119], v[108:109], v[108:109]
    v_pk_fma_f32 v[118:119], v[110:111], v[110:111], v[118:119]
    v_pk_fma_f32 v[118:119], v[112:113], v[112:113], v[118:119]
    v_pk_fma_f32 v[118:119], v[114:115], v[114:115], v[118:119]
    v_add_f32 v107, v118, v119
    s_nop 1
    v_permlane16_swap_b32 v100, v101
    v_permlane16_swap_b32 v104, v105
    v_permlane16_swap_b32 v102, v103
    v_permlane16_swap_b32 v106, v107
    v_sub_f32 v116, v100, v101
    v_add_f32 v100, v100, v101
    v_add_f32 v104, v104, v105
    v_mul_f32 v117, 0x40800000, v116
    v_mul_f32 v100, 0.5, v100
    v_fmac_f32 v104, v116, v117
    v_sub_f32 v116, v102, v103
    v_add_f32 v102, v102, v103
    v_add_f32 v106, v106, v107
    v_mul_f32 v117, 0x40800000, v116
    v_mul_f32 v102, 0.5, v102
    v_fmac_f32 v106, v116, v117
    s_nop 1
    v_permlane32_swap_b32 v100, v102
    v_permlane32_swap_b32 v104, v106
    v_sub_f32 v116, v100, v102
    v_add_f32 v100, v100, v102
    v_add_f32 v104, v104, v106
    v_mul_f32 v117, 0x41000000, v116
    v_mul_f32 v100, 0.5, v100
    v_fmac_f32 v104, v116, v117
    v_mov_b32 v101, v104
    s_lshl_b32 s43, s51, 9
    v_lshl_add_u32 v5, v0, 3, s43
    s_cmp_eq_u32 s52, 0
    s_cbranch_scc1 L_w2_w0
    ds_write_b64 v5, v[100:101] offset:4096
    s_waitcnt lgkmcnt(0)
    s_barrier
    s_cmp_eq_u32 s3, 0
    s_cbranch_scc1 L_w2_end
    s_branch L_sync_w2
L_w2_w0:
    s_barrier
    ds_read_b64 v[102:103], v5 offset:4096
    s_waitcnt lgkmcnt(0)
    v_sub_f32 v116, v100, v102
    v_add_f32 v100, v100, v102
    v_add_f32 v101, v101, v103
    v_mul_f32 v117, 0x41800000, v116
    v_mul_f32 v100, 0.5, v100
    v_fmac_f32 v101, v116, v117
    s_lshl_b32 s43, s41, 7
    s_lshl_b32 s44, s51, 6
    s_add_u32 s43, s43, s44
    v_add_u32 v5, s43, v0
    v_lshlrev_b32 v5, 3, v5
    s_lshl_b32 s43, s42, 14
    s_add_u32 s43, s43, 0
    buffer_store_dwordx2 v[100:101], v5, s[24:27], s43 offen sc1
    s_cmp_eq_u32 s3, 0
    s_cbranch_scc1 L_w2_end
    s_branch L_sync_w2
L_w2_ool5:
    s_cmp_lg_u32 s53, 4
    s_cbranch_scc1 L_w2_q27
    s_waitcnt vmcnt(0)
    s_mov_b64 exec, 1
    buffer_store_dword v204, v203, s[24:27], s59 offen sc1
    s_mov_b64 exec, -1
    v_lshlrev_b32 v162, 16, v158
    v_and_b32 v163, 0xffff0000, v158
    v_lshlrev_b32 v164, 16, v159
    v_and_b32 v165, 0xffff0000, v159
    v_lshlrev_b32 v166, 16, v160
    v_and_b32 v167, 0xffff0000, v160
    v_lshlrev_b32 v168, 16, v161
    v_and_b32 v169, 0xffff0000, v161
    s_lshl_b32 s59, s2, 2
    s_add_u32 s59, s59, s40
    s_lshl_b32 s55, s59, 13
    s_lshl_b32 s59, s59, 7
    s_add_u32 s59, s59, 1572864
L_w2_q27:
    s_cmp_lg_u32 s53, 6
    s_cbranch_scc1 L_w2_q28
    s_mov_b64 exec, 1
    buffer_load_dword v204, v203, s[24:27], s59 offen sc1
    s_mov_b64 exec, -1
L_w2_q28:
    s_branch L_w2_back6
L_sync_w2:
    s_load_dwordx2 s[4:5], s[0:1], 80
    s_waitcnt vmcnt(0) lgkmcnt(0)
    s_barrier
    s_add_u32 s8, s4, 65011712
    s_addc_u32 s9, s5, 0
    s_and_b32 s9, s9, 0xffff
    s_mov_b32 s10, 1048576
    s_mov_b32 s11, 131072
    v_mbcnt_lo_u32_b32 v0, -1, 0
    v_mbcnt_hi_u32_b32 v0, -1, v0
    s_xor_b32 s12, s3, 1
    s_mul_i32 s12, s12, 5
    s_add_u32 s12, s12, 4
    s_lshl_b32 s12, s12, 15
    s_cmp_lg_u32 s97, 0
    s_cbranch_scc1 L_syncw2_go1
    s_lshl_b32 s13, s96, 7
    s_add_u32 s13, s12, s13
    v_mov_b32 v1, 0
    v_mov_b32 v2, s95
    s_mov_b64 exec, 1
    buffer_store_dword v2, v1, s[8:11], s13 offen sc1
    s_mov_b64 exec, -1
L_syncw2_go1:
    s_and_b32 s14, s2, 7
    s_lshr_b32 s15, s2, 3
    s_and_b32 s13, s14, 1
    s_lshl_b32 s13, s13, 3
    s_and_b32 s15, s15, 7
    s_add_u32 s13, s13, s15
    s_lshl_b32 s13, s13, 11
    s_add_u32 s99, s12, s13
    s_lshl_b32 s13, s97, 6
    v_or_b32 v0, s13, v0
    s_mov_b32 s3, 0
    s_add_u32 s98, s98, 1
    s_branch qkv_run
ce_w2:
.p2align 8
cs_attn:
.globl attn_b_kernel
.p2align 8
.type attn_b_kernel,@function
attn_b_kernel:
    s_mov_b32 s3, 0
    s_branch attn_body
.globl attn_a_kernel
.p2align 8
.type attn_a_kernel,@function
attn_a_kernel:
    s_mov_b32 s3, 1
    s_mov_b32 s98, 1
    s_mov_b32 s99, -1
    s_mov_b32 s95, 1
attn_body:
    s_cmp_ge_u32 s2, 256
    s_cbranch_scc1 L_attn_end
attn_run:
    s_load_dwordx2 s[4:5], s[0:1], 80
    s_xor_b32 s48, s3, 1
    s_mul_i32 s48, s48, 134217728
    s_load_dwordx2 s[32:33], s[0:1], 16
    s_load_dwordx2 s[34:35], s[0:1], 48
    s_load_dwordx2 s[44:45], s[0:1], 32
    v_lshrrev_b32 v1, 6, v0
    v_and_b32 v0, 63, v0
    v_readfirstlane_b32 s16, v1
    v_lshlrev_b32 v1, 4, v0
    s_mul_i32 s49, s3, 8
    v_cmp_gt_u32 vcc, s49, v0
    v_lshlrev_b32 v2, 7, v0
    v_mov_b32 v3, 2146435072
    v_cndmask_b32 v6, v3, v2, vcc
    s_and_b32 s19, s2, 7
    s_lshl_b32 s17, s19, 2
    s_lshr_b32 s19, s2, 6
    s_add_u32 s17, s17, s19
    s_lshr_b32 s18, s2, 3
    s_and_b32 s18, s18, 7
    s_mov_b32 s97, s16
    s_lshl_b32 s96, s18, 5
    s_add_u32 s96, s96, s17
    s_and_b32 s19, s16, 3
    s_lshl_b32 s19, s19, 1
    s_lshl_b32 s18, s18, 3
    s_add_u32 s18, s18, s19
    s_lshl_b32 s20, s17, 6
    s_add_u32 s19, s20, s18
    s_lshl_b32 s24, s19, 11
    s_lshr_b32 s19, s16, 2
    s_lshl_b32 s19, s19, 5
    s_add_u32 s19, s19, s20
    s_lshl_b32 s25, s19, 12
    s_add_u32 s25, s25, 4194304
    s_mov_b32 s21, s25
    s_waitcnt lgkmcnt(0)
    s_add_u32 s8, s4, s48
    s_addc_u32 s9, s5, 0
    s_and_b32 s9, s9, 0xffff
    s_mov_b32 s10, 12615680
    s_mov_b32 s11, 131072
    s_cmp_eq_u32 s99, -1
    s_cbranch_scc1 L_attn_dwe1
    s_cmp_lg_u32 s97, 4
    s_cbranch_scc1 L_attn_dwb2
    s_add_u32 s52, s4, 65011712
    s_addc_u32 s53, s5, 0
    s_and_b32 s53, s53, 0xffff
    s_mov_b32 s54, 1048576
    s_mov_b32 s55, 131072
    v_lshlrev_b32 v216, 7, v0
    s_mov_b32 s23, 0x400000
    s_mov_b64 exec, 0xffff
L_attn_dwp3:
    buffer_load_dword v217, v216, s[52:55], s99 offen sc1
    s_waitcnt vmcnt(0)
    v_cmp_ne_u32 vcc, s95, v217
    s_sub_u32 s23, s23, 1
    s_cbranch_scc1 L_attn_dwg4
    s_nop 1
    s_cbranch_vccz L_attn_dwg4
    s_sleep 1
    s_branch L_attn_dwp3
L_attn_dwg4:
    s_mov_b64 exec, -1
L_attn_dwb2:
    s_barrier
L_attn_dwe1:
    buffer_load_dwordx4 v[12:15], v1, s[8:11], s24 offen offset:0
    buffer_load_dwordx4 v[16:19], v1, s[8:11], s24 offen offset:1024
    buffer_load_dwordx4 v[20:23], v1, s[8:11], s24 offen offset:2048
    buffer_load_dwordx4 v[24:27], v1, s[8:11], s24 offen offset:3072
    s_lshl_b32 s27, s2, 3
    s_add_u32 s27, s27, s16
    s_cmp_lt_u32 s27, 1792
    s_cselect_b32 s36, s44, s32
    s_cselect_b32 s37, s45, s33
    s_mov_b32 s38, 2097152
    s_cselect_b32 s38, 7340032, s38
    s_mov_b32 s19, 1792
    s_cselect_b32 s19, 896, s19
    s_cmp_lt_u32 s27, 896
    s_cselect_b32 s36, s34, s36
    s_cselect_b32 s37, s35, s37
    s_cselect_b32 s19, 0, s19
    s_and_b32 s37, s37, 0xffff
    s_mov_b32 s39, 131072
    s_sub_u32 s27, s27, s19
    s_lshl_b32 s27, s27, 13
    buffer_load_dwordx4 v[28:31], v1, s[8:11], s21 offen offset:2048
    buffer_load_dwordx4 v[32:35], v1, s[8:11], s21 offen offset:3072
    s_add_u32 s21, s21, 4096
    buffer_load_dwordx4 v[60:63], v1, s[8:11], s21 offen offset:0
    buffer_load_dwordx4 v[64:67], v1, s[8:11], s21 offen offset:1024
    buffer_load_dwordx4 v[36:39], v1, s[8:11], s21 offen offset:2048
    buffer_load_dwordx4 v[40:43], v1, s[8:11], s21 offen offset:3072
    s_add_u32 s21, s21, 4096
    s_add_u32 s12, s4, s48
    s_addc_u32 s13, s5, 0
    s_add_u32 s12, s12, 58720256
    s_addc_u32 s13, s13, 0
    s_and_b32 s13, s13, 0xffff
    s_mov_b32 s14, 5242880
    s_mov_b32 s15, 131072
    s_mov_b32 s40, s32
    s_and_b32 s41, s33, 0xffff
    s_mov_b32 s42, 2097152
    s_mov_b32 s43, 131072
    v_lshrrev_b32 v2, 4, v0
    v_lshrrev_b32 v3, 2, v0
    v_xor_b32 v2, v2, v3
    v_and_b32 v2, 1, v2
    v_cmp_eq_u32 vcc, 0, v2
    v_mov_b32 v3, 0x3f803f80
    s_nop 1
    v_cndmask_b32 v8, 0, v3, vcc
    v_cndmask_b32 v9, 0, v3, vcc
    v_cndmask_b32 v10, 0, v3, vcc
    v_cndmask_b32 v11, 0, v3, vcc
    s_mov_b32 s26, 0
    v_mov_b32 v212, 0xff800000
    v_mov_b32 v213, 0xff800000
    v_mov_b32 v156, 0
    v_mov_b32 v157, 0
    v_mov_b32 v158, 0
    v_mov_b32 v159, 0
    v_mov_b32 v160, 0
    v_mov_b32 v161, 0
    v_mov_b32 v162, 0
    v_mov_b32 v163, 0
    v_mov_b32 v164, 0
    v_mov_b32 v165, 0
    v_mov_b32 v166, 0
    v_mov_b32 v167, 0
    v_mov_b32 v168, 0
    v_mov_b32 v169, 0
    v_mov_b32 v170, 0
    v_mov_b32 v171, 0
    v_mov_b32 v188, 0
    v_mov_b32 v189, 0
    v_mov_b32 v190, 0
    v_mov_b32 v191, 0
    v_mov_b32 v172, 0
    v_mov_b32 v173, 0
    v_mov_b32 v174, 0
    v_mov_b32 v175, 0
    v_mov_b32 v176, 0
    v_mov_b32 v177, 0
    v_mov_b32 v178, 0
    v_mov_b32 v179, 0
    v_mov_b32 v180, 0
    v_mov_b32 v181, 0
    v_mov_b32 v182, 0
    v_mov_b32 v183, 0
    v_mov_b32 v184, 0
    v_mov_b32 v185, 0
    v_mov_b32 v186, 0
    v_mov_b32 v187, 0
    v_mov_b32 v192, 0
    v_mov_b32 v193, 0
    v_mov_b32 v194, 0
    v_mov_b32 v195, 0
    v_mov_b32 v208, 0
    v_mov_b32 v88, 0
    v_mov_b32 v209, 0
    v_mov_b32 v89, 0
    v_mov_b32 v210, 0
    v_mov_b32 v90, 0
    v_mov_b32 v211, 0
    v_mov_b32 v91, 0
    s_waitcnt vmcnt(4)
    v_mfma_f32_32x32x16_bf16 v[92:107], v[28:31], v[12:15], 0
    v_mfma_f32_32x32x16_bf16 v[92:107], v[32:35], v[16:19], v[92:107]
    v_mfma_f32_32x32x16_bf16 v[108:123], v[28:31], v[20:23], 0
    v_mfma_f32_32x32x16_bf16 v[108:123], v[32:35], v[24:27], v[108:123]
    s_nop 11
    v_max3_f32 v212, v92, v93, v212
    v_max3_f32 v213, v108, v109, v213
    v_max3_f32 v212, v94, v95, v212
    v_max3_f32 v213, v110, v111, v213
    v_max3_f32 v212, v96, v97, v212
    v_max3_f32 v213, v112, v113, v213
    v_max3_f32 v212, v98, v99, v212
    v_max3_f32 v213, v114, v115, v213
    v_max3_f32 v212, v100, v101, v212
    v_max3_f32 v213, v116, v117, v213
    v_max3_f32 v212, v102, v103, v212
    v_max3_f32 v213, v118, v119, v213
    v_max3_f32 v212, v104, v105, v212
    v_max3_f32 v213, v120, v121, v213
    v_max3_f32 v212, v106, v107, v212
    v_max3_f32 v213, v122, v123, v213
L_attn_main:
    v_mov_b32 v2, v212
    v_mov_b32 v3, v213
    s_nop 1
    v_permlane32_swap_b32 v212, v2
    v_permlane32_swap_b32 v213, v3
    v_max_f32 v212, v212, v2
    v_max_f32 v213, v213, v3
    v_sub_f32 v124, 0, v212
    v_sub_f32 v125, 0, v212
    v_sub_f32 v126, 0, v212
    v_sub_f32 v127, 0, v212
    v_sub_f32 v128, 0, v212
    v_sub_f32 v129, 0, v212
    v_sub_f32 v130, 0, v212
    v_sub_f32 v131, 0, v212
    v_sub_f32 v132, 0, v212
    v_sub_f32 v133, 0, v212
    v_sub_f32 v134, 0, v212
    v_sub_f32 v135, 0, v212
    v_sub_f32 v136, 0, v212
    v_sub_f32 v137, 0, v212
    v_sub_f32 v138, 0, v212
    v_sub_f32 v139, 0, v212
    v_sub_f32 v140, 0, v213
    v_sub_f32 v141, 0, v213
    v_sub_f32 v142, 0, v213
    v_sub_f32 v143, 0, v213
    v_sub_f32 v144, 0, v213
    v_sub_f32 v145, 0, v213
    v_sub_f32 v146, 0, v213
    v_sub_f32 v147, 0, v213
    v_sub_f32 v148, 0, v213
    v_sub_f32 v149, 0, v213
    v_sub_f32 v150, 0, v213
    v_sub_f32 v151, 0, v213
    v_sub_f32 v152, 0, v213
    v_sub_f32 v153, 0, v213
    v_sub_f32 v154, 0, v213
    v_sub_f32 v155, 0, v213
    s_nop 1
    v_mfma_f32_32x32x16_bf16 v[92:107], v[28:31], v[12:15], v[124:139]
    v_mfma_f32_32x32x16_bf16 v[92:107], v[32:35], v[16:19], v[92:107]
    buffer_load_dwordx4 v[68:71], v1, s[8:11], s21 offen offset:0
    buffer_load_dwordx4 v[72:75], v1, s[8:11], s21 offen offset:1024
    buffer_load_dwordx4 v[44:47], v1, s[8:11], s21 offen offset:2048
    buffer_load_dwordx4 v[48:51], v1, s[8:11], s21 offen offset:3072
    s_add_u32 s21, s21, 4096
    buffer_load_dwordx4 v[76:79], v1, s[8:11], s21 offen offset:0
    buffer_load_dwordx4 v[80:83], v1, s[8:11], s21 offen offset:1024
    buffer_load_dwordx4 v[52:55], v1, s[8:11], s21 offen offset:2048
    buffer_load_dwordx4 v[56:59], v1, s[8:11], s21 offen offset:3072
    s_add_u32 s21, s21, 4096
    s_mov_b32 s23, 8
    s_nop 3
L_attn_loop:
    v_exp_f32 v92, v92
    v_exp_f32 v93, v93
    v_mfma_f32_32x32x16_bf16 v[172:187], v[88:91], v[208:211], v[172:187]
    buffer_load_dwordx4 v[84:87], v1, s[8:11], s21 offen offset:0
    buffer_load_dwordx4 v[88:91], v1, s[8:11], s21 offen offset:1024
    v_exp_f32 v94, v94
    v_exp_f32 v95, v95
    v_cvt_pk_bf16_f32 v196, v92, v93
    v_exp_f32 v96, v96
    v_mfma_f32_16x16x32_bf16 v[192:195], v[8:11], v[208:211], v[192:195]
    buffer_load_dword v7, v6, s[36:39], s27 offen
    s_add_u32 s27, s27, 1024
    v_exp_f32 v97, v97
    v_cvt_pk_bf16_f32 v197, v94, v95
    v_exp_f32 v98, v98
    v_exp_f32 v99, v99
    v_mfma_f32_32x32x16_bf16 v[108:123], v[28:31], v[20:23], v[140:155]
    v_cvt_pk_bf16_f32 v198, v96, v97
    v_exp_f32 v100, v100
    v_cvt_pk_bf16_f32 v199, v98, v99
    v_exp_f32 v101, v101
    v_mfma_f32_32x32x16_bf16 v[108:123], v[32:35], v[24:27], v[108:123]
    buffer_load_dwordx4 v[28:31], v1, s[8:11], s21 offen offset:2048
    buffer_load_dwordx4 v[32:35], v1, s[8:11], s21 offen offset:3072
    s_add_u32 s21, s21, 4096
    v_exp_f32 v102, v102
    v_cvt_pk_bf16_f32 v200, v100, v101
    v_exp_f32 v103, v103
    v_exp_f32 v104, v104
    s_waitcnt vmcnt(13)
    v_mfma_f32_32x32x16_bf16 v[156:171], v[60:63], v[196:199], v[156:171]
    v_cvt_pk_bf16_f32 v201, v102, v103
    v_exp_f32 v105, v105
    v_exp_f32 v106, v106
    v_exp_f32 v107, v107
    v_mfma_f32_16x16x32_bf16 v[188:191], v[8:11], v[196:199], v[188:191]
    v_cvt_pk_bf16_f32 v202, v104, v105
    v_cvt_pk_bf16_f32 v203, v106, v107
    v_exp_f32 v108, v108
    v_exp_f32 v109, v109
    v_mfma_f32_32x32x16_bf16 v[156:171], v[64:67], v[200:203], v[156:171]
    v_exp_f32 v110, v110
    v_exp_f32 v111, v111
    v_cvt_pk_bf16_f32 v204, v108, v109
    v_exp_f32 v112, v112
    v_mfma_f32_16x16x32_bf16 v[188:191], v[8:11], v[200:203], v[188:191]
    v_exp_f32 v113, v113
    v_cvt_pk_bf16_f32 v205, v110, v111
    v_exp_f32 v114, v114
    v_exp_f32 v115, v115
    v_mfma_f32_32x32x16_bf16 v[92:107], v[36:39], v[12:15], v[124:139]
    v_cvt_pk_bf16_f32 v206, v112, v113
    v_exp_f32 v116, v116
    v_cvt_pk_bf16_f32 v207, v114, v115
    v_exp_f32 v117, v117
    v_mfma_f32_32x32x16_bf16 v[92:107], v[40:43], v[16:19], v[92:107]
    v_exp_f32 v118, v118
    v_cvt_pk_bf16_f32 v208, v116, v117
    v_exp_f32 v119, v119
    v_exp_f32 v120, v120
    v_mfma_f32_32x32x16_bf16 v[172:187], v[60:63], v[204:207], v[172:187]
    v_cvt_pk_bf16_f32 v209, v118, v119
    v_exp_f32 v121, v121
    v_exp_f32 v122, v122
    v_exp_f32 v123, v123
    v_mfma_f32_16x16x32_bf16 v[192:195], v[8:11], v[204:207], v[192:195]
    v_cvt_pk_bf16_f32 v210, v120, v121
    v_cvt_pk_bf16_f32 v211, v122, v123
    v_exp_f32 v92, v92
    v_exp_f32 v93, v93
    v_mfma_f32_32x32x16_bf16 v[172:187], v[64:67], v[208:211], v[172:187]
    buffer_load_dwordx4 v[60:63], v1, s[8:11], s21 offen offset:0
    buffer_load_dwordx4 v[64:67], v1, s[8:11], s21 offen offset:1024
    v_exp_f32 v94, v94
    v_exp_f32 v95, v95
    v_cvt_pk_bf16_f32 v196, v92, v93
    v_exp_f32 v96, v96
    v_mfma_f32_16x16x32_bf16 v[192:195], v[8:11], v[208:211], v[192:195]
    v_exp_f32 v97, v97
    v_cvt_pk_bf16_f32 v197, v94, v95
    v_exp_f32 v98, v98
    v_exp_f32 v99, v99
    v_mfma_f32_32x32x16_bf16 v[108:123], v[36:39], v[20:23], v[140:155]
    v_cvt_pk_bf16_f32 v198, v96, v97
    v_exp_f32 v100, v100
    v_cvt_pk_bf16_f32 v199, v98, v99
    v_exp_f32 v101, v101
    v_mfma_f32_32x32x16_bf16 v[108:123], v[40:43], v[24:27], v[108:123]
    buffer_load_dwordx4 v[36:39], v1, s[8:11], s21 offen offset:2048
    buffer_load_dwordx4 v[40:43], v1, s[8:11], s21 offen offset:3072
    s_add_u32 s21, s21, 4096
    v_exp_f32 v102, v102
    v_cvt_pk_bf16_f32 v200, v100, v101
    v_exp_f32 v103, v103
    v_exp_f32 v104, v104
    s_waitcnt vmcnt(13)
    v_mfma_f32_32x32x16_bf16 v[156:171], v[68:71], v[196:199], v[156:171]
    v_cvt_pk_bf16_f32 v201, v102, v103
    v_exp_f32 v105, v105
    v_exp_f32 v106, v106
    v_exp_f32 v107, v107
    v_mfma_f32_16x16x32_bf16 v[188:191], v[8:11], v[196:199], v[188:191]
    v_cvt_pk_bf16_f32 v202, v104, v105
    v_cvt_pk_bf16_f32 v203, v106, v107
    v_exp_f32 v108, v108
    v_exp_f32 v109, v109
    v_mfma_f32_32x32x16_bf16 v[156:171], v[72:75], v[200:203], v[156:171]
    v_exp_f32 v110, v110
    v_exp_f32 v111, v111
    v_cvt_pk_bf16_f32 v204, v108, v109
    v_exp_f32 v112, v112
    v_mfma_f32_16x16x32_bf16 v[188:191], v[8:11], v[200:203], v[188:191]
    v_exp_f32 v113, v113
    v_cvt_pk_bf16_f32 v205, v110, v111
    v_exp_f32 v114, v114
    v_exp_f32 v115, v115
    v_mfma_f32_32x32x16_bf16 v[92:107], v[44:47], v[12:15], v[124:139]
    v_cvt_pk_bf16_f32 v206, v112, v113
    v_exp_f32 v116, v116
    v_cvt_pk_bf16_f32 v207, v114, v115
    v_exp_f32 v117, v117
    v_mfma_f32_32x32x16_bf16 v[92:107], v[48:51], v[16:19], v[92:107]
    v_exp_f32 v118, v118
    v_cvt_pk_bf16_f32 v208, v116, v117
    v_exp_f32 v119, v119
    v_exp_f32 v120, v120
    v_mfma_f32_32x32x16_bf16 v[172:187], v[68:71], v[204:207], v[172:187]
    v_cvt_pk_bf16_f32 v209, v118, v119
    v_exp_f32 v121, v121
    v_exp_f32 v122, v122
    v_exp_f32 v123, v123
    v_mfma_f32_16x16x32_bf16 v[192:195], v[8:11], v[204:207], v[192:195]
    v_cvt_pk_bf16_f32 v210, v120, v121
    v_cvt_pk_bf16_f32 v211, v122, v123
    v_exp_f32 v92, v92
    v_exp_f32 v93, v93
    v_mfma_f32_32x32x16_bf16 v[172:187], v[72:75], v[208:211], v[172:187]
    buffer_load_dwordx4 v[68:71], v1, s[8:11], s21 offen offset:0
    buffer_load_dwordx4 v[72:75], v1, s[8:11], s21 offen offset:1024
    v_exp_f32 v94, v94
    v_exp_f32 v95, v95
    v_cvt_pk_bf16_f32 v196, v92, v93
    v_exp_f32 v96, v96
    v_mfma_f32_16x16x32_bf16 v[192:195], v[8:11], v[208:211], v[192:195]
    v_exp_f32 v97, v97
    v_cvt_pk_bf16_f32 v197, v94, v95
    v_exp_f32 v98, v98
    v_exp_f32 v99, v99
    v_mfma_f32_32x32x16_bf16 v[108:123], v[44:47], v[20:23], v[140:155]
    v_cvt_pk_bf16_f32 v198, v96, v97
    v_exp_f32 v100, v100
    v_cvt_pk_bf16_f32 v199, v98, v99
    v_exp_f32 v101, v101
    v_mfma_f32_32x32x16_bf16 v[108:123], v[48:51], v[24:27], v[108:123]
    buffer_load_dwordx4 v[44:47], v1, s[8:11], s21 offen offset:2048
    buffer_load_dwordx4 v[48:51], v1, s[8:11], s21 offen offset:3072
    s_add_u32 s21, s21, 4096
    v_exp_f32 v102, v102
    v_cvt_pk_bf16_f32 v200, v100, v101
    v_exp_f32 v103, v103
    v_exp_f32 v104, v104
    s_waitcnt vmcnt(13)
    v_mfma_f32_32x32x16_bf16 v[156:171], v[76:79], v[196:199], v[156:171]
    v_cvt_pk_bf16_f32 v201, v102, v103
    v_exp_f32 v105, v105
    v_exp_f32 v106, v106
    v_exp_f32 v107, v107
    v_mfma_f32_16x16x32_bf16 v[188:191], v[8:11], v[196:199], v[188:191]
    v_cvt_pk_bf16_f32 v202, v104, v105
    v_cvt_pk_bf16_f32 v203, v106, v107
    v_exp_f32 v108, v108
    v_exp_f32 v109, v109
    v_mfma_f32_32x32x16_bf16 v[156:171], v[80:83], v[200:203], v[156:171]
    v_exp_f32 v110, v110
    v_exp_f32 v111, v111
    v_cvt_pk_bf16_f32 v204, v108, v109
    v_exp_f32 v112, v112
    v_mfma_f32_16x16x32_bf16 v[188:191], v[8:11], v[200:203], v[188:191]
    v_exp_f32 v113, v113
    v_cvt_pk_bf16_f32 v205, v110, v111
    v_exp_f32 v114, v114
    v_exp_f32 v115, v115
    v_mfma_f32_32x32x16_bf16 v[92:107], v[52:55], v[12:15], v[124:139]
    v_cvt_pk_bf16_f32 v206, v112, v113
    v_exp_f32 v116, v116
    v_cvt_pk_bf16_f32 v207, v114, v115
    v_exp_f32 v117, v117
    v_mfma_f32_32x32x16_bf16 v[92:107], v[56:59], v[16:19], v[92:107]
    v_exp_f32 v118, v118
    v_cvt_pk_bf16_f32 v208, v116, v117
    v_exp_f32 v119, v119
    v_exp_f32 v120, v120
    v_mfma_f32_32x32x16_bf16 v[172:187], v[76:79], v[204:207], v[172:187]
    v_cvt_pk_bf16_f32 v209, v118, v119
    v_exp_f32 v121, v121
    v_exp_f32 v122, v122
    v_exp_f32 v123, v123
    v_mfma_f32_16x16x32_bf16 v[192:195], v[8:11], v[204:207], v[192:195]
    v_cvt_pk_bf16_f32 v210, v120, v121
    v_cvt_pk_bf16_f32 v211, v122, v123
    v_exp_f32 v92, v92
    v_exp_f32 v93, v93
    v_mfma_f32_32x32x16_bf16 v[172:187], v[80:83], v[208:211], v[172:187]
    buffer_load_dwordx4 v[76:79], v1, s[8:11], s21 offen offset:0
    buffer_load_dwordx4 v[80:83], v1, s[8:11], s21 offen offset:1024
    v_exp_f32 v94, v94
    v_exp_f32 v95, v95
    v_cvt_pk_bf16_f32 v196, v92, v93
    v_exp_f32 v96, v96
    v_mfma_f32_16x16x32_bf16 v[192:195], v[8:11], v[208:211], v[192:195]
    v_exp_f32 v97, v97
    v_cvt_pk_bf16_f32 v197, v94, v95
    v_exp_f32 v98, v98
    v_exp_f32 v99, v99
    v_mfma_f32_32x32x16_bf16 v[108:123], v[52:55], v[20:23], v[140:155]
    v_cvt_pk_bf16_f32 v198, v96, v97
    v_exp_f32 v100, v100
    v_cvt_pk_bf16_f32 v199, v98, v99
    v_exp_f32 v101, v101
    v_mfma_f32_32x32x16_bf16 v[108:123], v[56:59], v[24:27], v[108:123]
    buffer_load_dwordx4 v[52:55], v1, s[8:11], s21 offen offset:2048
    buffer_load_dwordx4 v[56:59], v1, s[8:11], s21 offen offset:3072
    s_add_u32 s21, s21, 4096
    v_exp_f32 v102, v102
    v_cvt_pk_bf16_f32 v200, v100, v101
    v_exp_f32 v103, v103
    v_exp_f32 v104, v104
    s_waitcnt vmcnt(12)
    v_mfma_f32_32x32x16_bf16 v[156:171], v[84:87], v[196:199], v[156:171]
    v_cvt_pk_bf16_f32 v201, v102, v103
    v_exp_f32 v105, v105
    v_exp_f32 v106, v106
    v_exp_f32 v107, v107
    v_mfma_f32_16x16x32_bf16 v[188:191], v[8:11], v[196:199], v[188:191]
    v_cvt_pk_bf16_f32 v202, v104, v105
    v_cvt_pk_bf16_f32 v203, v106, v107
    v_exp_f32 v108, v108
    v_exp_f32 v109, v109
    v_mfma_f32_32x32x16_bf16 v[156:171], v[88:91], v[200:203], v[156:171]
    v_exp_f32 v110, v110
    v_exp_f32 v111, v111
    v_cvt_pk_bf16_f32 v204, v108, v109
    v_exp_f32 v112, v112
    v_mfma_f32_16x16x32_bf16 v[188:191], v[8:11], v[200:203], v[188:191]
    v_exp_f32 v113, v113
    v_cvt_pk_bf16_f32 v205, v110, v111
    v_exp_f32 v114, v114
    v_exp_f32 v115, v115
    v_mfma_f32_32x32x16_bf16 v[92:107], v[28:31], v[12:15], v[124:139]
    v_cvt_pk_bf16_f32 v206, v112, v113
    v_exp_f32 v116, v116
    v_cvt_pk_bf16_f32 v207, v114, v115
    v_exp_f32 v117, v117
    v_mfma_f32_32x32x16_bf16 v[92:107], v[32:35], v[16:19], v[92:107]
    v_exp_f32 v118, v118
    v_cvt_pk_bf16_f32 v208, v116, v117
    v_exp_f32 v119, v119
    v_exp_f32 v120, v120
    v_mfma_f32_32x32x16_bf16 v[172:187], v[84:87], v[204:207], v[172:187]
    v_cvt_pk_bf16_f32 v209, v118, v119
    v_exp_f32 v121, v121
    v_exp_f32 v122, v122
    v_exp_f32 v123, v123
    v_mfma_f32_16x16x32_bf16 v[192:195], v[8:11], v[204:207], v[192:195]
    s_sub_u32 s23, s23, 1
    s_cmp_lg_u32 s23, 0
    v_cvt_pk_bf16_f32 v210, v120, v121
    v_cvt_pk_bf16_f32 v211, v122, v123
    s_cbranch_scc1 L_attn_loop
    s_nop 0
    v_mfma_f32_32x32x16_bf16 v[172:187], v[88:91], v[208:211], v[172:187]
    v_mfma_f32_16x16x32_bf16 v[192:195], v[8:11], v[208:211], v[192:195]
    s_nop 15
    v_mov_b32 v2, 0x5f800000
    v_cmp_nle_f32 vcc, v188, v2
    v_cmp_nle_f32 s[28:29], v192, v2
    s_nop 1
    s_or_b64 s[28:29], s[28:29], vcc
    s_cmp_eq_u64 s[28:29], 0
    s_cbranch_scc1 L_attn_ok
    s_cmp_lg_u32 s26, 0
    s_cbranch_scc1 L_attn_ok
    s_waitcnt vmcnt(0)
    s_mov_b32 s26, 1
    s_mov_b32 s21, s25
    s_mov_b32 s23, 32
    v_mov_b32 v212, 0xff800000
    v_mov_b32 v213, 0xff800000
L_attn_maxloop:
    buffer_load_dwordx4 v[28:31], v1, s[8:11], s21 offen offset:2048
    buffer_load_dwordx4 v[32:35], v1, s[8:11], s21 offen offset:3072
    s_add_u32 s21, s21, 4096
    s_waitcnt vmcnt(0)
    v_mfma_f32_32x32x16_bf16 v[92:107], v[28:31], v[12:15], 0
    v_mfma_f32_32x32x16_bf16 v[92:107], v[32:35], v[16:19], v[92:107]
    v_mfma_f32_32x32x16_bf16 v[108:123], v[28:31], v[20:23], 0
    v_mfma_f32_32x32x16_bf16 v[108:123], v[32:35], v[24:27], v[108:123]
    s_nop 11
    v_max3_f32 v212, v92, v93, v212
    v_max3_f32 v213, v108, v109, v213
    v_max3_f32 v212, v94, v95, v212
    v_max3_f32 v213, v110, v111, v213
    v_max3_f32 v212, v96, v97, v212
    v_max3_f32 v213, v112, v113, v213
    v_max3_f32 v212, v98, v99, v212
    v_max3_f32 v213, v114, v115, v213
    v_max3_f32 v212, v100, v101, v212
    v_max3_f32 v213, v116, v117, v213
    v_max3_f32 v212, v102, v103, v212
    v_max3_f32 v213, v118, v119, v213
    v_max3_f32 v212, v104, v105, v212
    v_max3_f32 v213, v120, v121, v213
    v_max3_f32 v212, v106, v107, v212
    v_max3_f32 v213, v122, v123, v213
    s_sub_u32 s23, s23, 1
    s_cmp_lg_u32 s23, 0
    s_cbranch_scc1 L_attn_maxloop
    s_mov_b32 s21, s25
    buffer_load_dwordx4 v[28:31], v1, s[8:11], s21 offen offset:2048
    buffer_load_dwordx4 v[32:35], v1, s[8:11], s21 offen offset:3072
    s_add_u32 s21, s21, 4096
    buffer_load_dwordx4 v[60:63], v1, s[8:11], s21 offen offset:0
    buffer_load_dwordx4 v[64:67], v1, s[8:11], s21 offen offset:1024
    buffer_load_dwordx4 v[36:39], v1, s[8:11], s21 offen offset:2048
    buffer_load_dwordx4 v[40:43], v1, s[8:11], s21 offen offset:3072
    s_add_u32 s21, s21, 4096
    v_mov_b32 v156, 0
    v_mov_b32 v157, 0
    v_mov_b32 v158, 0
    v_mov_b32 v159, 0
    v_mov_b32 v160, 0
    v_mov_b32 v161, 0
    v_mov_b32 v162, 0
    v_mov_b32 v163, 0
    v_mov_b32 v164, 0
    v_mov_b32 v165, 0
    v_mov_b32 v166, 0
    v_mov_b32 v167, 0
    v_mov_b32 v168, 0
    v_mov_b32 v169, 0
    v_mov_b32 v170, 0
    v_mov_b32 v171, 0
    v_mov_b32 v188, 0
    v_mov_b32 v189, 0
    v_mov_b32 v190, 0
    v_mov_b32 v191, 0
    v_mov_b32 v172, 0
    v_mov_b32 v173, 0
    v_mov_b32 v174, 0
    v_mov_b32 v175, 0
    v_mov_b32 v176, 0
    v_mov_b32 v177, 0
    v_mov_b32 v178, 0
    v_mov_b32 v179, 0
    v_mov_b32 v180, 0
    v_mov_b32 v181, 0
    v_mov_b32 v182, 0
    v_mov_b32 v183, 0
    v_mov_b32 v184, 0
    v_mov_b32 v185, 0
    v_mov_b32 v186, 0
    v_mov_b32 v187, 0
    v_mov_b32 v192, 0
    v_mov_b32 v193, 0
    v_mov_b32 v194, 0
    v_mov_b32 v195, 0
    v_mov_b32 v208, 0
    v_mov_b32 v88, 0
    v_mov_b32 v209, 0
    v_mov_b32 v89, 0
    v_mov_b32 v210, 0
    v_mov_b32 v90, 0
    v_mov_b32 v211, 0
    v_mov_b32 v91, 0
    s_waitcnt vmcnt(4)
    s_branch L_attn_main
L_attn_ok:
    s_mul_i32 s19, s16, 5120
    v_add_u32 v2, s19, v1
    s_xor_b32 s20, s16, 4
    s_mul_i32 s20, s20, 5120
    v_add_u32 v3, s20, v1
    s_cmp_ge_u32 s16, 4
    s_cbranch_scc1 L_attn_kh1
    v_mov_b32 v193, v213
    ds_write_b128 v2, v[172:175] offset:0
    ds_write_b128 v2, v[176:179] offset:1024
    ds_write_b128 v2, v[180:183] offset:2048
    ds_write_b128 v2, v[184:187] offset:3072
    ds_write_b128 v2, v[192:195] offset:4096
    s_waitcnt lgkmcnt(0)
    s_barrier
    ds_read_b128 v[108:111], v3 offset:4096
    ds_read_b128 v[92:95], v3 offset:0
    ds_read_b128 v[96:99], v3 offset:1024
    ds_read_b128 v[100:103], v3 offset:2048
    ds_read_b128 v[104:107], v3 offset:3072
    s_waitcnt lgkmcnt(4)
    v_max_f32 v4, v212, v109
    v_sub_f32 v5, v212, v4
    v_sub_f32 v4, v109, v4
    v_exp_f32 v5, v5
    v_exp_f32 v4, v4
    s_nop 0
    v_mul_f32 v110, v5, v188
    v_fmac_f32 v110, v4, v108
    v_rcp_f32 v110, v110
    s_nop 0
    v_mul_f32 v5, v5, v110
    v_mul_f32 v4, v4, v110
    s_waitcnt lgkmcnt(0)
    v_mul_f32 v92, v92, v4
    v_fmac_f32 v92, v156, v5
    v_mul_f32 v93, v93, v4
    v_fmac_f32 v93, v157, v5
    v_mul_f32 v94, v94, v4
    v_fmac_f32 v94, v158, v5
    v_mul_f32 v95, v95, v4
    v_fmac_f32 v95, v159, v5
    v_mul_f32 v96, v96, v4
    v_fmac_f32 v96, v160, v5
    v_mul_f32 v97, v97, v4
    v_fmac_f32 v97, v161, v5
    v_mul_f32 v98, v98, v4
    v_fmac_f32 v98, v162, v5
    v_mul_f32 v99, v99, v4
    v_fmac_f32 v99, v163, v5
    v_mul_f32 v100, v100, v4
    v_fmac_f32 v100, v164, v5
    v_mul_f32 v101, v101, v4
    v_fmac_f32 v101, v165, v5
    v_mul_f32 v102, v102, v4
    v_fmac_f32 v102, v166, v5
    v_mul_f32 v103, v103, v4
    v_fmac_f32 v103, v167, v5
    v_mul_f32 v104, v104, v4
    v_fmac_f32 v104, v168, v5
    v_mul_f32 v105, v105, v4
    v_fmac_f32 v105, v169, v5
    v_mul_f32 v106, v106, v4
    v_fmac_f32 v106, v170, v5
    v_mul_f32 v107, v107, v4
    v_fmac_f32 v107, v171, v5
    v_cvt_pk_bf16_f32 v196, v92, v93
    v_cvt_pk_bf16_f32 v197, v94, v95
    v_cvt_pk_bf16_f32 v198, v96, v97
    v_cvt_pk_bf16_f32 v199, v98, v99
    v_cvt_pk_bf16_f32 v200, v100, v101
    v_cvt_pk_bf16_f32 v201, v102, v103
    v_cvt_pk_bf16_f32 v202, v104, v105
    v_cvt_pk_bf16_f32 v203, v106, v107
    s_add_u32 s19, s18, 0
    s_branch L_attn_fin
L_attn_kh1:
    v_mov_b32 v189, v212
    ds_write_b128 v2, v[156:159] offset:0
    ds_write_b128 v2, v[160:163] offset:1024
    ds_write_b128 v2, v[164:167] offset:2048
    ds_write_b128 v2, v[168:171] offset:3072
    ds_write_b128 v2, v[188:191] offset:4096
    s_waitcnt lgkmcnt(0)
    s_barrier
    s_sub_u32 s27, s16, 4
    s_lshr_b32 s19, s2, 3
    s_and_b32 s19, s19, 31
    s_and_b32 s20, s2, 7
    s_mul_i32 s19, s19, 32
    s_lshr_b32 s20, s20, 2
    s_lshl_b32 s20, s20, 10
    s_add_u32 s20, s20, 384
    v_lshl_add_u32 v5, s27, 6, v0
    v_cmp_gt_u32 vcc, 32, v5
    v_add_u32 v5, s19, v5
    v_mul_u32_u24 v4, 2048, v5
    v_add_u32 v4, s20, v4
    v_mov_b32 v5, 2146435072
    s_nop 0
    v_cndmask_b32 v4, v5, v4, vcc
    buffer_load_dword v29, v4, s[40:43], 0 offen
    s_lshr_b32 s19, s2, 3
    s_lshl_b32 s19, s19, 2
    s_add_u32 s19, s19, s27
    s_cmp_ge_u32 s19, 2
    s_cbranch_scc1 L_attn_nct6
    s_getpc_b64 s[46:47]
L_attn_pc5:
    s_sub_u32 s46, s46, L_attn_pc5-code_start
    s_subb_u32 s47, s47, 0
    v_lshl_add_u32 v4, s19, 6, v0
    v_lshlrev_b32 v4, 7, v4
    v_add_u32 v4, cs_wo-code_start, v4
    v_min_u32 v4, ce_wo-code_start-4, v4
    v_mov_b32 v5, s47
    v_add_co_u32 v4, vcc, s46, v4
    s_nop 1
    v_addc_co_u32 v5, vcc, 0, v5, vcc
    global_load_dword v30, v[4:5], off
L_attn_nct6:
    ds_read_b128 v[108:111], v3 offset:4096
    ds_read_b128 v[92:95], v3 offset:0
    ds_read_b128 v[96:99], v3 offset:1024
    ds_read_b128 v[100:103], v3 offset:2048
    ds_read_b128 v[104:107], v3 offset:3072
    s_waitcnt lgkmcnt(4)
    v_max_f32 v4, v213, v109
    v_sub_f32 v5, v213, v4
    v_sub_f32 v4, v109, v4
    v_exp_f32 v5, v5
    v_exp_f32 v4, v4
    s_nop 0
    v_mul_f32 v110, v5, v192
    v_fmac_f32 v110, v4, v108
    v_rcp_f32 v110, v110
    s_nop 0
    v_mul_f32 v5, v5, v110
    v_mul_f32 v4, v4, v110
    s_waitcnt lgkmcnt(0)
    v_mul_f32 v92, v92, v4
    v_fmac_f32 v92, v172, v5
    v_mul_f32 v93, v93, v4
    v_fmac_f32 v93, v173, v5
    v_mul_f32 v94, v94, v4
    v_fmac_f32 v94, v174, v5
    v_mul_f32 v95, v95, v4
    v_fmac_f32 v95, v175, v5
    v_mul_f32 v96, v96, v4
    v_fmac_f32 v96, v176, v5
    v_mul_f32 v97, v97, v4
    v_fmac_f32 v97, v177, v5
    v_mul_f32 v98, v98, v4
    v_fmac_f32 v98, v178, v5
    v_mul_f32 v99, v99, v4
    v_fmac_f32 v99, v179, v5
    v_mul_f32 v100, v100, v4
    v_fmac_f32 v100, v180, v5
    v_mul_f32 v101, v101, v4
    v_fmac_f32 v101, v181, v5
    v_mul_f32 v102, v102, v4
    v_fmac_f32 v102, v182, v5
    v_mul_f32 v103, v103, v4
    v_fmac_f32 v103, v183, v5
    v_mul_f32 v104, v104, v4
    v_fmac_f32 v104, v184, v5
    v_mul_f32 v105, v105, v4
    v_fmac_f32 v105, v185, v5
    v_mul_f32 v106, v106, v4
    v_fmac_f32 v106, v186, v5
    v_mul_f32 v107, v107, v4
    v_fmac_f32 v107, v187, v5
    v_cvt_pk_bf16_f32 v196, v92, v93
    v_cvt_pk_bf16_f32 v197, v94, v95
    v_cvt_pk_bf16_f32 v198, v96, v97
    v_cvt_pk_bf16_f32 v199, v98, v99
    v_cvt_pk_bf16_f32 v200, v100, v101
    v_cvt_pk_bf16_f32 v201, v102, v103
    v_cvt_pk_bf16_f32 v202, v104, v105
    v_cvt_pk_bf16_f32 v203, v106, v107
    s_add_u32 s19, s18, 1
L_attn_fin:
    v_and_b32 v2, 0x13, v0
    v_bfe_u32 v3, v0, 2, 1
    v_lshl_or_b32 v2, v3, 3, v2
    v_bfe_u32 v3, v0, 3, 1
    v_lshl_or_b32 v2, v3, 2, v2
    v_lshlrev_b32 v2, 6, v2
    v_lshrrev_b32 v3, 5, v0
    v_lshl_or_b32 v2, v3, 4, v2
    s_lshl_b32 s20, s16, 11
    s_add_u32 s20, s20, 40960
    v_add_u32 v2, s20, v2
    v_add_u32 v3, s20, v1
    ds_write_b128 v2, v[196:199] offset:0
    ds_write_b128 v2, v[200:203] offset:32
    s_waitcnt lgkmcnt(0)
    ds_read_b128 v[204:207], v3 offset:0
    ds_read_b128 v[208:211], v3 offset:1024
    s_lshl_b32 s19, s19, 11
    s_lshl_b32 s20, s17, 17
    s_add_u32 s19, s19, s20
    s_waitcnt lgkmcnt(0)
    buffer_store_dwordx4 v[204:207], v1, s[12:15], s19 offen offset:0 sc1
    buffer_store_dwordx4 v[208:211], v1, s[12:15], s19 offen offset:1024 sc1
    s_branch L_sync_attn
L_attn_end:
    s_endpgm
L_sync_attn:
    s_load_dwordx2 s[4:5], s[0:1], 80
    s_waitcnt vmcnt(0) lgkmcnt(0)
    s_barrier
    s_add_u32 s8, s4, 65011712
    s_addc_u32 s9, s5, 0
    s_and_b32 s9, s9, 0xffff
    s_mov_b32 s10, 1048576
    s_mov_b32 s11, 131072
    v_mbcnt_lo_u32_b32 v0, -1, 0
    v_mbcnt_hi_u32_b32 v0, -1, v0
    s_xor_b32 s12, s3, 1
    s_mul_i32 s12, s12, 5
    s_add_u32 s12, s12, 1
    s_lshl_b32 s12, s12, 15
    s_cmp_lg_u32 s97, 0
    s_cbranch_scc1 L_syncattn_go1
    s_lshl_b32 s13, s96, 7
    s_add_u32 s13, s12, s13
    v_mov_b32 v1, 0
    v_mov_b32 v2, s95
    s_mov_b64 exec, 1
    buffer_store_dword v2, v1, s[8:11], s13 offen sc1
    s_mov_b64 exec, -1
L_syncattn_go1:
    s_and_b32 s14, s2, 7
    s_lshr_b32 s15, s2, 3
    s_and_b32 s13, s14, 3
    s_lshl_b32 s13, s13, 1
    s_bfe_u32 s15, s15, 0x10001
    s_add_u32 s13, s13, s15
    s_lshl_b32 s13, s13, 12
    s_add_u32 s99, s12, s13
    s_lshl_b32 s13, s97, 6
    v_or_b32 v0, s13, v0
    s_add_u32 s98, s98, 1
    s_branch wo_run
ce_attn:
code_end:
.section .rodata,"a"
.p2align 6
.amdhsa_kernel qkv_a_kernel
  .amdhsa_next_free_vgpr 256
  .amdhsa_next_free_sgpr 100
  .amdhsa_accum_offset 256
  .amdhsa_group_segment_fixed_size 0
  .amdhsa_kernarg_size 88
  .amdhsa_user_sgpr_count 2
  .amdhsa_user_sgpr_kernarg_segment_ptr 1
  .amdhsa_system_sgpr_workgroup_id_x 1
  .amdhsa_float_denorm_mode_32 3
.end_amdhsa_kernel
```
